```python
import torch

def _softmax(x, axis=-1):
    return torch.softmax(x, dim=axis)

def _gelu(x):
    return torch.nn.functional.gelu(x, approximate='tanh')

def _silu(x):
    return torch.nn.functional.silu(x)

def _sigmoid(x):
    return torch.sigmoid(x)

def _layernorm(x, axis=-1, eps=1e-05):
    m = x.mean(dim=axis, keepdim=True)
    v = x.var(dim=axis, keepdim=True, unbiased=False)
    return (x - m) / torch.sqrt(v + eps)

def _scatter_add(tgt, idx, src, axis=0):
    return tgt.clone().index_add_(axis, idx, src)

def _segment_sum(src, seg, n):
    out = torch.zeros((n,) + src.shape[1:], dtype=src.dtype)
    return out.index_add_(0, seg, src)

def _pad(x, pw):
    flat = tuple((v for pair in reversed(pw) for v in pair))
    return torch.nn.functional.pad(x, flat)
kernel_name = 'gated_mix__ssm_conv_h3__memory_aug_recurrent_mem_tr__prompt'

def setup_inputs():

    _w = lambda a: (lambda t: t.to(torch.bfloat16) if t.is_floating_point() else t)(torch.as_tensor(a))

    def _A_setup():
        B, S, D = (1, 2048, 512)
        ks = 4
        return {'q': _w((lambda *s: torch.randn(*s, dtype=torch.bfloat16) * 0.05)(B, S, D)), 'k': _w((lambda *s: torch.randn(*s, dtype=torch.bfloat16) * 1.6)(B, S, D)), 'v': _w((lambda *s: torch.randn(*s, dtype=torch.bfloat16) * 1.6)(B, S, D)), 'shift_k': _w((lambda *s: torch.randn(*s, dtype=torch.bfloat16) * 1.6)(D, ks) * 0.5), 'ssm_k': _w((lambda *s: torch.randn(*s, dtype=torch.bfloat16) * 1.6)(D, S) * (1.0 / S ** 0.5)), 'ssm_D': _w((lambda *s: torch.randn(*s, dtype=torch.bfloat16) * 1.6)(D))}
    _A_in = _A_setup()

    def _B_setup():
        B, S, Dm = (1, 2048, 512)
        H, Dh = (32, 128)
        M, seg = (8, 32)
        seg = min(seg, S)
        S = S // seg * seg
        return {'x': _w((lambda *s: torch.randn(*s, dtype=torch.bfloat16) * 0.05)(B, S, Dm)), 'mem0': _w((lambda *s: torch.randn(*s, dtype=torch.bfloat16) * 1.6)(B, M, Dm)), 'Wq': _w((lambda *s: torch.randn(*s, dtype=torch.bfloat16) * 0.8)(Dm, H, Dh) * Dm ** (-0.5)), 'Wk': _w((lambda *s: torch.randn(*s, dtype=torch.bfloat16) * 0.8)(Dm, H, Dh) * Dm ** (-0.5)), 'Wv': _w((lambda *s: torch.randn(*s, dtype=torch.bfloat16) * 1.6)(Dm, H, Dh) * Dm ** (-0.5)), 'Wo': _w((lambda *s: torch.randn(*s, dtype=torch.bfloat16) * 1.6)(H, Dh, Dm) * (H * Dh) ** (-0.5)), 'seg_len': seg}
    _B_in = _B_setup()
    return {'A_q': _A_in['q'], 'A_k': _A_in['k'], 'A_v': _A_in['v'], 'A_shift_k': _A_in['shift_k'], 'A_ssm_k': _A_in['ssm_k'], 'A_ssm_D': _A_in['ssm_D'], 'B_x': _B_in['x'], 'B_mem0': _B_in['mem0'], 'B_Wq': _B_in['Wq'], 'B_Wk': _B_in['Wk'], 'B_Wv': _B_in['Wv'], 'B_Wo': _B_in['Wo'], 'B_seg_len': _B_in['seg_len'], 'gate_w': _w((lambda *s: torch.randn(*s, dtype=torch.bfloat16) * 0.05)(512) * 16.0)}

def reference(A_q, A_k, A_v, A_shift_k, A_ssm_k, A_ssm_D, B_x, B_mem0, B_Wq, B_Wk, B_Wv, B_Wo, B_seg_len, gate_w):

    def _A_ref(q, k, v, shift_k, ssm_k, ssm_D):
        B, S, D = q.shape
        ks = shift_k.shape[-1]
        k_pad = _pad(k, ((0, 0), (ks - 1, 0), (0, 0)))
        k_shift = torch.zeros_like(k)
        for t in range(ks):
            k_shift = k_shift + k_pad[:, t:t + S, :] * shift_k[:, ks - 1 - t][None, None, :]
        kv = k_shift * v
        L = 2 * S
        kv_pad = _pad(kv, ((0, 0), (0, S), (0, 0)))
        kf_pad = _pad(ssm_k, ((0, 0), (0, S)))
        kv_f = (lambda x, axes=(-2, -1): torch.fft.rfft2(x.float(), dim=axes))(kv_pad[:, None, :, :], axes=(1, 2))
        kf_f = (lambda x, axes=(-2, -1): torch.fft.rfft2(x.float(), dim=axes))(kf_pad[:, None, :], axes=(1, 2))
        kf_f = (lambda x, *d: x.permute(*d))(kf_f, 1, 2, 0)
        y_f = kv_f * kf_f[None, :, :, :]
        y = (lambda x, s, axes=(-2, -1): torch.fft.irfft2(x, s=s, dim=axes).to(torch.bfloat16))(y_f, (1, L), axes=(1, 2))[:, 0, :S, :]
        y = y + kv * ssm_D[None, None, :]
        return q * y

    def _B_ref(x, mem0, Wq, Wk, Wv, Wo, seg_len):
        B, S, Dm = x.shape
        H, Dh = (Wq.shape[1], Wq.shape[2])
        M = mem0.shape[1]
        scale = Dh ** (-0.5)
        n_seg = S // seg_len
        L = M + seg_len
        idx = torch.arange(L)
        mask = (idx[:, None] < M) | (idx[:, None] >= idx[None, :])
        mem = mem0
        outs = []
        for s in range(n_seg):
            xs = x[:, s * seg_len:(s + 1) * seg_len, :].clone()
            h = torch.concatenate([mem, xs], axis=1)
            q = torch.einsum('btd,dhe->bhte', h, Wq)
            k = torch.einsum('btd,dhe->bhte', h, Wk)
            v = torch.einsum('btd,dhe->bhte', h, Wv)
            scores = torch.einsum('bhqe,bhke->bhqk', q, k) * scale
            scores = torch.where(mask[None, None], scores, -1000000000.0)
            p = _softmax(scores, axis=-1)
            o = torch.einsum('bhqk,bhke->bhqe', p, v)
            o = torch.einsum('bhte,hed->btd', o, Wo)
            mem = o[:, :M, :].clone()
            outs.append(o[:, M:, :])
        return torch.concatenate(outs, axis=1)
    x = A_q
    g = _sigmoid((x * gate_w).sum(-1, keepdims=True))
    a = _A_ref(x, A_k, A_v, A_shift_k, A_ssm_k, A_ssm_D)
    b = _B_ref(x, B_mem0, B_Wq, B_Wk, B_Wv, B_Wo, B_seg_len)
    return g * a + (1 - g) * b
```

```asm
; @launch grid=(256,1,1) block=(256,1,1) lds=163840
.amdgcn_target "amdgcn-amd-amdhsa--gfx950"
.text
.globl gated_mix__ssm_conv_h3__memory_aug_recurrent_mem_tr__prompt_kernel
.p2align 8
.type gated_mix__ssm_conv_h3__memory_aug_recurrent_mem_tr__prompt_kernel,@function
gated_mix__ssm_conv_h3__memory_aug_recurrent_mem_tr__prompt_kernel:
    s_cmp_ge_u32 s2, 256
    s_cbranch_scc1 KEND
    s_load_dwordx8 s[4:11], s[0:1], 0
    s_load_dwordx4 s[12:15], s[0:1], 32
    s_load_dwordx2 s[16:17], s[0:1], 56
    s_load_dwordx8 s[20:27], s[0:1], 64
    s_load_dwordx4 s[28:31], s[0:1], 104
    s_load_dwordx4 s[32:35], s[0:1], 120
    s_getreg_b32 s49, hwreg(HW_REG_XCC_ID)
    s_and_b32 s49, s49, 7
    v_lshrrev_b32 v1, 6, v0
    v_mov_b32 v2, v0
    v_and_b32 v0, 63, v0
    v_readfirstlane_b32 s48, v1
    s_waitcnt lgkmcnt(0)
    s_mov_b32 s36, s34
    s_mov_b32 s37, s35
    s_mov_b32 s38, 268435456
    s_mov_b32 s39, 0x20000
    s_cmp_eq_u32 s48, 0
    s_cbranch_scc0 PRO_NORANK
    s_and_b32 s67, s49, 3
    s_lshl_b32 s67, s67, 6
    s_lshr_b32 s68, s49, 2
    s_lshl_b32 s68, s68, 2
    s_add_u32 s67, s67, s68
    v_mov_b32 v3, s67
    v_mov_b32 v4, 1
    s_mov_b64 exec, 1
    global_atomic_add v5, v3, v4, s[32:33] sc0
    s_mov_b64 exec, -1
PRO_NORANK:
    s_waitcnt vmcnt(0)
    s_cmp_eq_u32 s48, 0
    s_cbranch_scc0 PRO_W
    v_readfirstlane_b32 s51, v5
    s_mov_b32 s50, s49
    s_cmp_lt_u32 s51, 32
    s_cbranch_scc1 PRO_HAVE
    v_mov_b32 v3, 136
    s_mov_b64 exec, 1
    global_atomic_add v5, v3, v4, s[32:33] sc0
    s_mov_b64 exec, -1
    v_lshlrev_b32 v9, 2, v0
    s_mov_b32 s65, 0
PRO_OV:
    global_load_dword v10, v9, s[32:33] sc1
    s_add_u32 s65, s65, 1
    s_waitcnt vmcnt(0)
    s_mov_b32 s68, 0
    v_readlane_b32 s67, v10, 0
    s_add_u32 s68, s68, s67
    v_readlane_b32 s67, v10, 16
    s_add_u32 s68, s68, s67
    v_readlane_b32 s67, v10, 32
    s_add_u32 s68, s68, s67
    v_readlane_b32 s67, v10, 48
    s_add_u32 s68, s68, s67
    v_readlane_b32 s67, v10, 1
    s_add_u32 s68, s68, s67
    v_readlane_b32 s67, v10, 17
    s_add_u32 s68, s68, s67
    v_readlane_b32 s67, v10, 33
    s_add_u32 s68, s68, s67
    v_readlane_b32 s67, v10, 49
    s_add_u32 s68, s68, s67
    s_cmp_ge_u32 s68, 256
    s_cbranch_scc1 PRO_OV2
    s_sleep 8
    s_cmp_lt_u32 s65, 262144
    s_cbranch_scc1 PRO_OV
PRO_OV2:
    v_readfirstlane_b32 s68, v5
    s_mov_b32 s50, 7
    s_mov_b32 s51, 31
    v_readlane_b32 s67, v10, 0
    s_min_u32 s67, s67, 32
    s_add_u32 s65, s67, s68
    s_cmp_lt_u32 s65, 32
    s_cbranch_scc0 PRO_OVN0
    s_mov_b32 s50, 0
    s_mov_b32 s51, s65
    s_branch PRO_HAVE
PRO_OVN0:
    s_sub_u32 s68, s65, 32
    v_readlane_b32 s67, v10, 16
    s_min_u32 s67, s67, 32
    s_add_u32 s65, s67, s68
    s_cmp_lt_u32 s65, 32
    s_cbranch_scc0 PRO_OVN1
    s_mov_b32 s50, 1
    s_mov_b32 s51, s65
    s_branch PRO_HAVE
PRO_OVN1:
    s_sub_u32 s68, s65, 32
    v_readlane_b32 s67, v10, 32
    s_min_u32 s67, s67, 32
    s_add_u32 s65, s67, s68
    s_cmp_lt_u32 s65, 32
    s_cbranch_scc0 PRO_OVN2
    s_mov_b32 s50, 2
    s_mov_b32 s51, s65
    s_branch PRO_HAVE
PRO_OVN2:
    s_sub_u32 s68, s65, 32
    v_readlane_b32 s67, v10, 48
    s_min_u32 s67, s67, 32
    s_add_u32 s65, s67, s68
    s_cmp_lt_u32 s65, 32
    s_cbranch_scc0 PRO_OVN3
    s_mov_b32 s50, 3
    s_mov_b32 s51, s65
    s_branch PRO_HAVE
PRO_OVN3:
    s_sub_u32 s68, s65, 32
    v_readlane_b32 s67, v10, 1
    s_min_u32 s67, s67, 32
    s_add_u32 s65, s67, s68
    s_cmp_lt_u32 s65, 32
    s_cbranch_scc0 PRO_OVN4
    s_mov_b32 s50, 4
    s_mov_b32 s51, s65
    s_branch PRO_HAVE
PRO_OVN4:
    s_sub_u32 s68, s65, 32
    v_readlane_b32 s67, v10, 17
    s_min_u32 s67, s67, 32
    s_add_u32 s65, s67, s68
    s_cmp_lt_u32 s65, 32
    s_cbranch_scc0 PRO_OVN5
    s_mov_b32 s50, 5
    s_mov_b32 s51, s65
    s_branch PRO_HAVE
PRO_OVN5:
    s_sub_u32 s68, s65, 32
    v_readlane_b32 s67, v10, 33
    s_min_u32 s67, s67, 32
    s_add_u32 s65, s67, s68
    s_cmp_lt_u32 s65, 32
    s_cbranch_scc0 PRO_OVN6
    s_mov_b32 s50, 6
    s_mov_b32 s51, s65
    s_branch PRO_HAVE
PRO_OVN6:
    s_sub_u32 s68, s65, 32
    v_readlane_b32 s67, v10, 49
    s_min_u32 s67, s67, 32
    s_add_u32 s65, s67, s68
    s_cmp_lt_u32 s65, 32
    s_cbranch_scc0 PRO_OVN7
    s_mov_b32 s50, 7
    s_mov_b32 s51, s65
    s_branch PRO_HAVE
PRO_OVN7:
    s_sub_u32 s68, s65, 32
PRO_HAVE:
    v_mov_b32 v10, s50
    v_mov_b32 v11, s51
    v_mov_b32 v9, 0
    ds_write_b64 v9, v[10:11]
    s_waitcnt lgkmcnt(0)
PRO_W:
    s_barrier
    v_mov_b32 v9, 0
    ds_read_b64 v[10:11], v9
    s_waitcnt lgkmcnt(0)
    v_readfirstlane_b32 s50, v10
    v_readfirstlane_b32 s51, v11
    s_and_b32 s50, s50, 7
    s_and_b32 s51, s51, 31
    s_cmp_eq_u32 s48, 0
    s_cselect_b32 s76, 1, 0
    s_mov_b32 s77, 0
    s_cmp_eq_u32 s50, 0
    s_cbranch_scc1 PRO_NOINIT
    s_cmp_lt_u32 s51, 4
    s_cbranch_scc0 PRO_NOINIT
    s_sub_u32 s68, s50, 1
    s_lshl_b32 s68, s68, 2
    s_add_u32 s68, s68, s51
    v_mov_b64 v[12:13], -1
    v_mov_b64 v[14:15], -1
    v_mov_b32 v8, 0
    v_lshlrev_b32 v9, 4, v2
    v_lshlrev_b32 v3, 2, v2
PRO_INIT:
    s_lshl_b32 s67, s68, 10
    buffer_store_dword v8, v3, s[36:39], s67 offen sc1
    s_lshl_b32 s67, s68, 13
    s_add_u32 s67, s67, 524288
    v_lshlrev_b32 v16, 5, v2
    buffer_store_dword v8, v16, s[36:39], s67 offen sc1
    s_lshl_b32 s67, s68, 12
    s_add_u32 s67, s67, 58064896
    buffer_store_dwordx4 v[12:15], v9, s[36:39], s67 offen sc1
    s_add_u32 s67, s67, 0x20000
    buffer_store_dwordx4 v[12:15], v9, s[36:39], s67 offen sc1
    s_add_u32 s67, s67, 0x20000
    buffer_store_dwordx4 v[12:15], v9, s[36:39], s67 offen sc1
    s_add_u32 s67, s67, 0x20000
    buffer_store_dwordx4 v[12:15], v9, s[36:39], s67 offen sc1
    s_add_u32 s67, s67, 0x20000
    buffer_store_dwordx4 v[12:15], v9, s[36:39], s67 offen sc1
    s_add_u32 s67, s67, 0x20000
    buffer_store_dwordx4 v[12:15], v9, s[36:39], s67 offen sc1
    s_add_u32 s67, s67, 0x20000
    buffer_store_dwordx4 v[12:15], v9, s[36:39], s67 offen sc1
    s_add_u32 s67, s67, 0x20000
    s_add_u32 s68, s68, 28
    s_cmp_lt_u32 s68, 32
    s_cbranch_scc1 PRO_INIT
    s_waitcnt vmcnt(0)
    s_barrier
    v_mov_b32 v3, 72
    v_mov_b32 v4, 1
    s_mov_b64 exec, s[76:77]
    global_atomic_add v3, v4, s[32:33]
    s_mov_b64 exec, -1
PRO_NOINIT:
    s_mov_b32 s65, 0
    s_barrier
    s_cmp_eq_u32 s50, 0
    s_cbranch_scc0 WORKER
    v_and_b32 v16, 15, v0
    v_lshrrev_b32 v17, 4, v0
    v_and_b32 v18, 3, v0
    v_lshrrev_b32 v19, 2, v0
    s_lshl_b32 s67, s51, 8
    s_lshl_b32 s68, s48, 6
    s_add_u32 s67, s67, s68
    v_lshlrev_b32 v20, 13, v19
    v_lshl_add_u32 v20, v18, 4, v20
    v_add_u32 v20, s67, v20
    s_lshl_b32 s67, s51, 17
    s_lshl_b32 s68, s48, 8
    s_add_u32 s67, s67, s68
    v_lshlrev_b32 v21, 10, v19
    v_lshl_add_u32 v21, v18, 4, v21
    v_add_u32 v21, s67, v21
    v_and_b32 v22, 1, v17
    v_lshlrev_b32 v22, 5, v22
    v_lshrrev_b32 v23, 1, v17
    v_lshl_add_u32 v22, v23, 2, v22
    v_lshrrev_b32 v23, 3, v16
    v_lshl_add_u32 v22, v23, 4, v22
    v_bfe_u32 v23, v16, 2, 1
    v_add_u32 v22, v22, v23
    v_lshlrev_b32 v22, 6, v22
    v_lshl_add_u32 v22, v18, 3, v22
    s_mul_i32 s62, s48, 28672
    s_mul_i32 s61, s48, 12288
    s_add_u32 s61, s61, 114688
    v_add_u32 v24, s62, v22
    v_add_u32 v25, s61, v22
    v_lshl_add_u32 v7, v0, 4, s62
    s_mov_b32 s40, s20
    s_mov_b32 s41, s21
    s_mov_b32 s42, 4194304
    s_mov_b32 s43, 0x20000
    s_mov_b32 s44, s22
    s_mov_b32 s45, s23
    s_mov_b32 s46, 4194304
    s_mov_b32 s47, 0x20000
    s_mov_b32 s84, s24
    s_mov_b32 s85, s25
    s_mov_b32 s86, 4194304
    s_mov_b32 s87, 0x20000
    s_mov_b32 s88, s26
    s_mov_b32 s89, s27
    s_mov_b32 s90, 4194304
    s_mov_b32 s91, 0x20000
    v_mov_b64 v[32:33], -1
    v_mov_b64 v[34:35], -1
    s_lshl_b32 s67, s51, 13
    s_lshl_b32 s68, s48, 11
    s_add_u32 s67, s67, s68
    s_add_u32 s67, s67, 1048576
    v_lshlrev_b32 v36, 4, v0
    buffer_store_dwordx4 v[32:35], v36, s[36:39], s67 offen sc1
    buffer_store_dwordx4 v[32:35], v36, s[36:39], s67 offen offset:1024 sc1
    s_mul_i32 s67, s51, 768
    s_lshl_b32 s68, s48, 8
    s_add_u32 s67, s67, s68
    s_add_u32 s67, s67, 262144
    s_cmp_lt_u32 s48, 3
    s_cselect_b32 exec_lo, 0xffff, 0
    s_mov_b32 exec_hi, 0
    buffer_store_dwordx4 v[32:35], v36, s[36:39], s67 offen sc1
    s_mov_b64 exec, -1
    s_mov_b32 s92, s16
    s_mov_b32 s93, s17
    s_mov_b32 s94, 8192
    s_mov_b32 s95, 0x20000
    s_lshl_b32 s67, s48, 8
    v_lshlrev_b32 v26, 11, v17
    v_lshl_add_u32 v26, v16, 1, v26
    v_add_u32 v26, s67, v26
    s_add_u32 m0, s62, 20480
    s_mov_b32 s67, 1572864
    buffer_load_dwordx4 v20, s[40:43], s67 offen lds
    s_add_u32 m0, s62, 21504
    s_mov_b32 s67, 1703936
    buffer_load_dwordx4 v20, s[40:43], s67 offen lds
    s_add_u32 m0, s62, 22528
    s_mov_b32 s67, 1835008
    buffer_load_dwordx4 v20, s[40:43], s67 offen lds
    s_add_u32 m0, s62, 23552
    s_mov_b32 s67, 1966080
    buffer_load_dwordx4 v20, s[40:43], s67 offen lds
    s_add_u32 m0, s62, 24576
    s_mov_b32 s67, 2097152
    buffer_load_dwordx4 v20, s[40:43], s67 offen lds
    s_add_u32 m0, s62, 25600
    s_mov_b32 s67, 2228224
    buffer_load_dwordx4 v20, s[40:43], s67 offen lds
    s_add_u32 m0, s62, 26624
    s_mov_b32 s67, 2359296
    buffer_load_dwordx4 v20, s[40:43], s67 offen lds
    s_add_u32 m0, s62, 27648
    s_mov_b32 s67, 2490368
    buffer_load_dwordx4 v20, s[40:43], s67 offen lds
    s_add_u32 m0, s61, 0
    s_mov_b32 s67, 2621440
    buffer_load_dwordx4 v20, s[40:43], s67 offen lds
    s_add_u32 m0, s61, 1024
    s_mov_b32 s67, 2752512
    buffer_load_dwordx4 v20, s[40:43], s67 offen lds
    s_add_u32 m0, s61, 2048
    s_mov_b32 s67, 2883584
    buffer_load_dwordx4 v20, s[40:43], s67 offen lds
    s_add_u32 m0, s61, 3072
    s_mov_b32 s67, 3014656
    buffer_load_dwordx4 v20, s[40:43], s67 offen lds
    s_add_u32 m0, s61, 4096
    s_mov_b32 s67, 3145728
    buffer_load_dwordx4 v20, s[40:43], s67 offen lds
    s_add_u32 m0, s61, 5120
    s_mov_b32 s67, 3276800
    buffer_load_dwordx4 v20, s[40:43], s67 offen lds
    s_add_u32 m0, s61, 6144
    s_mov_b32 s67, 3407872
    buffer_load_dwordx4 v20, s[40:43], s67 offen lds
    s_add_u32 m0, s61, 7168
    s_mov_b32 s67, 3538944
    buffer_load_dwordx4 v20, s[40:43], s67 offen lds
    buffer_load_ushort v48, v26, s[92:95], 0 offen offset:0
    buffer_load_ushort v49, v26, s[92:95], 0 offen offset:32
    buffer_load_ushort v56, v26, s[92:95], 0 offen offset:1024
    buffer_load_ushort v57, v26, s[92:95], 0 offen offset:1056
    buffer_load_ushort v50, v26, s[92:95], 0 offen offset:64
    buffer_load_ushort v51, v26, s[92:95], 0 offen offset:96
    buffer_load_ushort v58, v26, s[92:95], 0 offen offset:1088
    buffer_load_ushort v59, v26, s[92:95], 0 offen offset:1120
    buffer_load_ushort v52, v26, s[92:95], 0 offen offset:128
    buffer_load_ushort v53, v26, s[92:95], 0 offen offset:160
    buffer_load_ushort v60, v26, s[92:95], 0 offen offset:1152
    buffer_load_ushort v61, v26, s[92:95], 0 offen offset:1184
    buffer_load_ushort v54, v26, s[92:95], 0 offen offset:192
    buffer_load_ushort v55, v26, s[92:95], 0 offen offset:224
    buffer_load_ushort v62, v26, s[92:95], 0 offen offset:1216
    buffer_load_ushort v63, v26, s[92:95], 0 offen offset:1248
    v_and_b32 v26, 2, v0
    v_cmp_eq_u32 vcc, 2, v26
    v_mov_b32 v27, 0x44444444
    v_mov_b32 v28, 0xeeeeeeee
    s_mov_b64 s[78:79], vcc
    v_cndmask_b32 v29, v27, v28, vcc
    v_mov_b32 v12, 0
    v_mov_b32 v13, 0
    v_mov_b32 v14, 0
    v_mov_b32 v15, 0
    v_mov_b32 v27, 0x3f80
    v_mov_b32 v28, 0x3f800000
    v_cmp_eq_u32 vcc, 0, v16
    s_nop 1
    v_cndmask_b32 v12, v12, v27, vcc
    v_cmp_eq_u32 vcc, 1, v16
    s_nop 1
    v_cndmask_b32 v12, v12, v28, vcc
    v_cmp_eq_u32 vcc, 2, v16
    s_nop 1
    v_cndmask_b32 v13, v13, v27, vcc
    v_cmp_eq_u32 vcc, 3, v16
    s_nop 1
    v_cndmask_b32 v13, v13, v28, vcc
    v_cmp_eq_u32 vcc, 4, v16
    s_nop 1
    v_cndmask_b32 v14, v14, v27, vcc
    v_cmp_eq_u32 vcc, 5, v16
    s_nop 1
    v_cndmask_b32 v14, v14, v28, vcc
    v_cmp_eq_u32 vcc, 6, v16
    s_nop 1
    v_cndmask_b32 v15, v15, v27, vcc
    v_cmp_eq_u32 vcc, 7, v16
    s_nop 1
    v_cndmask_b32 v15, v15, v28, vcc
    s_and_b32 s67, s48, 2
    s_lshl_b32 s67, s67, 11
    s_lshl_b32 s68, s51, 7
    s_add_u32 s67, s67, s68
    v_lshrrev_b32 v26, 3, v0
    v_and_b32 v27, 7, v0
    v_lshlrev_b32 v1, 13, v26
    v_lshl_add_u32 v1, v27, 4, v1
    v_add_u32 v1, s67, v1
    s_lshl_b32 s68, s48, 9
    v_lshl_add_u32 v11, v0, 3, s68
    v_and_b32 v26, 1, v17
    v_lshl_add_u32 v26, v27, 1, v26
    s_and_b32 s68, s51, 3
    v_mov_b32 v27, s68
    v_lshrrev_b32 v28, 1, v27
    v_lshl_add_u32 v28, v28, 3, v26
    v_and_b32 v28, 15, v28
    v_lshl_add_u32 v28, v27, 4, v28
    v_lshlrev_b32 v2, 3, v28
    s_and_b32 s67, s67, 0xfffffe00
    v_add_u32 v2, s67, v2
    s_mov_b32 s72, 0x00FF00FF
    s_mov_b32 s73, 0
    s_mov_b32 s74, -1
    s_mov_b32 s75, 0
    v_bfe_u32 v26, v0, 3, 1
    v_lshl_add_u32 v2, v26, 14, v2
    s_lshl_b32 s67, s48, 11
    s_add_u32 s67, s67, 147456
    v_lshl_add_u32 v3, v0, 4, s67
    s_lshl_b32 s67, s48, 10
    s_add_u32 s67, s67, 155648
    v_lshrrev_b32 v28, 1, v17
    v_lshl_add_u32 v28, v28, 3, v16
    v_and_b32 v28, 15, v28
    v_lshl_add_u32 v28, v17, 4, v28
    v_lshlrev_b32 v6, 3, v28
    v_add_u32 v6, s67, v6
    v_lshrrev_b32 v26, 2, v16
    v_lshl_add_u32 v26, v17, 2, v26
    v_lshrrev_b32 v28, 1, v18
    v_lshl_add_u32 v28, v28, 3, v26
    v_and_b32 v28, 15, v28
    v_lshl_add_u32 v28, v18, 4, v28
    v_lshlrev_b32 v4, 3, v28
    v_add_u32 v4, 147456, v4
    v_and_b32 v27, 1, v18
    v_lshlrev_b32 v27, 1, v27
    v_lshrrev_b32 v28, 1, v18
    v_or_b32 v27, v27, v28
    v_lshrrev_b32 v28, 1, v27
    v_lshl_add_u32 v28, v28, 3, v26
    v_and_b32 v28, 15, v28
    v_lshl_add_u32 v28, v27, 4, v28
    v_lshlrev_b32 v5, 3, v28
    v_add_u32 v5, 147456, v5
    v_lshlrev_b32 v8, 4, v0
    v_add_u32 v8, 114688, v8
    v_lshrrev_b32 v26, 1, v17
    v_lshl_add_u32 v26, v26, 4, v16
    v_lshlrev_b32 v26, 4, v26
    v_and_b32 v27, 1, v17
    v_lshl_add_u32 v26, v27, 3, v26
    s_lshl_b32 s67, s48, 11
    s_add_u32 s67, s67, 122880
    v_add_u32 v9, s67, v26
    v_lshlrev_b32 v65, 2, v0
    s_mov_b32 s52, 0
    s_mov_b32 s64, 0
    s_mov_b32 s82, 0
    s_waitcnt vmcnt(28)
    ds_read_b64_tr_b16 a[0:1], v24 offset:20480
    ds_read_b64_tr_b16 a[2:3], v24 offset:20608
    ds_read_b64_tr_b16 a[4:5], v24 offset:20992
    ds_read_b64_tr_b16 a[6:7], v24 offset:21120
    ds_read_b64_tr_b16 a[8:9], v24 offset:20512
    ds_read_b64_tr_b16 a[10:11], v24 offset:20640
    ds_read_b64_tr_b16 a[12:13], v24 offset:21024
    ds_read_b64_tr_b16 a[14:15], v24 offset:21152
    s_waitcnt lgkmcnt(0)
    s_add_u32 m0, s61, 8192
    s_mov_b32 s67, 3670016
    buffer_load_dwordx4 v20, s[40:43], s67 offen lds
    s_add_u32 m0, s61, 9216
    s_mov_b32 s67, 3801088
    buffer_load_dwordx4 v20, s[40:43], s67 offen lds
    s_add_u32 m0, s61, 10240
    s_mov_b32 s67, 3932160
    buffer_load_dwordx4 v20, s[40:43], s67 offen lds
    s_add_u32 m0, s61, 11264
    s_mov_b32 s67, 4063232
    buffer_load_dwordx4 v20, s[40:43], s67 offen lds
    s_waitcnt vmcnt(28)
    ds_read_b64_tr_b16 a[16:17], v24 offset:24576
    ds_read_b64_tr_b16 a[18:19], v24 offset:24704
    ds_read_b64_tr_b16 a[20:21], v24 offset:25088
    ds_read_b64_tr_b16 a[22:23], v24 offset:25216
    ds_read_b64_tr_b16 a[24:25], v24 offset:24608
    ds_read_b64_tr_b16 a[26:27], v24 offset:24736
    ds_read_b64_tr_b16 a[28:29], v24 offset:25120
    ds_read_b64_tr_b16 a[30:31], v24 offset:25248
    s_waitcnt lgkmcnt(0)
    s_add_u32 m0, s62, 0
    s_mov_b32 s67, 0
    buffer_load_dwordx4 v20, s[44:47], s67 offen lds
    s_add_u32 m0, s62, 1024
    s_mov_b32 s67, 131072
    buffer_load_dwordx4 v20, s[44:47], s67 offen lds
    s_add_u32 m0, s62, 2048
    s_mov_b32 s67, 262144
    buffer_load_dwordx4 v20, s[44:47], s67 offen lds
    s_add_u32 m0, s62, 3072
    s_mov_b32 s67, 393216
    buffer_load_dwordx4 v20, s[44:47], s67 offen lds
    s_barrier
    v_mov_b32 v36, 72
    v_mov_b32 v37, 1
    s_mov_b64 exec, s[76:77]
    global_atomic_add v36, v37, s[32:33]
    s_mov_b64 exec, -1
    s_waitcnt vmcnt(29)
    ds_read_b64_tr_b16 a[32:33], v25 offset:0
    ds_read_b64_tr_b16 a[34:35], v25 offset:128
    ds_read_b64_tr_b16 a[36:37], v25 offset:512
    ds_read_b64_tr_b16 a[38:39], v25 offset:640
    ds_read_b64_tr_b16 a[40:41], v25 offset:32
    ds_read_b64_tr_b16 a[42:43], v25 offset:160
    ds_read_b64_tr_b16 a[44:45], v25 offset:544
    ds_read_b64_tr_b16 a[46:47], v25 offset:672
    s_waitcnt lgkmcnt(0)
    s_add_u32 m0, s62, 4096
    s_mov_b32 s67, 524288
    buffer_load_dwordx4 v20, s[44:47], s67 offen lds
    s_add_u32 m0, s62, 5120
    s_mov_b32 s67, 655360
    buffer_load_dwordx4 v20, s[44:47], s67 offen lds
    s_add_u32 m0, s62, 6144
    s_mov_b32 s67, 786432
    buffer_load_dwordx4 v20, s[44:47], s67 offen lds
    s_add_u32 m0, s62, 7168
    s_mov_b32 s67, 917504
    buffer_load_dwordx4 v20, s[44:47], s67 offen lds
    s_waitcnt vmcnt(29)
    ds_read_b64_tr_b16 a[48:49], v25 offset:4096
    ds_read_b64_tr_b16 a[50:51], v25 offset:4224
    ds_read_b64_tr_b16 a[52:53], v25 offset:4608
    ds_read_b64_tr_b16 a[54:55], v25 offset:4736
    ds_read_b64_tr_b16 a[56:57], v25 offset:4128
    ds_read_b64_tr_b16 a[58:59], v25 offset:4256
    ds_read_b64_tr_b16 a[60:61], v25 offset:4640
    ds_read_b64_tr_b16 a[62:63], v25 offset:4768
    s_waitcnt lgkmcnt(0)
    s_add_u32 m0, s62, 8192
    s_mov_b32 s67, 1048576
    buffer_load_dwordx4 v20, s[44:47], s67 offen lds
    s_add_u32 m0, s62, 9216
    s_mov_b32 s67, 1179648
    buffer_load_dwordx4 v20, s[44:47], s67 offen lds
    s_add_u32 m0, s62, 10240
    s_mov_b32 s67, 1310720
    buffer_load_dwordx4 v20, s[44:47], s67 offen lds
    s_add_u32 m0, s62, 11264
    s_mov_b32 s67, 1441792
    buffer_load_dwordx4 v20, s[44:47], s67 offen lds
    s_waitcnt vmcnt(13)
    ds_read_b64_tr_b16 a[64:65], v25 offset:8192
    ds_read_b64_tr_b16 a[66:67], v25 offset:8320
    ds_read_b64_tr_b16 a[68:69], v25 offset:8704
    ds_read_b64_tr_b16 a[70:71], v25 offset:8832
    ds_read_b64_tr_b16 a[72:73], v25 offset:8224
    ds_read_b64_tr_b16 a[74:75], v25 offset:8352
    ds_read_b64_tr_b16 a[76:77], v25 offset:8736
    ds_read_b64_tr_b16 a[78:79], v25 offset:8864
    s_waitcnt lgkmcnt(0)
    s_add_u32 m0, s62, 12288
    s_mov_b32 s67, 1572864
    buffer_load_dwordx4 v20, s[44:47], s67 offen lds
    s_add_u32 m0, s62, 13312
    s_mov_b32 s67, 1703936
    buffer_load_dwordx4 v20, s[44:47], s67 offen lds
    s_add_u32 m0, s62, 14336
    s_mov_b32 s67, 1835008
    buffer_load_dwordx4 v20, s[44:47], s67 offen lds
    s_add_u32 m0, s62, 15360
    s_mov_b32 s67, 1966080
    buffer_load_dwordx4 v20, s[44:47], s67 offen lds
    s_waitcnt vmcnt(13)
    ds_read_b64_tr_b16 a[80:81], v24 offset:0
    ds_read_b64_tr_b16 a[82:83], v24 offset:128
    ds_read_b64_tr_b16 a[84:85], v24 offset:512
    ds_read_b64_tr_b16 a[86:87], v24 offset:640
    ds_read_b64_tr_b16 a[88:89], v24 offset:32
    ds_read_b64_tr_b16 a[90:91], v24 offset:160
    ds_read_b64_tr_b16 a[92:93], v24 offset:544
    ds_read_b64_tr_b16 a[94:95], v24 offset:672
    s_waitcnt lgkmcnt(0)
    s_add_u32 m0, s62, 16384
    s_mov_b32 s67, 2097152
    buffer_load_dwordx4 v20, s[44:47], s67 offen lds
    s_add_u32 m0, s62, 17408
    s_mov_b32 s67, 2228224
    buffer_load_dwordx4 v20, s[44:47], s67 offen lds
    s_add_u32 m0, s62, 18432
    s_mov_b32 s67, 2359296
    buffer_load_dwordx4 v20, s[44:47], s67 offen lds
    s_add_u32 m0, s62, 19456
    s_mov_b32 s67, 2490368
    buffer_load_dwordx4 v20, s[44:47], s67 offen lds
    s_waitcnt vmcnt(12)
    ds_read_b64_tr_b16 a[96:97], v24 offset:4096
    ds_read_b64_tr_b16 a[98:99], v24 offset:4224
    ds_read_b64_tr_b16 a[100:101], v24 offset:4608
    ds_read_b64_tr_b16 a[102:103], v24 offset:4736
    ds_read_b64_tr_b16 a[104:105], v24 offset:4128
    ds_read_b64_tr_b16 a[106:107], v24 offset:4256
    ds_read_b64_tr_b16 a[108:109], v24 offset:4640
    ds_read_b64_tr_b16 a[110:111], v24 offset:4768
    s_waitcnt lgkmcnt(0)
    s_add_u32 m0, s62, 20480
    s_mov_b32 s67, 2621440
    buffer_load_dwordx4 v20, s[44:47], s67 offen lds
    s_add_u32 m0, s62, 21504
    s_mov_b32 s67, 2752512
    buffer_load_dwordx4 v20, s[44:47], s67 offen lds
    s_add_u32 m0, s62, 22528
    s_mov_b32 s67, 2883584
    buffer_load_dwordx4 v20, s[44:47], s67 offen lds
    s_add_u32 m0, s62, 23552
    s_mov_b32 s67, 3014656
    buffer_load_dwordx4 v20, s[44:47], s67 offen lds
    s_waitcnt vmcnt(12)
    ds_read_b64_tr_b16 a[112:113], v24 offset:8192
    ds_read_b64_tr_b16 a[114:115], v24 offset:8320
    ds_read_b64_tr_b16 a[116:117], v24 offset:8704
    ds_read_b64_tr_b16 a[118:119], v24 offset:8832
    ds_read_b64_tr_b16 a[120:121], v24 offset:8224
    ds_read_b64_tr_b16 a[122:123], v24 offset:8352
    ds_read_b64_tr_b16 a[124:125], v24 offset:8736
    ds_read_b64_tr_b16 a[126:127], v24 offset:8864
    s_waitcnt lgkmcnt(0)
    s_add_u32 m0, s62, 24576
    s_mov_b32 s67, 3145728
    buffer_load_dwordx4 v20, s[44:47], s67 offen lds
    s_add_u32 m0, s62, 25600
    s_mov_b32 s67, 3276800
    buffer_load_dwordx4 v20, s[44:47], s67 offen lds
    s_add_u32 m0, s62, 26624
    s_mov_b32 s67, 3407872
    buffer_load_dwordx4 v20, s[44:47], s67 offen lds
    s_add_u32 m0, s62, 27648
    s_mov_b32 s67, 3538944
    buffer_load_dwordx4 v20, s[44:47], s67 offen lds
    s_waitcnt vmcnt(12)
    ds_read_b64_tr_b16 a[128:129], v24 offset:12288
    ds_read_b64_tr_b16 a[130:131], v24 offset:12416
    ds_read_b64_tr_b16 a[132:133], v24 offset:12800
    ds_read_b64_tr_b16 a[134:135], v24 offset:12928
    ds_read_b64_tr_b16 a[136:137], v24 offset:12320
    ds_read_b64_tr_b16 a[138:139], v24 offset:12448
    ds_read_b64_tr_b16 a[140:141], v24 offset:12832
    ds_read_b64_tr_b16 a[142:143], v24 offset:12960
    s_waitcnt lgkmcnt(0)
    s_add_u32 m0, s61, 0
    s_mov_b32 s67, 3670016
    buffer_load_dwordx4 v20, s[44:47], s67 offen lds
    s_add_u32 m0, s61, 1024
    s_mov_b32 s67, 3801088
    buffer_load_dwordx4 v20, s[44:47], s67 offen lds
    s_add_u32 m0, s61, 2048
    s_mov_b32 s67, 3932160
    buffer_load_dwordx4 v20, s[44:47], s67 offen lds
    s_add_u32 m0, s61, 3072
    s_mov_b32 s67, 4063232
    buffer_load_dwordx4 v20, s[44:47], s67 offen lds
    s_waitcnt vmcnt(12)
    ds_read_b64_tr_b16 a[144:145], v24 offset:16384
    ds_read_b64_tr_b16 a[146:147], v24 offset:16512
    ds_read_b64_tr_b16 a[148:149], v24 offset:16896
    ds_read_b64_tr_b16 a[150:151], v24 offset:17024
    ds_read_b64_tr_b16 a[152:153], v24 offset:16416
    ds_read_b64_tr_b16 a[154:155], v24 offset:16544
    ds_read_b64_tr_b16 a[156:157], v24 offset:16928
    ds_read_b64_tr_b16 a[158:159], v24 offset:17056
    s_waitcnt lgkmcnt(0)
    s_add_u32 m0, s61, 4096
    s_mov_b32 s67, 0
    buffer_load_dwordx4 v20, s[84:87], s67 offen lds
    s_add_u32 m0, s61, 5120
    s_mov_b32 s67, 131072
    buffer_load_dwordx4 v20, s[84:87], s67 offen lds
    s_add_u32 m0, s61, 6144
    s_mov_b32 s67, 262144
    buffer_load_dwordx4 v20, s[84:87], s67 offen lds
    s_add_u32 m0, s61, 7168
    s_mov_b32 s67, 393216
    buffer_load_dwordx4 v20, s[84:87], s67 offen lds
    s_waitcnt vmcnt(12)
    ds_read_b64_tr_b16 a[160:161], v24 offset:20480
    ds_read_b64_tr_b16 a[162:163], v24 offset:20608
    ds_read_b64_tr_b16 a[164:165], v24 offset:20992
    ds_read_b64_tr_b16 a[166:167], v24 offset:21120
    ds_read_b64_tr_b16 a[168:169], v24 offset:20512
    ds_read_b64_tr_b16 a[170:171], v24 offset:20640
    ds_read_b64_tr_b16 a[172:173], v24 offset:21024
    ds_read_b64_tr_b16 a[174:175], v24 offset:21152
    s_waitcnt lgkmcnt(0)
    s_add_u32 m0, s61, 8192
    s_mov_b32 s67, 524288
    buffer_load_dwordx4 v20, s[84:87], s67 offen lds
    s_add_u32 m0, s61, 9216
    s_mov_b32 s67, 655360
    buffer_load_dwordx4 v20, s[84:87], s67 offen lds
    s_add_u32 m0, s61, 10240
    s_mov_b32 s67, 786432
    buffer_load_dwordx4 v20, s[84:87], s67 offen lds
    s_add_u32 m0, s61, 11264
    s_mov_b32 s67, 917504
    buffer_load_dwordx4 v20, s[84:87], s67 offen lds
    s_waitcnt vmcnt(12)
    ds_read_b64_tr_b16 a[176:177], v24 offset:24576
    ds_read_b64_tr_b16 a[178:179], v24 offset:24704
    ds_read_b64_tr_b16 a[180:181], v24 offset:25088
    ds_read_b64_tr_b16 a[182:183], v24 offset:25216
    ds_read_b64_tr_b16 a[184:185], v24 offset:24608
    ds_read_b64_tr_b16 a[186:187], v24 offset:24736
    ds_read_b64_tr_b16 a[188:189], v24 offset:25120
    ds_read_b64_tr_b16 a[190:191], v24 offset:25248
    s_waitcnt lgkmcnt(0)
    s_add_u32 m0, s62, 0
    s_mov_b32 s67, 1048576
    buffer_load_dwordx4 v20, s[84:87], s67 offen lds
    s_add_u32 m0, s62, 1024
    s_mov_b32 s67, 1179648
    buffer_load_dwordx4 v20, s[84:87], s67 offen lds
    s_add_u32 m0, s62, 2048
    s_mov_b32 s67, 1310720
    buffer_load_dwordx4 v20, s[84:87], s67 offen lds
    s_add_u32 m0, s62, 3072
    s_mov_b32 s67, 1441792
    buffer_load_dwordx4 v20, s[84:87], s67 offen lds
    s_waitcnt vmcnt(12)
    ds_read_b64_tr_b16 a[192:193], v25 offset:0
    ds_read_b64_tr_b16 a[194:195], v25 offset:128
    ds_read_b64_tr_b16 a[196:197], v25 offset:512
    ds_read_b64_tr_b16 a[198:199], v25 offset:640
    ds_read_b64_tr_b16 a[200:201], v25 offset:32
    ds_read_b64_tr_b16 a[202:203], v25 offset:160
    ds_read_b64_tr_b16 a[204:205], v25 offset:544
    ds_read_b64_tr_b16 a[206:207], v25 offset:672
    s_waitcnt lgkmcnt(0)
    s_add_u32 m0, s62, 4096
    s_mov_b32 s67, 1572864
    buffer_load_dwordx4 v20, s[84:87], s67 offen lds
    s_add_u32 m0, s62, 5120
    s_mov_b32 s67, 1703936
    buffer_load_dwordx4 v20, s[84:87], s67 offen lds
    s_add_u32 m0, s62, 6144
    s_mov_b32 s67, 1835008
    buffer_load_dwordx4 v20, s[84:87], s67 offen lds
    s_add_u32 m0, s62, 7168
    s_mov_b32 s67, 1966080
    buffer_load_dwordx4 v20, s[84:87], s67 offen lds
    s_waitcnt vmcnt(12)
    ds_read_b64_tr_b16 a[208:209], v25 offset:4096
    ds_read_b64_tr_b16 a[210:211], v25 offset:4224
    ds_read_b64_tr_b16 a[212:213], v25 offset:4608
    ds_read_b64_tr_b16 a[214:215], v25 offset:4736
    ds_read_b64_tr_b16 a[216:217], v25 offset:4128
    ds_read_b64_tr_b16 a[218:219], v25 offset:4256
    ds_read_b64_tr_b16 a[220:221], v25 offset:4640
    ds_read_b64_tr_b16 a[222:223], v25 offset:4768
    s_waitcnt lgkmcnt(0)
    s_add_u32 m0, s62, 8192
    s_mov_b32 s67, 2097152
    buffer_load_dwordx4 v20, s[84:87], s67 offen lds
    s_add_u32 m0, s62, 9216
    s_mov_b32 s67, 2228224
    buffer_load_dwordx4 v20, s[84:87], s67 offen lds
    s_add_u32 m0, s62, 10240
    s_mov_b32 s67, 2359296
    buffer_load_dwordx4 v20, s[84:87], s67 offen lds
    s_add_u32 m0, s62, 11264
    s_mov_b32 s67, 2490368
    buffer_load_dwordx4 v20, s[84:87], s67 offen lds
    s_waitcnt vmcnt(12)
    ds_read_b64_tr_b16 a[224:225], v25 offset:8192
    ds_read_b64_tr_b16 a[226:227], v25 offset:8320
    ds_read_b64_tr_b16 a[228:229], v25 offset:8704
    ds_read_b64_tr_b16 a[230:231], v25 offset:8832
    ds_read_b64_tr_b16 a[232:233], v25 offset:8224
    ds_read_b64_tr_b16 a[234:235], v25 offset:8352
    ds_read_b64_tr_b16 a[236:237], v25 offset:8736
    ds_read_b64_tr_b16 a[238:239], v25 offset:8864
    s_waitcnt lgkmcnt(0)
    s_add_u32 m0, s62, 12288
    s_mov_b32 s67, 2621440
    buffer_load_dwordx4 v20, s[84:87], s67 offen lds
    s_add_u32 m0, s62, 13312
    s_mov_b32 s67, 2752512
    buffer_load_dwordx4 v20, s[84:87], s67 offen lds
    s_add_u32 m0, s62, 14336
    s_mov_b32 s67, 2883584
    buffer_load_dwordx4 v20, s[84:87], s67 offen lds
    s_add_u32 m0, s62, 15360
    s_mov_b32 s67, 3014656
    buffer_load_dwordx4 v20, s[84:87], s67 offen lds
    s_waitcnt vmcnt(12)
    ds_read_b64_tr_b16 a[240:241], v24 offset:0
    ds_read_b64_tr_b16 a[242:243], v24 offset:128
    ds_read_b64_tr_b16 a[244:245], v24 offset:512
    ds_read_b64_tr_b16 a[246:247], v24 offset:640
    ds_read_b64_tr_b16 a[248:249], v24 offset:32
    ds_read_b64_tr_b16 a[250:251], v24 offset:160
    ds_read_b64_tr_b16 a[252:253], v24 offset:544
    ds_read_b64_tr_b16 a[254:255], v24 offset:672
    s_waitcnt lgkmcnt(0)
    s_add_u32 m0, s62, 16384
    s_mov_b32 s67, 3145728
    buffer_load_dwordx4 v20, s[84:87], s67 offen lds
    s_add_u32 m0, s62, 17408
    s_mov_b32 s67, 3276800
    buffer_load_dwordx4 v20, s[84:87], s67 offen lds
    s_add_u32 m0, s62, 18432
    s_mov_b32 s67, 3407872
    buffer_load_dwordx4 v20, s[84:87], s67 offen lds
    s_add_u32 m0, s62, 19456
    s_mov_b32 s67, 3538944
    buffer_load_dwordx4 v20, s[84:87], s67 offen lds
    s_waitcnt vmcnt(12)
    ds_read_b64_tr_b16 v[112:113], v24 offset:4096
    ds_read_b64_tr_b16 v[114:115], v24 offset:4224
    ds_read_b64_tr_b16 v[116:117], v24 offset:4608
    ds_read_b64_tr_b16 v[118:119], v24 offset:4736
    ds_read_b64_tr_b16 v[120:121], v24 offset:4128
    ds_read_b64_tr_b16 v[122:123], v24 offset:4256
    ds_read_b64_tr_b16 v[124:125], v24 offset:4640
    ds_read_b64_tr_b16 v[126:127], v24 offset:4768
    s_waitcnt lgkmcnt(0)
    s_add_u32 m0, s62, 20480
    s_mov_b32 s67, 3670016
    buffer_load_dwordx4 v20, s[84:87], s67 offen lds
    s_add_u32 m0, s62, 21504
    s_mov_b32 s67, 3801088
    buffer_load_dwordx4 v20, s[84:87], s67 offen lds
    s_add_u32 m0, s62, 22528
    s_mov_b32 s67, 3932160
    buffer_load_dwordx4 v20, s[84:87], s67 offen lds
    s_add_u32 m0, s62, 23552
    s_mov_b32 s67, 4063232
    buffer_load_dwordx4 v20, s[84:87], s67 offen lds
    global_load_dword v64, v65, s[32:33] sc1
    s_waitcnt vmcnt(13)
    ds_read_b64_tr_b16 v[128:129], v24 offset:8192
    ds_read_b64_tr_b16 v[130:131], v24 offset:8320
    ds_read_b64_tr_b16 v[132:133], v24 offset:8704
    ds_read_b64_tr_b16 v[134:135], v24 offset:8832
    ds_read_b64_tr_b16 v[136:137], v24 offset:8224
    ds_read_b64_tr_b16 v[138:139], v24 offset:8352
    ds_read_b64_tr_b16 v[140:141], v24 offset:8736
    ds_read_b64_tr_b16 v[142:143], v24 offset:8864
    s_waitcnt lgkmcnt(0)
    s_add_u32 m0, s62, 24576
    s_mov_b32 s67, 0
    buffer_load_dwordx4 v21, s[88:91], s67 offen lds
    s_add_u32 m0, s62, 25600
    s_mov_b32 s67, 16384
    buffer_load_dwordx4 v21, s[88:91], s67 offen lds
    s_add_u32 m0, s62, 26624
    s_mov_b32 s67, 32768
    buffer_load_dwordx4 v21, s[88:91], s67 offen lds
    s_add_u32 m0, s62, 27648
    s_mov_b32 s67, 49152
    buffer_load_dwordx4 v21, s[88:91], s67 offen lds
    s_waitcnt vmcnt(13)
    ds_read_b64_tr_b16 v[144:145], v24 offset:12288
    ds_read_b64_tr_b16 v[146:147], v24 offset:12416
    ds_read_b64_tr_b16 v[148:149], v24 offset:12800
    ds_read_b64_tr_b16 v[150:151], v24 offset:12928
    ds_read_b64_tr_b16 v[152:153], v24 offset:12320
    ds_read_b64_tr_b16 v[154:155], v24 offset:12448
    ds_read_b64_tr_b16 v[156:157], v24 offset:12832
    ds_read_b64_tr_b16 v[158:159], v24 offset:12960
    s_waitcnt lgkmcnt(0)
    s_add_u32 m0, s61, 0
    s_mov_b32 s67, 64
    buffer_load_dwordx4 v21, s[88:91], s67 offen lds
    s_add_u32 m0, s61, 1024
    s_mov_b32 s67, 16448
    buffer_load_dwordx4 v21, s[88:91], s67 offen lds
    s_add_u32 m0, s61, 2048
    s_mov_b32 s67, 32832
    buffer_load_dwordx4 v21, s[88:91], s67 offen lds
    s_add_u32 m0, s61, 3072
    s_mov_b32 s67, 49216
    buffer_load_dwordx4 v21, s[88:91], s67 offen lds
    s_waitcnt vmcnt(13)
    ds_read_b64_tr_b16 v[160:161], v24 offset:16384
    ds_read_b64_tr_b16 v[162:163], v24 offset:16512
    ds_read_b64_tr_b16 v[164:165], v24 offset:16896
    ds_read_b64_tr_b16 v[166:167], v24 offset:17024
    ds_read_b64_tr_b16 v[168:169], v24 offset:16416
    ds_read_b64_tr_b16 v[170:171], v24 offset:16544
    ds_read_b64_tr_b16 v[172:173], v24 offset:16928
    ds_read_b64_tr_b16 v[174:175], v24 offset:17056
    s_waitcnt lgkmcnt(0)
    s_add_u32 m0, s61, 4096
    s_mov_b32 s67, 128
    buffer_load_dwordx4 v21, s[88:91], s67 offen lds
    s_add_u32 m0, s61, 5120
    s_mov_b32 s67, 16512
    buffer_load_dwordx4 v21, s[88:91], s67 offen lds
    s_add_u32 m0, s61, 6144
    s_mov_b32 s67, 32896
    buffer_load_dwordx4 v21, s[88:91], s67 offen lds
    s_add_u32 m0, s61, 7168
    s_mov_b32 s67, 49280
    buffer_load_dwordx4 v21, s[88:91], s67 offen lds
    s_waitcnt vmcnt(13)
    ds_read_b64_tr_b16 v[176:177], v24 offset:20480
    ds_read_b64_tr_b16 v[178:179], v24 offset:20608
    ds_read_b64_tr_b16 v[180:181], v24 offset:20992
    ds_read_b64_tr_b16 v[182:183], v24 offset:21120
    ds_read_b64_tr_b16 v[184:185], v24 offset:20512
    ds_read_b64_tr_b16 v[186:187], v24 offset:20640
    ds_read_b64_tr_b16 v[188:189], v24 offset:21024
    ds_read_b64_tr_b16 v[190:191], v24 offset:21152
    s_waitcnt lgkmcnt(0)
    s_add_u32 m0, s61, 8192
    s_mov_b32 s67, 192
    buffer_load_dwordx4 v21, s[88:91], s67 offen lds
    s_add_u32 m0, s61, 9216
    s_mov_b32 s67, 16576
    buffer_load_dwordx4 v21, s[88:91], s67 offen lds
    s_add_u32 m0, s61, 10240
    s_mov_b32 s67, 32960
    buffer_load_dwordx4 v21, s[88:91], s67 offen lds
    s_add_u32 m0, s61, 11264
    s_mov_b32 s67, 49344
    buffer_load_dwordx4 v21, s[88:91], s67 offen lds
    s_waitcnt vmcnt(12)
    ds_read_b64_tr_b16 v[192:193], v24 offset:24576
    ds_read_b64_tr_b16 v[194:195], v24 offset:24704
    ds_read_b64_tr_b16 v[196:197], v24 offset:25088
    ds_read_b64_tr_b16 v[198:199], v24 offset:25216
    ds_read_b64_tr_b16 v[200:201], v24 offset:24608
    ds_read_b64_tr_b16 v[202:203], v24 offset:24736
    ds_read_b64_tr_b16 v[204:205], v24 offset:25120
    ds_read_b64_tr_b16 v[206:207], v24 offset:25248
    s_waitcnt lgkmcnt(0)
    s_add_u32 m0, s62, 0
    s_mov_b32 s67, 0
    buffer_load_dwordx4 v20, s[40:43], s67 offen lds
    s_add_u32 m0, s62, 1024
    s_mov_b32 s67, 131072
    buffer_load_dwordx4 v20, s[40:43], s67 offen lds
    s_add_u32 m0, s62, 2048
    s_mov_b32 s67, 262144
    buffer_load_dwordx4 v20, s[40:43], s67 offen lds
    s_add_u32 m0, s62, 3072
    s_mov_b32 s67, 393216
    buffer_load_dwordx4 v20, s[40:43], s67 offen lds
    s_waitcnt vmcnt(12)
    ds_read_b64_tr_b16 v[208:209], v25 offset:0
    ds_read_b64_tr_b16 v[210:211], v25 offset:128
    ds_read_b64_tr_b16 v[212:213], v25 offset:512
    ds_read_b64_tr_b16 v[214:215], v25 offset:640
    ds_read_b64_tr_b16 v[216:217], v25 offset:32
    ds_read_b64_tr_b16 v[218:219], v25 offset:160
    ds_read_b64_tr_b16 v[220:221], v25 offset:544
    ds_read_b64_tr_b16 v[222:223], v25 offset:672
    s_waitcnt lgkmcnt(0)
    s_add_u32 m0, s62, 4096
    s_mov_b32 s67, 524288
    buffer_load_dwordx4 v20, s[40:43], s67 offen lds
    s_add_u32 m0, s62, 5120
    s_mov_b32 s67, 655360
    buffer_load_dwordx4 v20, s[40:43], s67 offen lds
    s_add_u32 m0, s62, 6144
    s_mov_b32 s67, 786432
    buffer_load_dwordx4 v20, s[40:43], s67 offen lds
    s_add_u32 m0, s62, 7168
    s_mov_b32 s67, 917504
    buffer_load_dwordx4 v20, s[40:43], s67 offen lds
    s_waitcnt vmcnt(12)
    ds_read_b64_tr_b16 v[224:225], v25 offset:4096
    ds_read_b64_tr_b16 v[226:227], v25 offset:4224
    ds_read_b64_tr_b16 v[228:229], v25 offset:4608
    ds_read_b64_tr_b16 v[230:231], v25 offset:4736
    ds_read_b64_tr_b16 v[232:233], v25 offset:4128
    ds_read_b64_tr_b16 v[234:235], v25 offset:4256
    ds_read_b64_tr_b16 v[236:237], v25 offset:4640
    ds_read_b64_tr_b16 v[238:239], v25 offset:4768
    s_waitcnt lgkmcnt(0)
    s_add_u32 m0, s62, 8192
    s_mov_b32 s67, 1048576
    buffer_load_dwordx4 v20, s[40:43], s67 offen lds
    s_add_u32 m0, s62, 9216
    s_mov_b32 s67, 1179648
    buffer_load_dwordx4 v20, s[40:43], s67 offen lds
    s_add_u32 m0, s62, 10240
    s_mov_b32 s67, 1310720
    buffer_load_dwordx4 v20, s[40:43], s67 offen lds
    s_add_u32 m0, s62, 11264
    s_mov_b32 s67, 1441792
    buffer_load_dwordx4 v20, s[40:43], s67 offen lds
    v_readlane_b32 s67, v64, 18
    v_readlane_b32 s82, v64, 0
    v_mov_b32 v66, 0
    s_cmp_ge_u32 s67, 60
    s_cselect_b32 s82, s82, 0
    s_cselect_b64 exec, -1, 0
    s_lshl_b32 s67, s51, 8
    buffer_load_dword v66, v65, s[36:39], s67 offen sc1
    s_mov_b64 exec, -1
    s_waitcnt vmcnt(13)
    ds_read_b64_tr_b16 v[240:241], v25 offset:8192
    ds_read_b64_tr_b16 v[242:243], v25 offset:8320
    ds_read_b64_tr_b16 v[244:245], v25 offset:8704
    ds_read_b64_tr_b16 v[246:247], v25 offset:8832
    ds_read_b64_tr_b16 v[248:249], v25 offset:8224
    ds_read_b64_tr_b16 v[250:251], v25 offset:8352
    ds_read_b64_tr_b16 v[252:253], v25 offset:8736
    ds_read_b64_tr_b16 v[254:255], v25 offset:8864
    s_waitcnt lgkmcnt(0)
    s_add_u32 m0, s62, 12288
    s_mov_b32 s67, 65536
    buffer_load_dwordx4 v21, s[88:91], s67 offen lds
    s_add_u32 m0, s62, 13312
    s_mov_b32 s67, 81920
    buffer_load_dwordx4 v21, s[88:91], s67 offen lds
    s_add_u32 m0, s62, 14336
    s_mov_b32 s67, 98304
    buffer_load_dwordx4 v21, s[88:91], s67 offen lds
    s_add_u32 m0, s62, 15360
    s_mov_b32 s67, 114688
    buffer_load_dwordx4 v21, s[88:91], s67 offen lds
    s_waitcnt vmcnt(13)
    ds_read_b64_tr_b16 v[32:33], v24 offset:0
    ds_read_b64_tr_b16 v[34:35], v24 offset:128
    ds_read_b64_tr_b16 v[36:37], v24 offset:512
    ds_read_b64_tr_b16 v[38:39], v24 offset:640
    ds_read_b64_tr_b16 v[40:41], v24 offset:32
    ds_read_b64_tr_b16 v[42:43], v24 offset:160
    ds_read_b64_tr_b16 v[44:45], v24 offset:544
    ds_read_b64_tr_b16 v[46:47], v24 offset:672
    s_waitcnt lgkmcnt(0)
    ds_write_b128 v7, v[32:35] offset:0
    ds_write_b128 v7, v[36:39] offset:1024
    ds_write_b128 v7, v[40:43] offset:2048
    ds_write_b128 v7, v[44:47] offset:3072
    s_waitcnt lgkmcnt(0)
    s_add_u32 m0, s62, 16384
    s_mov_b32 s67, 65600
    buffer_load_dwordx4 v21, s[88:91], s67 offen lds
    s_add_u32 m0, s62, 17408
    s_mov_b32 s67, 81984
    buffer_load_dwordx4 v21, s[88:91], s67 offen lds
    s_add_u32 m0, s62, 18432
    s_mov_b32 s67, 98368
    buffer_load_dwordx4 v21, s[88:91], s67 offen lds
    s_add_u32 m0, s62, 19456
    s_mov_b32 s67, 114752
    buffer_load_dwordx4 v21, s[88:91], s67 offen lds
    s_waitcnt vmcnt(13)
    ds_read_b64_tr_b16 v[32:33], v24 offset:4096
    ds_read_b64_tr_b16 v[34:35], v24 offset:4224
    ds_read_b64_tr_b16 v[36:37], v24 offset:4608
    ds_read_b64_tr_b16 v[38:39], v24 offset:4736
    ds_read_b64_tr_b16 v[40:41], v24 offset:4128
    ds_read_b64_tr_b16 v[42:43], v24 offset:4256
    ds_read_b64_tr_b16 v[44:45], v24 offset:4640
    ds_read_b64_tr_b16 v[46:47], v24 offset:4768
    s_waitcnt lgkmcnt(0)
    ds_write_b128 v7, v[32:35] offset:4096
    ds_write_b128 v7, v[36:39] offset:5120
    ds_write_b128 v7, v[40:43] offset:6144
    ds_write_b128 v7, v[44:47] offset:7168
    s_waitcnt lgkmcnt(0)
    s_add_u32 m0, s62, 20480
    s_mov_b32 s67, 65664
    buffer_load_dwordx4 v21, s[88:91], s67 offen lds
    s_add_u32 m0, s62, 21504
    s_mov_b32 s67, 82048
    buffer_load_dwordx4 v21, s[88:91], s67 offen lds
    s_add_u32 m0, s62, 22528
    s_mov_b32 s67, 98432
    buffer_load_dwordx4 v21, s[88:91], s67 offen lds
    s_add_u32 m0, s62, 23552
    s_mov_b32 s67, 114816
    buffer_load_dwordx4 v21, s[88:91], s67 offen lds
    s_waitcnt vmcnt(13)
    ds_read_b64_tr_b16 v[32:33], v24 offset:8192
    ds_read_b64_tr_b16 v[34:35], v24 offset:8320
    ds_read_b64_tr_b16 v[36:37], v24 offset:8704
    ds_read_b64_tr_b16 v[38:39], v24 offset:8832
    ds_read_b64_tr_b16 v[40:41], v24 offset:8224
    ds_read_b64_tr_b16 v[42:43], v24 offset:8352
    ds_read_b64_tr_b16 v[44:45], v24 offset:8736
    ds_read_b64_tr_b16 v[46:47], v24 offset:8864
    s_waitcnt lgkmcnt(0)
    ds_write_b128 v7, v[32:35] offset:8192
    ds_write_b128 v7, v[36:39] offset:9216
    ds_write_b128 v7, v[40:43] offset:10240
    ds_write_b128 v7, v[44:47] offset:11264
    s_waitcnt lgkmcnt(0)
    s_add_u32 m0, s62, 24576
    s_mov_b32 s67, 65728
    buffer_load_dwordx4 v21, s[88:91], s67 offen lds
    s_add_u32 m0, s62, 25600
    s_mov_b32 s67, 82112
    buffer_load_dwordx4 v21, s[88:91], s67 offen lds
    s_add_u32 m0, s62, 26624
    s_mov_b32 s67, 98496
    buffer_load_dwordx4 v21, s[88:91], s67 offen lds
    s_add_u32 m0, s62, 27648
    s_mov_b32 s67, 114880
    buffer_load_dwordx4 v21, s[88:91], s67 offen lds
    s_waitcnt vmcnt(12)
    ds_read_b64_tr_b16 v[32:33], v24 offset:12288
    ds_read_b64_tr_b16 v[34:35], v24 offset:12416
    ds_read_b64_tr_b16 v[36:37], v24 offset:12800
    ds_read_b64_tr_b16 v[38:39], v24 offset:12928
    ds_read_b64_tr_b16 v[40:41], v24 offset:12320
    ds_read_b64_tr_b16 v[42:43], v24 offset:12448
    ds_read_b64_tr_b16 v[44:45], v24 offset:12832
    ds_read_b64_tr_b16 v[46:47], v24 offset:12960
    s_waitcnt lgkmcnt(0)
    ds_write_b128 v7, v[32:35] offset:12288
    ds_write_b128 v7, v[36:39] offset:13312
    ds_write_b128 v7, v[40:43] offset:14336
    ds_write_b128 v7, v[44:47] offset:15360
    s_waitcnt lgkmcnt(0)
    s_barrier
    v_cmp_eq_u32 vcc, 0, v66
    s_ff1_i32_b64 s64, vcc
    s_lshl_b32 s67, s51, 14
    s_add_u32 s96, s67, 16629760
    s_lshl_b32 s67, s48, 11
    s_add_u32 s97, s67, 114688
    s_cmp_gt_u32 s64, 0
    s_cselect_b64 exec, -1, 0
    s_add_u32 m0, s97, 0
    s_add_u32 s67, s96, 0
    buffer_load_dwordx4 v3, s[36:39], s67 offen offset:0 sc1 lds
    s_add_u32 m0, s97, 0
    s_add_u32 s67, s96, 0
    buffer_load_dwordx4 v3, s[36:39], s67 offen offset:1024 sc1 lds
    s_add_u32 m0, s97, 8192
    s_add_u32 s67, s96, 8192
    buffer_load_dwordx4 v3, s[36:39], s67 offen offset:0 sc1 lds
    s_add_u32 m0, s97, 8192
    s_add_u32 s67, s96, 8192
    buffer_load_dwordx4 v3, s[36:39], s67 offen offset:1024 sc1 lds
    s_mov_b64 exec, -1
    v_lshl_or_b32 v48, v56, 16, v48
    v_lshl_or_b32 v49, v57, 16, v49
    v_lshl_or_b32 v50, v58, 16, v50
    v_lshl_or_b32 v51, v59, 16, v51
    v_lshl_or_b32 v52, v60, 16, v52
    v_lshl_or_b32 v53, v61, 16, v53
    v_lshl_or_b32 v54, v62, 16, v54
    v_lshl_or_b32 v55, v63, 16, v55
    s_lshl_b32 s67, s48, 9
    s_add_u32 s67, s67, 8192
    v_subrev_u32 v27, s67, v6
    ds_write_b64 v27, v[48:49] offset:0
    ds_write_b64 v27, v[50:51] offset:2048
    ds_write_b64 v27, v[52:53] offset:4096
    ds_write_b64 v27, v[54:55] offset:6144
    s_waitcnt lgkmcnt(0)
    ds_read_b128 v[48:51], v7 offset:0
    ds_read_b128 v[52:55], v7 offset:1024
    ds_read_b128 v[56:59], v7 offset:2048
    ds_read_b128 v[60:63], v7 offset:3072
    ds_read_b128 v[64:67], v7 offset:4096
    ds_read_b128 v[68:71], v7 offset:5120
    ds_read_b128 v[72:75], v7 offset:6144
    ds_read_b128 v[76:79], v7 offset:7168
    ds_read_b128 v[80:83], v7 offset:8192
    ds_read_b128 v[84:87], v7 offset:9216
    v_mov_b64 v[96:97], 0
    v_mov_b64 v[98:99], 0
    v_mov_b64 v[100:101], 0
    v_mov_b64 v[102:103], 0
    v_mov_b64 v[104:105], 0
    v_mov_b64 v[106:107], 0
    v_mov_b64 v[108:109], 0
    v_mov_b64 v[110:111], 0
    v_mov_b32 v0, v29
    s_lshl_b32 s67, s51, 13
    s_add_u32 s53, s67, 1048576
    s_add_u32 s54, s53, 4096
    s_mov_b32 s55, 1048576
    s_mov_b32 s56, 1114112
    s_mov_b32 s4, 1179648
    s_mov_b32 s5, 1245184
    s_mov_b32 s66, 0
    s_mov_b32 s57, 262144
    s_mov_b32 s83, 0
    s_lshl_b32 s67, s51, 12
    s_add_u32 s63, s67, 50462720
    s_mov_b32 s8, 0x3f003f00
    s_mov_b32 s9, 0x3f803f80
    s_lshl_b32 s81, s51, 7
    s_add_u32 s81, s81, 16384
    s_mov_b32 s80, 0x3e0293ee
    s_lshl_b32 s58, s51, 8
    s_add_u32 s58, s58, 4
    s_waitcnt vmcnt(12)
    ds_read_b64_tr_b16 v[32:33], v24 offset:16384
    ds_read_b64_tr_b16 v[34:35], v24 offset:16512
    ds_read_b64_tr_b16 v[36:37], v24 offset:16896
    ds_read_b64_tr_b16 v[38:39], v24 offset:17024
    ds_read_b64_tr_b16 v[40:41], v24 offset:16416
    ds_read_b64_tr_b16 v[42:43], v24 offset:16544
    ds_read_b64_tr_b16 v[44:45], v24 offset:16928
    ds_read_b64_tr_b16 v[46:47], v24 offset:17056
    s_waitcnt lgkmcnt(0)
    ds_write_b128 v7, v[32:35] offset:16384
    ds_write_b128 v7, v[36:39] offset:17408
    ds_write_b128 v7, v[40:43] offset:18432
    ds_write_b128 v7, v[44:47] offset:19456
    s_waitcnt lgkmcnt(0)
    s_min_u32 s67, s52, 59
    s_lshl_b32 s67, s67, 2
    s_add_u32 s67, s67, s58
    s_load_dwordx4 s[12:15], s[34:35], s67 glc
    s_mov_b32 s67, 114688
    buffer_load_dwordx4 v[88:91], v3, s[36:39], s67 offen offset:0 sc1
    buffer_load_dwordx4 v[88:91], v3, s[36:39], s67 offen offset:1024 sc1
    s_mov_b32 s67, 122880
    buffer_load_dwordx4 v[88:91], v3, s[36:39], s67 offen offset:0 sc1
    buffer_load_dwordx4 v[88:91], v3, s[36:39], s67 offen offset:1024 sc1
    s_mov_b32 s67, 131072
    buffer_load_dwordx4 v[88:91], v3, s[36:39], s67 offen offset:0 sc1
    buffer_load_dwordx4 v[88:91], v3, s[36:39], s67 offen offset:1024 sc1
    buffer_load_dwordx4 v[88:91], v1, s[36:39], s55 offen sc1
    buffer_load_dwordx4 v[88:91], v1, s[36:39], s56 offen sc1
    buffer_load_dwordx4 v[88:91], v1, s[36:39], s4 offen sc1
    buffer_load_dwordx4 v[88:91], v1, s[36:39], s5 offen sc1
    s_waitcnt vmcnt(18)
    ds_read_b64_tr_b16 v[32:33], v24 offset:20480
    ds_read_b64_tr_b16 v[34:35], v24 offset:20608
    ds_read_b64_tr_b16 v[36:37], v24 offset:20992
    ds_read_b64_tr_b16 v[38:39], v24 offset:21120
    ds_read_b64_tr_b16 v[40:41], v24 offset:20512
    ds_read_b64_tr_b16 v[42:43], v24 offset:20640
    ds_read_b64_tr_b16 v[44:45], v24 offset:21024
    ds_read_b64_tr_b16 v[46:47], v24 offset:21152
    s_waitcnt lgkmcnt(0)
    ds_write_b128 v7, v[32:35] offset:20480
    ds_write_b128 v7, v[36:39] offset:21504
    ds_write_b128 v7, v[40:43] offset:22528
    ds_write_b128 v7, v[44:47] offset:23552
    s_waitcnt lgkmcnt(0)
    s_waitcnt vmcnt(14)
    ds_read_b64_tr_b16 v[32:33], v24 offset:24576
    ds_read_b64_tr_b16 v[34:35], v24 offset:24704
    ds_read_b64_tr_b16 v[36:37], v24 offset:25088
    ds_read_b64_tr_b16 v[38:39], v24 offset:25216
    ds_read_b64_tr_b16 v[40:41], v24 offset:24608
    ds_read_b64_tr_b16 v[42:43], v24 offset:24736
    ds_read_b64_tr_b16 v[44:45], v24 offset:25120
    ds_read_b64_tr_b16 v[46:47], v24 offset:25248
    s_waitcnt lgkmcnt(0)
    ds_write_b128 v7, v[32:35] offset:24576
    ds_write_b128 v7, v[36:39] offset:25600
    ds_write_b128 v7, v[40:43] offset:26624
    ds_write_b128 v7, v[44:47] offset:27648
    s_waitcnt lgkmcnt(0)
    s_cmp_ge_u32 s82, 32
    s_cselect_b32 s12, s12, 0
    s_mov_b32 s61, s96
    s_mov_b32 s62, s97
    s_cmp_ge_u32 s82, 32
    s_cbranch_scc1 MODE_D
    v_mbcnt_lo_u32_b32 v33, -1, 0
    v_mbcnt_hi_u32_b32 v33, -1, v33
    v_lshlrev_b32 v33, 2, v33
WI_1:
    global_load_dword v32, v33, s[32:33] sc1
    s_add_u32 s65, s65, 1
    s_waitcnt vmcnt(0)
    v_readlane_b32 s67, v32, 18
    s_cmp_ge_u32 s67, 60
    s_cbranch_scc1 WID_2
    s_sleep 16
    s_cmp_lt_u32 s65, 262144
    s_cbranch_scc1 WI_1
WID_2:
MODE_L:
    v_readlane_b32 s82, v32, 0
    s_cmp_ge_u32 s82, 32
    s_cbranch_scc1 MODE_D
    s_mov_b32 s68, 0
    v_readlane_b32 s67, v32, 0
    s_add_u32 s68, s68, s67
    v_readlane_b32 s67, v32, 16
    s_add_u32 s68, s68, s67
    v_readlane_b32 s67, v32, 32
    s_add_u32 s68, s68, s67
    v_readlane_b32 s67, v32, 48
    s_add_u32 s68, s68, s67
    v_readlane_b32 s67, v32, 1
    s_add_u32 s68, s68, s67
    v_readlane_b32 s67, v32, 17
    s_add_u32 s68, s68, s67
    v_readlane_b32 s67, v32, 33
    s_add_u32 s68, s68, s67
    v_readlane_b32 s67, v32, 49
    s_add_u32 s68, s68, s67
    s_cmp_ge_u32 s68, 256
    s_cbranch_scc1 MODE_D
    s_sleep 16
    global_load_dword v32, v33, s[32:33] sc1
    s_add_u32 s65, s65, 1
    s_waitcnt vmcnt(0)
    s_cmp_lt_u32 s65, 262144
    s_cbranch_scc1 MODE_L
MODE_D:
    s_cmp_gt_u32 s64, 0
    s_cbranch_scc1 KV0_D
    s_add_u32 s68, s52, 0
    s_cmp_gt_u32 s64, s68
    s_cbranch_scc1 KRD_3
    s_waitcnt vmcnt(0)
    v_mbcnt_lo_u32_b32 v33, -1, 0
    v_mbcnt_hi_u32_b32 v33, -1, v33
    v_lshlrev_b32 v33, 2, v33
KR_4:
    s_lshl_b32 s67, s51, 8
    buffer_load_dword v32, v33, s[36:39], s67 offen sc1
    s_add_u32 s65, s65, 1
    s_waitcnt vmcnt(0)
    v_cmp_eq_u32 vcc, 0, v32
    s_ff1_i32_b64 s64, vcc
    s_cmp_gt_u32 s64, s68
    s_cbranch_scc1 KRD_3
    s_sleep 16
    s_cmp_lt_u32 s65, 262144
    s_cbranch_scc1 KR_4
    s_branch KRD_3
KRD_3:
    s_add_u32 m0, s62, 0
    s_add_u32 s67, s61, 0
    buffer_load_dwordx4 v3, s[36:39], s67 offen offset:0 sc1 lds
    s_add_u32 m0, s62, 0
    s_add_u32 s67, s61, 0
    buffer_load_dwordx4 v3, s[36:39], s67 offen offset:1024 sc1 lds
    s_add_u32 m0, s62, 8192
    s_add_u32 s67, s61, 8192
    buffer_load_dwordx4 v3, s[36:39], s67 offen offset:0 sc1 lds
    s_add_u32 m0, s62, 8192
    s_add_u32 s67, s61, 8192
    buffer_load_dwordx4 v3, s[36:39], s67 offen offset:1024 sc1 lds
KV0_D:
    s_add_u32 s61, s61, 0x80000
    s_xor_b32 s62, s62, 0x3C000
    s_cmp_ge_u32 s82, 32
    s_cbranch_scc0 CHAIN_SLOW
    s_waitcnt vmcnt(0) lgkmcnt(0)
    s_add_u32 s68, s52, 1
    s_cmp_gt_u32 s64, s68
    s_cbranch_scc1 KRD_5
    s_waitcnt vmcnt(0)
    v_mbcnt_lo_u32_b32 v38, -1, 0
    v_mbcnt_hi_u32_b32 v38, -1, v38
    v_lshlrev_b32 v38, 2, v38
KR_6:
    s_lshl_b32 s67, s51, 8
    buffer_load_dword v10, v38, s[36:39], s67 offen sc1
    s_add_u32 s65, s65, 1
    s_waitcnt vmcnt(0)
    v_cmp_eq_u32 vcc, 0, v10
    s_ff1_i32_b64 s64, vcc
    s_cmp_gt_u32 s64, s68
    s_cbranch_scc1 KRD_5
    s_sleep 16
    s_cmp_lt_u32 s65, 262144
    s_cbranch_scc1 KR_6
    s_branch KRD_5
KRD_5:
    s_add_u32 s10, s61, 8192
    s_mov_b32 m0, s62
    v_mov_b32 v10, 0
    v_mov_b32 v90, 0
    s_branch CHF_ENTRY
CHF_LOOP_0:
    v_mov_b64 v[36:37], -1
    v_xor_b32 v8, 0x3C000, v8
    v_xor_b32 v9, 0x3C000, v9
    v_add_u32 v2, 0x2000, v2
    v_subrev_u32 v10, 0x6000, v2
    v_min_u32 v2, v2, v10
    s_add_u32 s66, s66, 0x2000
    s_cmp_eq_u32 s66, 0x6000
    s_cselect_b32 s66, 0, s66
    s_add_u32 s59, s66, 114688
    s_add_u32 s61, s61, 0x80000
    s_xor_b32 s62, s62, 0x3C000
    s_add_u32 s63, s63, 0x20000
    s_add_u32 s10, s61, 8192
    s_mov_b32 m0, s62
    s_mov_b32 s11, s52
    s_min_u32 s67, s52, 59
    s_add_u32 s67, s67, 1
    s_add_u32 s67, s67, s12
    s_and_b32 s12, s12, s13
    s_add_u32 s67, s67, s12
    s_and_b32 s12, s12, s14
    s_add_u32 s67, s67, s12
    s_and_b32 s12, s12, s15
    s_add_u32 s67, s67, s12
    s_cmp_ge_u32 s67, 64
    s_cselect_b32 s67, -1, s67
    s_max_u32 s64, s64, s67
    s_add_u32 s52, s52, 1
    s_min_u32 s67, s52, 59
    s_lshl_b32 s67, s67, 2
    s_add_u32 s67, s67, s58
    s_load_dwordx4 s[12:15], s[34:35], s67 glc
    ds_read_b128 v[48:51], v7 offset:0
    ds_read_b128 v[52:55], v7 offset:1024
    ds_read_b128 v[56:59], v7 offset:2048
    ds_read_b128 v[60:63], v7 offset:3072
    ds_read_b128 v[64:67], v7 offset:4096
    ds_read_b128 v[68:71], v7 offset:5120
    ds_read_b128 v[72:75], v7 offset:6144
    ds_read_b128 v[76:79], v7 offset:7168
    ds_read_b128 v[80:83], v7 offset:8192
    ds_read_b128 v[84:87], v7 offset:9216
    buffer_load_dwordx4 v[16:19], v1, s[36:39], s55 offen sc1
    buffer_load_dwordx4 v[20:23], v1, s[36:39], s56 offen sc1
    buffer_load_dwordx4 v[24:27], v1, s[36:39], s4 offen sc1
    buffer_load_dwordx4 v[28:31], v1, s[36:39], s5 offen sc1
    s_waitcnt vmcnt(3)
    v_mfma_f32_16x16x32_bf16 v[32:35], v[12:15], v[16:19], 0
    v_bitop3_b32 v10, v16, v18, s83 bitop3:0x7e
    s_waitcnt vmcnt(2)
    v_mfma_f32_16x16x32_bf16 v[32:35], v[12:15], v[20:23], v[32:35]
    v_bitop3_b32 v38, v20, v22, s83 bitop3:0x7e
    v_or_b32 v10, v10, v38
    s_waitcnt vmcnt(1)
    v_mfma_f32_16x16x32_bf16 v[32:35], v[12:15], v[24:27], v[32:35]
    v_bitop3_b32 v38, v24, v26, s83 bitop3:0x7e
    v_or_b32 v10, v10, v38
    s_waitcnt vmcnt(0)
    v_mfma_f32_16x16x32_bf16 v[32:35], v[12:15], v[28:31], v[32:35]
    v_bitop3_b32 v38, v28, v30, s83 bitop3:0x7e
    v_or_b32 v10, v10, v38
    v_and_b32 v10, 1, v10
    v_cmp_ne_u32 vcc, 0, v10
    s_cbranch_vccnz P1R_8
P1_7_OK:
    s_xor_b32 s83, s83, 1
    s_nop 1
    v_add_f32_dpp v32, v32, v32 row_ror:8 row_mask:0xf bank_mask:0xf
    v_add_f32_dpp v33, v33, v33 row_ror:8 row_mask:0xf bank_mask:0xf
    v_add_f32_dpp v34, v34, v34 row_ror:8 row_mask:0xf bank_mask:0xf
    v_add_f32_dpp v35, v35, v35 row_ror:8 row_mask:0xf bank_mask:0xf
    s_mov_b64 exec, s[72:73]
    v_cvt_pk_bf16_f32 v36, v32, v33
    v_cvt_pk_bf16_f32 v37, v34, v35
    s_mov_b64 exec, s[74:75]
    buffer_store_dwordx2 v[36:37], v2, s[36:39], s57 offen
    s_mov_b64 exec, -1
    s_barrier
    s_add_u32 s68, s52, 1
    s_cmp_le_u32 s64, s68
    s_cbranch_scc1 KRS_12
KRD_11:
    s_sleep 2
    buffer_load_dwordx4 v[40:43], v3, s[36:39], s59 offen sc1
    buffer_load_dwordx4 v[44:47], v3, s[36:39], s59 offen offset:1024 sc1
    s_sleep 2
    buffer_load_dwordx4 v[104:107], v3, s[36:39], s59 offen sc1
    buffer_load_dwordx4 v[108:111], v3, s[36:39], s59 offen offset:1024 sc1
    s_cmp_ge_u32 s52, 63
    s_cbranch_scc1 CHF_LASTW
    v_mov_b32 v90, s11
    v_mov_b64 v[96:97], 0
    v_mov_b64 v[98:99], 0
    v_mov_b64 v[100:101], 0
    v_mov_b64 v[102:103], 0
    s_branch CHF_LOOP_AGW
CHF_LOOP_1:
    v_mov_b64 v[36:37], -1
    v_xor_b32 v8, 0x3C000, v8
    v_xor_b32 v9, 0x3C000, v9
    v_add_u32 v2, 0x2000, v2
    v_subrev_u32 v10, 0x6000, v2
    v_min_u32 v2, v2, v10
    s_add_u32 s66, s66, 0x2000
    s_cmp_eq_u32 s66, 0x6000
    s_cselect_b32 s66, 0, s66
    s_add_u32 s59, s66, 114688
    s_add_u32 s61, s61, 0x80000
    s_xor_b32 s62, s62, 0x3C000
    s_add_u32 s63, s63, 0x20000
    s_add_u32 s10, s61, 8192
    s_mov_b32 m0, s62
    s_mov_b32 s11, s52
    s_min_u32 s67, s52, 59
    s_add_u32 s67, s67, 1
    s_add_u32 s67, s67, s12
    s_and_b32 s12, s12, s13
    s_add_u32 s67, s67, s12
    s_and_b32 s12, s12, s14
    s_add_u32 s67, s67, s12
    s_and_b32 s12, s12, s15
    s_add_u32 s67, s67, s12
    s_cmp_ge_u32 s67, 64
    s_cselect_b32 s67, -1, s67
    s_max_u32 s64, s64, s67
    s_add_u32 s52, s52, 1
    s_min_u32 s67, s52, 59
    s_lshl_b32 s67, s67, 2
    s_add_u32 s67, s67, s58
    s_load_dwordx4 s[12:15], s[34:35], s67 glc
    ds_read_b128 v[48:51], v7 offset:0
    ds_read_b128 v[52:55], v7 offset:1024
    ds_read_b128 v[56:59], v7 offset:2048
    ds_read_b128 v[60:63], v7 offset:3072
    ds_read_b128 v[64:67], v7 offset:4096
    ds_read_b128 v[68:71], v7 offset:5120
    ds_read_b128 v[72:75], v7 offset:6144
    ds_read_b128 v[76:79], v7 offset:7168
    ds_read_b128 v[80:83], v7 offset:8192
    ds_read_b128 v[84:87], v7 offset:9216
    s_xor_b32 s83, s83, 1
    s_barrier
    s_add_u32 s68, s52, 1
    s_cmp_le_u32 s64, s68
    s_cbranch_scc1 KRS_18
KRD_17:
    s_sleep 2
    buffer_load_dwordx4 v[40:43], v3, s[36:39], s59 offen sc1
    buffer_load_dwordx4 v[44:47], v3, s[36:39], s59 offen offset:1024 sc1
    s_sleep 2
    buffer_load_dwordx4 v[104:107], v3, s[36:39], s59 offen sc1
    buffer_load_dwordx4 v[108:111], v3, s[36:39], s59 offen offset:1024 sc1
    s_cmp_ge_u32 s52, 63
    s_cbranch_scc1 CHF_LASTW
    v_mov_b32 v90, s11
    v_mov_b64 v[96:97], 0
    v_mov_b64 v[98:99], 0
    v_mov_b64 v[100:101], 0
    v_mov_b64 v[102:103], 0
    s_branch CHF_LOOP_AGW
CHF_LOOP_3:
    v_mov_b64 v[36:37], -1
    v_xor_b32 v8, 0x3C000, v8
    v_xor_b32 v9, 0x3C000, v9
    v_add_u32 v2, 0x2000, v2
    v_subrev_u32 v10, 0x6000, v2
    v_min_u32 v2, v2, v10
    s_add_u32 s66, s66, 0x2000
    s_cmp_eq_u32 s66, 0x6000
    s_cselect_b32 s66, 0, s66
    s_add_u32 s59, s66, 114688
    s_add_u32 s61, s61, 0x80000
    s_xor_b32 s62, s62, 0x3C000
    s_add_u32 s63, s63, 0x20000
    s_add_u32 s10, s61, 8192
    s_mov_b32 m0, s62
    s_mov_b32 s11, s52
    s_min_u32 s67, s52, 59
    s_add_u32 s67, s67, 1
    s_add_u32 s67, s67, s12
    s_and_b32 s12, s12, s13
    s_add_u32 s67, s67, s12
    s_and_b32 s12, s12, s14
    s_add_u32 s67, s67, s12
    s_and_b32 s12, s12, s15
    s_add_u32 s67, s67, s12
    s_cmp_ge_u32 s67, 64
    s_cselect_b32 s67, -1, s67
    s_max_u32 s64, s64, s67
    s_add_u32 s52, s52, 1
    s_min_u32 s67, s52, 59
    s_lshl_b32 s67, s67, 2
    s_add_u32 s67, s67, s58
    s_load_dwordx4 s[12:15], s[34:35], s67 glc
    ds_read_b128 v[48:51], v7 offset:0
    ds_read_b128 v[52:55], v7 offset:1024
    ds_read_b128 v[56:59], v7 offset:2048
    ds_read_b128 v[60:63], v7 offset:3072
    ds_read_b128 v[64:67], v7 offset:4096
    ds_read_b128 v[68:71], v7 offset:5120
    ds_read_b128 v[72:75], v7 offset:6144
    ds_read_b128 v[76:79], v7 offset:7168
    ds_read_b128 v[80:83], v7 offset:8192
    ds_read_b128 v[84:87], v7 offset:9216
    s_xor_b32 s83, s83, 1
    s_barrier
    s_add_u32 s68, s52, 1
    s_cmp_le_u32 s64, s68
    s_cbranch_scc1 KRS_24
KRD_23:
    s_sleep 2
    buffer_load_dwordx4 v[40:43], v3, s[36:39], s59 offen sc1
    buffer_load_dwordx4 v[44:47], v3, s[36:39], s59 offen offset:1024 sc1
    s_sleep 2
    buffer_load_dwordx4 v[104:107], v3, s[36:39], s59 offen sc1
    buffer_load_dwordx4 v[108:111], v3, s[36:39], s59 offen offset:1024 sc1
    s_cmp_ge_u32 s52, 63
    s_cbranch_scc1 CHF_LASTW
    v_mov_b32 v90, s11
    v_mov_b64 v[96:97], 0
    v_mov_b64 v[98:99], 0
    v_mov_b64 v[100:101], 0
    v_mov_b64 v[102:103], 0
    s_branch CHF_LOOP_AGW
.p2align 6
CHF_LOOP_2:
    v_mov_b64 v[36:37], -1
    v_xor_b32 v8, 0x3C000, v8
    v_xor_b32 v9, 0x3C000, v9
    v_add_u32 v2, 0x2000, v2
    v_subrev_u32 v10, 0x6000, v2
    v_min_u32 v2, v2, v10
    s_add_u32 s66, s66, 0x2000
    s_cmp_eq_u32 s66, 0x6000
    s_cselect_b32 s66, 0, s66
    s_add_u32 s59, s66, 114688
    s_add_u32 s61, s61, 0x80000
    s_xor_b32 s62, s62, 0x3C000
    s_add_u32 s63, s63, 0x20000
    s_add_u32 s10, s61, 8192
    s_mov_b32 m0, s62
    s_mov_b32 s11, s52
    s_min_u32 s67, s52, 59
    s_add_u32 s67, s67, 1
    s_add_u32 s67, s67, s12
    s_and_b32 s12, s12, s13
    s_add_u32 s67, s67, s12
    s_and_b32 s12, s12, s14
    s_add_u32 s67, s67, s12
    s_and_b32 s12, s12, s15
    s_add_u32 s67, s67, s12
    s_cmp_ge_u32 s67, 64
    s_cselect_b32 s67, -1, s67
    s_max_u32 s64, s64, s67
    s_add_u32 s52, s52, 1
    s_min_u32 s67, s52, 59
    s_lshl_b32 s67, s67, 2
    s_add_u32 s67, s67, s58
    s_load_dwordx4 s[12:15], s[34:35], s67 glc
    ds_read_b128 v[48:51], v7 offset:0
    ds_read_b128 v[52:55], v7 offset:1024
    ds_read_b128 v[56:59], v7 offset:2048
    ds_read_b128 v[60:63], v7 offset:3072
    ds_read_b128 v[64:67], v7 offset:4096
    ds_read_b128 v[68:71], v7 offset:5120
    ds_read_b128 v[72:75], v7 offset:6144
    ds_read_b128 v[76:79], v7 offset:7168
    ds_read_b128 v[80:83], v7 offset:8192
    ds_read_b128 v[84:87], v7 offset:9216
    buffer_load_dwordx4 v[16:19], v1, s[36:39], s55 offen sc1
    buffer_load_dwordx4 v[20:23], v1, s[36:39], s56 offen sc1
    buffer_load_dwordx4 v[24:27], v1, s[36:39], s4 offen sc1
    buffer_load_dwordx4 v[28:31], v1, s[36:39], s5 offen sc1
    s_sleep 2
    buffer_load_dwordx4 v[96:99], v1, s[36:39], s55 offen sc1
    buffer_load_dwordx4 v[100:103], v1, s[36:39], s56 offen sc1
    buffer_load_dwordx4 v[104:107], v1, s[36:39], s4 offen sc1
    buffer_load_dwordx4 v[108:111], v1, s[36:39], s5 offen sc1
    s_waitcnt vmcnt(7)
    v_mfma_f32_16x16x32_bf16 v[32:35], v[12:15], v[16:19], 0
    v_bitop3_b32 v10, v16, v18, s83 bitop3:0x7e
    s_waitcnt vmcnt(6)
    v_mfma_f32_16x16x32_bf16 v[32:35], v[12:15], v[20:23], v[32:35]
    v_bitop3_b32 v38, v20, v22, s83 bitop3:0x7e
    v_or_b32 v10, v10, v38
    s_waitcnt vmcnt(5)
    v_mfma_f32_16x16x32_bf16 v[32:35], v[12:15], v[24:27], v[32:35]
    v_bitop3_b32 v38, v24, v26, s83 bitop3:0x7e
    v_or_b32 v10, v10, v38
    s_waitcnt vmcnt(4)
    v_mfma_f32_16x16x32_bf16 v[32:35], v[12:15], v[28:31], v[32:35]
    v_bitop3_b32 v38, v28, v30, s83 bitop3:0x7e
    v_or_b32 v10, v10, v38
    v_and_b32 v10, 1, v10
    v_cmp_ne_u32 vcc, 0, v10
    s_cbranch_vccnz P1R_26
P1_25_OK:
    s_xor_b32 s83, s83, 1
    s_nop 1
    v_add_f32_dpp v32, v32, v32 row_ror:8 row_mask:0xf bank_mask:0xf
    v_add_f32_dpp v33, v33, v33 row_ror:8 row_mask:0xf bank_mask:0xf
    v_add_f32_dpp v34, v34, v34 row_ror:8 row_mask:0xf bank_mask:0xf
    v_add_f32_dpp v35, v35, v35 row_ror:8 row_mask:0xf bank_mask:0xf
    s_mov_b64 exec, s[72:73]
    v_cvt_pk_bf16_f32 v36, v32, v33
    v_cvt_pk_bf16_f32 v37, v34, v35
    s_mov_b64 exec, s[74:75]
    buffer_store_dwordx2 v[36:37], v2, s[36:39], s57 offen
    s_mov_b64 exec, -1
    s_barrier
    s_add_u32 s68, s52, 1
    s_cmp_le_u32 s64, s68
    s_cbranch_scc1 KRS_30
KRD_29:
    s_sleep 2
    buffer_load_dwordx4 v[40:43], v3, s[36:39], s59 offen sc1
    buffer_load_dwordx4 v[44:47], v3, s[36:39], s59 offen offset:1024 sc1
    s_sleep 2
    buffer_load_dwordx4 v[104:107], v3, s[36:39], s59 offen sc1
    buffer_load_dwordx4 v[108:111], v3, s[36:39], s59 offen offset:1024 sc1
    s_cmp_ge_u32 s52, 63
    s_cbranch_scc1 CHF_LASTW
    v_mov_b32 v90, s11
    s_waitcnt vmcnt(4)
    v_mov_b64 v[96:97], 0
    v_mov_b64 v[98:99], 0
    v_mov_b64 v[100:101], 0
    v_mov_b64 v[102:103], 0
CHF_LOOP_AGW:
    s_waitcnt vmcnt(2)
    ds_write_b128 v3, v[40:43]
    ds_write_b128 v3, v[44:47] offset:1024
    v_max3_u32 v10, v40, v42, v44
    v_max_u32 v10, v10, v46
    v_cmp_eq_u32 vcc, -1, v10
    s_cbranch_vccnz P2R_28
P2_27_OK:
CHF_ENTRY:
    s_waitcnt lgkmcnt(0)
    s_barrier
    ds_read_b64_tr_b16 v[16:17], v4 offset:0
    ds_read_b64_tr_b16 v[18:19], v4 offset:2048
    ds_read_b64_tr_b16 v[20:21], v4 offset:4096
    ds_read_b64_tr_b16 v[22:23], v4 offset:6144
    ds_read_b64_tr_b16 v[24:25], v4 offset:512
    ds_read_b64_tr_b16 v[26:27], v4 offset:2560
    ds_read_b64_tr_b16 v[28:29], v4 offset:4608
    ds_read_b64_tr_b16 v[30:31], v4 offset:6656
    s_waitcnt lgkmcnt(6)
    v_smfmac_f32_16x16x64_bf16 v[96:99], v[16:19], v[48:55], v0
    ds_read_b64_tr_b16 v[32:33], v4 offset:1024
    buffer_load_dwordx4 v3, s[36:39], s61 offen offset:0 sc1 lds
    v_smfmac_f32_16x16x64_bf16 v[100:103], v[16:19], v[56:63], v0
    ds_read_b64_tr_b16 v[34:35], v4 offset:3072
    s_waitcnt lgkmcnt(6)
    v_smfmac_f32_16x16x64_bf16 v[96:99], v[20:23], v[64:71], v0
    ds_read_b64_tr_b16 v[36:37], v4 offset:5120
    buffer_load_dwordx4 v3, s[36:39], s61 offen offset:1024 sc1 lds
    v_smfmac_f32_16x16x64_bf16 v[100:103], v[20:23], v[72:79], v0
    ds_read_b64_tr_b16 v[38:39], v4 offset:7168
    s_waitcnt lgkmcnt(6)
    v_smfmac_f32_16x16x64_bf16 v[96:99], v[24:27], v[80:87], v0
    s_add_u32 m0, s62, 8192
    s_waitcnt lgkmcnt(4)
    v_smfmac_f32_16x16x64_bf16 v[96:99], v[28:31], a[0:7], v0
    s_waitcnt vmcnt(2)
    ds_read_b64_tr_b16 v[40:41], v4 offset:1536
    v_smfmac_f32_16x16x64_bf16 v[100:103], v[28:31], a[8:15], v0
    ds_read_b64_tr_b16 v[42:43], v4 offset:3584
    s_waitcnt lgkmcnt(4)
    v_smfmac_f32_16x16x64_bf16 v[96:99], v[32:35], a[16:23], v0
    ds_read_b64_tr_b16 v[44:45], v4 offset:5632
    buffer_load_dwordx4 v3, s[36:39], s10 offen offset:0 sc1 lds
    v_smfmac_f32_16x16x64_bf16 v[100:103], v[32:35], a[24:31], v0
    ds_read_b64_tr_b16 v[46:47], v4 offset:7680
    s_waitcnt lgkmcnt(4)
    v_smfmac_f32_16x16x64_bf16 v[96:99], v[36:39], a[32:39], v0
    ds_read_b128 v[48:51], v7 offset:10240
    buffer_load_dwordx4 v3, s[36:39], s10 offen offset:1024 sc1 lds
    v_smfmac_f32_16x16x64_bf16 v[100:103], v[36:39], a[40:47], v0
    ds_read_b128 v[52:55], v7 offset:11264
    s_waitcnt lgkmcnt(4)
    v_mov_b64 v[104:105], 0
    v_smfmac_f32_16x16x64_bf16 v[96:99], v[40:43], a[48:55], v0
    s_mov_b64 exec, s[76:77]
    buffer_store_dword v90, off, s[36:39], s81 sc1
    s_mov_b64 exec, -1
    v_smfmac_f32_16x16x64_bf16 v[100:103], v[40:43], a[56:63], v0
    s_waitcnt lgkmcnt(2)
    v_mov_b64 v[106:107], 0
    v_smfmac_f32_16x16x64_bf16 v[96:99], v[44:47], a[64:71], v0
    buffer_store_dwordx2 v[92:93], v11, s[36:39], s63 offen sc1
    v_mov_b64 v[108:109], 0
    v_smfmac_f32_16x16x64_bf16 v[100:103], v[44:47], a[72:79], v0
    s_waitcnt lgkmcnt(0)
    v_mov_b64 v[110:111], 0
    v_smfmac_f32_16x16x64_bf16 v[100:103], v[24:27], v[48:55], v0
    buffer_store_dwordx2 v[94:95], v11, s[36:39], s63 offen offset:2048 sc1
    v_smfmac_f32_16x16x64_bf16 v[104:107], v[16:19], a[80:87], v0
    v_add_f32 v96, v96, v98
    v_add_f32 v97, v97, v99
    v_smfmac_f32_16x16x64_bf16 v[108:111], v[16:19], a[88:95], v0
    v_cvt_pk_bf16_f32 v90, v96, v97
    v_add_f32 v100, v100, v102
    v_smfmac_f32_16x16x64_bf16 v[104:107], v[20:23], a[96:103], v0
    ds_write2_b32 v6, v90, v90 offset0:0 offset1:1
    v_add_f32 v101, v101, v103
    v_cvt_pk_bf16_f32 v91, v100, v101
    v_smfmac_f32_16x16x64_bf16 v[108:111], v[20:23], a[104:111], v0
    ds_write2_b32 v6, v91, v91 offset0:128 offset1:129
    v_smfmac_f32_16x16x64_bf16 v[104:107], v[24:27], a[112:119], v0
    ds_read_b128 v[64:67], v8 offset:0
    v_add_u32 v10, 4096, v6
    v_smfmac_f32_16x16x64_bf16 v[108:111], v[24:27], a[120:127], v0
    ds_read_b128 v[68:71], v8 offset:4096
    v_smfmac_f32_16x16x64_bf16 v[104:107], v[28:31], a[128:135], v0
    ds_read_b128 v[72:75], v8 offset:1024
    v_smfmac_f32_16x16x64_bf16 v[108:111], v[28:31], a[136:143], v0
    ds_read_b128 v[76:79], v8 offset:5120
    v_smfmac_f32_16x16x64_bf16 v[104:107], v[32:35], a[144:151], v0
    s_waitcnt lgkmcnt(4)
    s_barrier
    v_smfmac_f32_16x16x64_bf16 v[108:111], v[32:35], a[152:159], v0
    ds_read_b64_tr_b16 v[48:49], v4 offset:8192
    ds_read_b64_tr_b16 v[50:51], v4 offset:8704
    v_smfmac_f32_16x16x64_bf16 v[104:107], v[36:39], a[160:167], v0
    ds_read_b64_tr_b16 v[52:53], v4 offset:9216
    ds_read_b64_tr_b16 v[54:55], v4 offset:9728
    v_smfmac_f32_16x16x64_bf16 v[108:111], v[36:39], a[168:175], v0
    ds_read_b128 v[80:83], v8 offset:2048
    v_smfmac_f32_16x16x64_bf16 v[104:107], v[40:43], a[176:183], v0
    ds_read_b64_tr_b16 v[56:57], v4 offset:10240
    ds_read_b128 v[84:87], v8 offset:6144
    v_smfmac_f32_16x16x64_bf16 v[108:111], v[40:43], a[184:191], v0
    ds_read_b64_tr_b16 v[58:59], v4 offset:10752
    ds_read_b64_tr_b16 v[60:61], v4 offset:11264
    v_smfmac_f32_16x16x64_bf16 v[104:107], v[44:47], a[192:199], v0
    ds_read_b64_tr_b16 v[62:63], v4 offset:11776
    v_smfmac_f32_16x16x64_bf16 v[108:111], v[44:47], a[200:207], v0
    s_waitcnt lgkmcnt(6)
    v_mfma_f32_16x16x32_bf16 v[96:99], v[64:67], v[48:51], 0
    ds_read_b128 v[64:67], v8 offset:3072
    v_add_f32 v104, v104, v106
    v_add_f32 v105, v105, v107
    v_mfma_f32_16x16x32_bf16 v[100:103], v[68:71], v[48:51], 0
    ds_read_b128 v[68:71], v8 offset:7168
    v_cvt_pk_bf16_f32 v92, v104, v105
    v_add_f32 v108, v108, v110
    v_mfma_f32_16x16x32_bf16 v[96:99], v[72:75], v[52:55], v[96:99]
    ds_write2_b32 v10, v92, v92 offset0:0 offset1:1
    v_add_f32 v109, v109, v111
    v_cvt_pk_bf16_f32 v93, v108, v109
    v_mfma_f32_16x16x32_bf16 v[100:103], v[76:79], v[52:55], v[100:103]
    s_waitcnt lgkmcnt(3)
    v_mov_b64 v[104:105], 0
    v_mov_b64 v[106:107], 0
    v_mfma_f32_16x16x32_bf16 v[96:99], v[80:83], v[56:59], v[96:99]
    ds_write2_b32 v10, v93, v93 offset0:128 offset1:129
    v_mov_b64 v[108:109], 0
    v_mov_b64 v[110:111], 0
    v_mfma_f32_16x16x32_bf16 v[100:103], v[84:87], v[56:59], v[100:103]
    s_waitcnt lgkmcnt(2)
    v_mfma_f32_16x16x32_bf16 v[96:99], v[64:67], v[60:63], v[96:99]
    v_mfma_f32_16x16x32_bf16 v[100:103], v[68:71], v[60:63], v[100:103]
    v_smfmac_f32_16x16x64_bf16 v[104:107], v[16:19], a[208:215], v0
    v_smfmac_f32_16x16x64_bf16 v[108:111], v[16:19], a[216:223], v0
    v_max3_f32 v68, v96, v97, v98
    v_max3_f32 v69, v100, v101, v102
    v_smfmac_f32_16x16x64_bf16 v[104:107], v[20:23], a[224:231], v0
    v_max3_f32 v68, v68, v99, v103
    v_max_f32 v68, v68, v69
    v_smfmac_f32_16x16x64_bf16 v[108:111], v[20:23], a[232:239], v0
    s_waitcnt lgkmcnt(0)
    s_barrier
    v_smfmac_f32_16x16x64_bf16 v[104:107], v[24:27], a[240:247], v0
    ds_read_b64_tr_b16 v[72:73], v5 offset:12288
    ds_read_b64_tr_b16 v[74:75], v5 offset:12800
    v_smfmac_f32_16x16x64_bf16 v[108:111], v[24:27], a[248:255], v0
    ds_read_b64_tr_b16 v[76:77], v5 offset:13312
    ds_read_b64_tr_b16 v[78:79], v5 offset:13824
    v_smfmac_f32_16x16x64_bf16 v[104:107], v[28:31], v[112:119], v0
    ds_read_b64_tr_b16 v[80:81], v5 offset:14336
    v_smfmac_f32_16x16x64_bf16 v[108:111], v[28:31], v[120:127], v0
    ds_read_b64_tr_b16 v[82:83], v5 offset:14848
    v_smfmac_f32_16x16x64_bf16 v[104:107], v[32:35], v[128:135], v0
    ds_read_b64_tr_b16 v[84:85], v5 offset:15360
    ds_read_b64_tr_b16 v[86:87], v5 offset:15872
    v_smfmac_f32_16x16x64_bf16 v[108:111], v[32:35], v[136:143], v0
    ds_read_b128 v[16:19], v7 offset:12288
    s_waitcnt lgkmcnt(7)
    v_mfma_f32_16x16x32_bf16 v[64:67], v[72:75], v[48:51], 0
    s_waitcnt lgkmcnt(5)
    v_mfma_f32_16x16x32_bf16 v[64:67], v[76:79], v[52:55], v[64:67]
    s_waitcnt lgkmcnt(3)
    v_cndmask_b32 v88, v96, v98, s[78:79]
    v_cndmask_b32 v89, v97, v99, s[78:79]
    v_mfma_f32_16x16x32_bf16 v[64:67], v[80:83], v[56:59], v[64:67]
    s_waitcnt lgkmcnt(1)
    v_cndmask_b32 v90, v100, v102, s[78:79]
    v_cndmask_b32 v91, v101, v103, s[78:79]
    v_mfma_f32_16x16x32_bf16 v[64:67], v[84:87], v[60:63], v[64:67]
    ds_read_b64 v[50:51], v9 offset:0
    v_mov_b64 v[72:73], 0
    v_mov_b64 v[74:75], 0
    v_smfmac_f32_16x16x64_bf16 v[104:107], v[36:39], v[144:151], v0
    ds_read_b64 v[54:55], v9 offset:512
    ds_read_b64 v[58:59], v9 offset:1024
    v_mov_b64 v[76:77], 0
    v_smfmac_f32_16x16x64_bf16 v[108:111], v[36:39], v[152:159], v0
    ds_read_b64 v[62:63], v9 offset:1536
    ds_read_b128 v[20:23], v7 offset:13312
    v_max3_f32 v68, v68, v64, v65
    v_mov_b32 v69, v68
    v_smfmac_f32_16x16x64_bf16 v[104:107], v[40:43], v[160:167], v0
    ds_read_b128 v[24:27], v7 offset:14336
    ds_read_b128 v[28:31], v7 offset:15360
    v_permlane32_swap_b32 v68, v69
    v_max_f32 v68, v68, v69
    v_mov_b32 v69, v68
    v_smfmac_f32_16x16x64_bf16 v[108:111], v[40:43], v[168:175], v0
    ds_read_b128 v[32:35], v7 offset:16384
    ds_read_b128 v[36:39], v7 offset:17408
    v_permlane16_swap_b32 v68, v69
    v_max_f32 v68, v68, v69
    v_smfmac_f32_16x16x64_bf16 v[104:107], v[44:47], v[176:183], v0
    v_mul_f32 v68, s80, v68
    v_smfmac_f32_16x16x64_bf16 v[108:111], v[44:47], v[184:191], v0
    ds_read_b128 v[40:43], v7 offset:18432
    ds_read_b128 v[44:47], v7 offset:19456
    v_mov_b64 v[78:79], 0
    v_mov_b32 v82, 0
    v_mov_b64 v[84:85], s[8:9]
    v_mov_b64 v[86:87], s[8:9]
    v_fma_f32 v64, v64, s80, -v68
    v_fma_f32 v65, v65, s80, -v68
    v_fma_f32 v88, v88, s80, -v68
    v_fma_f32 v89, v89, s80, -v68
    v_fma_f32 v90, v90, s80, -v68
    v_fma_f32 v91, v91, s80, -v68
    v_exp_f32 v64, v64
    v_exp_f32 v65, v65
    v_exp_f32 v88, v88
    v_exp_f32 v89, v89
    v_exp_f32 v90, v90
    v_exp_f32 v91, v91
    v_cvt_pk_bf16_f32 v80, v64, v65
    v_cvt_pk_bf16_f32 v81, v88, v89
    v_cvt_pk_bf16_f32 v83, v90, v91
    v_permlane32_swap_b32 v80, v82
    v_cvt_pk_bf16_f32 v48, v104, v105
    v_cvt_pk_bf16_f32 v49, v106, v107
    v_mfma_f32_16x16x32_bf16 v[68:71], v[80:83], v[84:87], 0
    s_waitcnt lgkmcnt(7)
    v_cvt_pk_bf16_f32 v56, v108, v109
    v_cvt_pk_bf16_f32 v57, v110, v111
    v_smfmac_f32_16x16x64_bf16 v[72:75], v[80:83], v[48:55], v0
    s_nop 0
    v_smfmac_f32_16x16x64_bf16 v[76:79], v[80:83], v[56:63], v0
    v_add_f32 v68, v68, v70
    v_add_f32 v69, v69, v71
    v_rcp_f32 v68, v68
    v_rcp_f32 v69, v69
    v_add_f32 v72, v72, v74
    v_add_f32 v73, v73, v75
    v_mul_f32 v72, v72, v68
    v_mul_f32 v73, v73, v69
    v_add_f32 v76, v76, v78
    v_add_f32 v77, v77, v79
    v_mul_f32 v76, v76, v68
    v_mul_f32 v77, v77, v69
    v_cvt_pk_bf16_f32 v72, v72, v73
    v_cvt_pk_bf16_f32 v73, v76, v77
    ds_write_b64 v6, v[72:73]
    v_mov_b64 v[48:49], 0
    v_mov_b64 v[50:51], 0
    v_pk_add_f32 v[104:105], v[104:105], v[106:107]
    v_cvt_pk_bf16_f32 v94, v104, v105
    v_pk_add_f32 v[108:109], v[108:109], v[110:111]
    v_cvt_pk_bf16_f32 v95, v108, v109
    v_mfma_f32_32x32x16_bf16 v[96:111], v[48:51], v[48:51], 0
    v_mov_b64 v[52:53], 0
    v_mov_b64 v[54:55], 0
    v_mov_b64 v[56:57], 0
    v_mov_b64 v[58:59], 0
    v_mov_b64 v[60:61], 0
    v_mov_b64 v[62:63], 0
    s_waitcnt lgkmcnt(0)
    s_barrier
    ds_read_b64_tr_b16 v[64:65], v4 offset:8192
    ds_read_b64_tr_b16 v[66:67], v4 offset:9216
    ds_read_b64_tr_b16 v[68:69], v4 offset:10240
    ds_read_b64_tr_b16 v[70:71], v4 offset:11264
    s_waitcnt lgkmcnt(2)
    v_smfmac_f32_16x16x64_bf16 v[48:51], v[64:67], v[192:199], v0
    v_smfmac_f32_16x16x64_bf16 v[52:55], v[64:67], v[200:207], v0
    s_waitcnt lgkmcnt(0)
    v_smfmac_f32_16x16x64_bf16 v[48:51], v[68:71], v[16:23], v0
    ds_read_b128 v[16:19], v7 offset:20480
    ds_read_b128 v[20:23], v7 offset:21504
    v_smfmac_f32_16x16x64_bf16 v[52:55], v[68:71], v[24:31], v0
    ds_read_b128 v[24:27], v7 offset:22528
    ds_read_b128 v[28:31], v7 offset:23552
    v_smfmac_f32_16x16x64_bf16 v[56:59], v[64:67], v[208:215], v0
    s_nop 0
    v_add_f32 v48, v48, v50
    v_smfmac_f32_16x16x64_bf16 v[60:63], v[64:67], v[216:223], v0
    v_add_f32 v49, v49, v51
    v_cvt_pk_bf16_f32 v72, v48, v49
    v_smfmac_f32_16x16x64_bf16 v[56:59], v[68:71], v[32:39], v0
    ds_read_b128 v[32:35], v7 offset:24576
    ds_read_b128 v[36:39], v7 offset:25600
    v_add_f32 v52, v52, v54
    v_add_f32 v53, v53, v55
    v_smfmac_f32_16x16x64_bf16 v[60:63], v[68:71], v[40:47], v0
    ds_read_b128 v[40:43], v7 offset:26624
    ds_read_b128 v[44:47], v7 offset:27648
    v_and_or_b32 v72, v72, -2, s83
    v_cvt_pk_bf16_f32 v73, v52, v53
    v_smfmac_f32_16x16x64_bf16 v[96:99], v[64:67], v[224:231], v0
    buffer_store_dwordx2 v[72:73], v11, s[36:39], s53 offen offset:0
    v_add_f32 v56, v56, v58
    v_add_f32 v57, v57, v59
    v_smfmac_f32_16x16x64_bf16 v[100:103], v[64:67], v[232:239], v0
    s_waitcnt lgkmcnt(6)
    v_cvt_pk_bf16_f32 v74, v56, v57
    v_add_f32 v60, v60, v62
    v_smfmac_f32_16x16x64_bf16 v[96:99], v[68:71], v[16:23], v0
    s_waitcnt lgkmcnt(4)
    v_add_f32 v61, v61, v63
    v_and_or_b32 v74, v74, -2, s83
    v_smfmac_f32_16x16x64_bf16 v[100:103], v[68:71], v[24:31], v0
    v_cvt_pk_bf16_f32 v75, v60, v61
    v_smfmac_f32_16x16x64_bf16 v[104:107], v[64:67], v[240:247], v0
    buffer_store_dwordx2 v[74:75], v11, s[36:39], s53 offen offset:2048
    v_add_f32 v96, v96, v98
    v_add_f32 v97, v97, v99
    v_smfmac_f32_16x16x64_bf16 v[108:111], v[64:67], v[248:255], v0
    s_waitcnt lgkmcnt(2)
    v_cvt_pk_bf16_f32 v76, v96, v97
    v_add_f32 v100, v100, v102
    v_add_f32 v101, v101, v103
    v_smfmac_f32_16x16x64_bf16 v[104:107], v[68:71], v[32:39], v0
    s_waitcnt lgkmcnt(0)
    v_and_or_b32 v76, v76, -2, s83
    v_cvt_pk_bf16_f32 v77, v100, v101
    v_smfmac_f32_16x16x64_bf16 v[108:111], v[68:71], v[40:47], v0
    buffer_store_dwordx2 v[76:77], v11, s[36:39], s54 offen offset:0
    s_nop 2
    v_add_f32 v104, v104, v106
    v_add_f32 v105, v105, v107
    v_cvt_pk_bf16_f32 v78, v104, v105
    v_and_or_b32 v78, v78, -2, s83
    v_add_f32 v108, v108, v110
    v_add_f32 v109, v109, v111
    v_cvt_pk_bf16_f32 v79, v108, v109
    buffer_store_dwordx2 v[78:79], v11, s[36:39], s54 offen offset:2048
    s_cmp_eq_u32 s48, 2
    s_cbranch_scc1 CHF_LOOP_2
    s_cmp_eq_u32 s48, 0
    s_cbranch_scc1 CHF_LOOP_0
    s_cmp_eq_u32 s48, 1
    s_cbranch_scc1 CHF_LOOP_1
    s_branch CHF_LOOP_3
P1R_8:
    s_add_u32 s65, s65, 1
    s_cmp_gt_u32 s65, 262144
    s_cbranch_scc1 P1_7_OK
    s_mov_b64 exec, vcc
    buffer_load_dwordx4 v[16:19], v1, s[36:39], s55 offen sc1
    buffer_load_dwordx4 v[20:23], v1, s[36:39], s56 offen sc1
    buffer_load_dwordx4 v[24:27], v1, s[36:39], s4 offen sc1
    buffer_load_dwordx4 v[28:31], v1, s[36:39], s5 offen sc1
    s_mov_b64 exec, -1
    s_waitcnt vmcnt(3)
    v_mfma_f32_16x16x32_bf16 v[32:35], v[12:15], v[16:19], 0
    v_bitop3_b32 v10, v16, v18, s83 bitop3:0x7e
    s_waitcnt vmcnt(2)
    v_mfma_f32_16x16x32_bf16 v[32:35], v[12:15], v[20:23], v[32:35]
    v_bitop3_b32 v38, v20, v22, s83 bitop3:0x7e
    v_or_b32 v10, v10, v38
    s_waitcnt vmcnt(1)
    v_mfma_f32_16x16x32_bf16 v[32:35], v[12:15], v[24:27], v[32:35]
    v_bitop3_b32 v38, v24, v26, s83 bitop3:0x7e
    v_or_b32 v10, v10, v38
    s_waitcnt vmcnt(0)
    v_mfma_f32_16x16x32_bf16 v[32:35], v[12:15], v[28:31], v[32:35]
    v_bitop3_b32 v38, v28, v30, s83 bitop3:0x7e
    v_or_b32 v10, v10, v38
    v_and_b32 v10, 1, v10
    v_cmp_ne_u32 vcc, 0, v10
    s_cbranch_vccz P1_7_OK
    s_branch P1R_8
KRS_12:
    s_waitcnt vmcnt(0)
    v_mbcnt_lo_u32_b32 v31, -1, 0
    v_mbcnt_hi_u32_b32 v31, -1, v31
    v_lshlrev_b32 v31, 2, v31
KR_31:
    s_lshl_b32 s67, s51, 8
    buffer_load_dword v10, v31, s[36:39], s67 offen sc1
    s_add_u32 s65, s65, 1
    s_waitcnt vmcnt(0)
    v_cmp_eq_u32 vcc, 0, v10
    s_ff1_i32_b64 s64, vcc
    s_cmp_gt_u32 s64, s68
    s_cbranch_scc1 KRD_11
    s_sleep 16
    s_cmp_lt_u32 s65, 262144
    s_cbranch_scc1 KR_31
    s_branch KRD_11
KRS_18:
    s_waitcnt vmcnt(0)
    v_mbcnt_lo_u32_b32 v31, -1, 0
    v_mbcnt_hi_u32_b32 v31, -1, v31
    v_lshlrev_b32 v31, 2, v31
KR_32:
    s_lshl_b32 s67, s51, 8
    buffer_load_dword v10, v31, s[36:39], s67 offen sc1
    s_add_u32 s65, s65, 1
    s_waitcnt vmcnt(0)
    v_cmp_eq_u32 vcc, 0, v10
    s_ff1_i32_b64 s64, vcc
    s_cmp_gt_u32 s64, s68
    s_cbranch_scc1 KRD_17
    s_sleep 16
    s_cmp_lt_u32 s65, 262144
    s_cbranch_scc1 KR_32
    s_branch KRD_17
KRS_24:
    s_waitcnt vmcnt(0)
    v_mbcnt_lo_u32_b32 v31, -1, 0
    v_mbcnt_hi_u32_b32 v31, -1, v31
    v_lshlrev_b32 v31, 2, v31
KR_33:
    s_lshl_b32 s67, s51, 8
    buffer_load_dword v10, v31, s[36:39], s67 offen sc1
    s_add_u32 s65, s65, 1
    s_waitcnt vmcnt(0)
    v_cmp_eq_u32 vcc, 0, v10
    s_ff1_i32_b64 s64, vcc
    s_cmp_gt_u32 s64, s68
    s_cbranch_scc1 KRD_23
    s_sleep 16
    s_cmp_lt_u32 s65, 262144
    s_cbranch_scc1 KR_33
    s_branch KRD_23
P1R_26:
    s_add_u32 s65, s65, 1
    s_cmp_gt_u32 s65, 262144
    s_cbranch_scc1 P1_25_OK
    s_mov_b64 exec, vcc
    buffer_load_dwordx4 v[16:19], v1, s[36:39], s55 offen sc1
    buffer_load_dwordx4 v[20:23], v1, s[36:39], s56 offen sc1
    buffer_load_dwordx4 v[24:27], v1, s[36:39], s4 offen sc1
    buffer_load_dwordx4 v[28:31], v1, s[36:39], s5 offen sc1
    s_mov_b64 exec, -1
    s_waitcnt vmcnt(7)
    v_mfma_f32_16x16x32_bf16 v[32:35], v[12:15], v[96:99], 0
    v_bitop3_b32 v10, v96, v98, s83 bitop3:0x7e
    s_waitcnt vmcnt(6)
    v_mfma_f32_16x16x32_bf16 v[32:35], v[12:15], v[100:103], v[32:35]
    v_bitop3_b32 v38, v100, v102, s83 bitop3:0x7e
    v_or_b32 v10, v10, v38
    s_waitcnt vmcnt(5)
    v_mfma_f32_16x16x32_bf16 v[32:35], v[12:15], v[104:107], v[32:35]
    v_bitop3_b32 v38, v104, v106, s83 bitop3:0x7e
    v_or_b32 v10, v10, v38
    s_waitcnt vmcnt(4)
    v_mfma_f32_16x16x32_bf16 v[32:35], v[12:15], v[108:111], v[32:35]
    v_bitop3_b32 v38, v108, v110, s83 bitop3:0x7e
    v_or_b32 v10, v10, v38
    v_and_b32 v10, 1, v10
    v_cmp_ne_u32 vcc, 0, v10
    s_cbranch_vccz P1_25_OK
    s_add_u32 s65, s65, 1
    s_cmp_gt_u32 s65, 262144
    s_cbranch_scc1 P1_25_OK
    s_mov_b64 exec, vcc
    buffer_load_dwordx4 v[96:99], v1, s[36:39], s55 offen sc1
    buffer_load_dwordx4 v[100:103], v1, s[36:39], s56 offen sc1
    buffer_load_dwordx4 v[104:107], v1, s[36:39], s4 offen sc1
    buffer_load_dwordx4 v[108:111], v1, s[36:39], s5 offen sc1
    s_mov_b64 exec, -1
    s_waitcnt vmcnt(7)
    v_mfma_f32_16x16x32_bf16 v[32:35], v[12:15], v[16:19], 0
    v_bitop3_b32 v10, v16, v18, s83 bitop3:0x7e
    s_waitcnt vmcnt(6)
    v_mfma_f32_16x16x32_bf16 v[32:35], v[12:15], v[20:23], v[32:35]
    v_bitop3_b32 v38, v20, v22, s83 bitop3:0x7e
    v_or_b32 v10, v10, v38
    s_waitcnt vmcnt(5)
    v_mfma_f32_16x16x32_bf16 v[32:35], v[12:15], v[24:27], v[32:35]
    v_bitop3_b32 v38, v24, v26, s83 bitop3:0x7e
    v_or_b32 v10, v10, v38
    s_waitcnt vmcnt(4)
    v_mfma_f32_16x16x32_bf16 v[32:35], v[12:15], v[28:31], v[32:35]
    v_bitop3_b32 v38, v28, v30, s83 bitop3:0x7e
    v_or_b32 v10, v10, v38
    v_and_b32 v10, 1, v10
    v_cmp_ne_u32 vcc, 0, v10
    s_cbranch_vccz P1_25_OK
    s_branch P1R_26
KRS_30:
    s_waitcnt vmcnt(0)
    v_mbcnt_lo_u32_b32 v31, -1, 0
    v_mbcnt_hi_u32_b32 v31, -1, v31
    v_lshlrev_b32 v31, 2, v31
KR_34:
    s_lshl_b32 s67, s51, 8
    buffer_load_dword v10, v31, s[36:39], s67 offen sc1
    s_add_u32 s65, s65, 1
    s_waitcnt vmcnt(0)
    v_cmp_eq_u32 vcc, 0, v10
    s_ff1_i32_b64 s64, vcc
    s_cmp_gt_u32 s64, s68
    s_cbranch_scc1 KRD_29
    s_sleep 16
    s_cmp_lt_u32 s65, 262144
    s_cbranch_scc1 KR_34
    s_branch KRD_29
P2R_28:
    s_add_u32 s65, s65, 1
    s_cmp_gt_u32 s65, 262144
    s_cbranch_scc1 P2_27_OK
    s_mov_b64 exec, vcc
    buffer_load_dwordx4 v[40:43], v3, s[36:39], s59 offen sc1
    buffer_load_dwordx4 v[44:47], v3, s[36:39], s59 offen offset:1024 sc1
    s_mov_b64 exec, -1
    s_waitcnt vmcnt(2)
    ds_write_b128 v3, v[104:107]
    ds_write_b128 v3, v[108:111] offset:1024
    v_max3_u32 v10, v104, v106, v108
    v_max_u32 v10, v10, v110
    v_cmp_eq_u32 vcc, -1, v10
    s_cbranch_vccz P2_27_OK
    s_add_u32 s65, s65, 1
    s_cmp_gt_u32 s65, 262144
    s_cbranch_scc1 P2_27_OK
    s_mov_b64 exec, vcc
    buffer_load_dwordx4 v[104:107], v3, s[36:39], s59 offen sc1
    buffer_load_dwordx4 v[108:111], v3, s[36:39], s59 offen offset:1024 sc1
    s_mov_b64 exec, -1
    s_waitcnt vmcnt(2)
    ds_write_b128 v3, v[40:43]
    ds_write_b128 v3, v[44:47] offset:1024
    v_max3_u32 v10, v40, v42, v44
    v_max_u32 v10, v10, v46
    v_cmp_eq_u32 vcc, -1, v10
    s_cbranch_vccz P2_27_OK
    s_branch P2R_28
CHF_LASTW:
    s_waitcnt vmcnt(0)
    ds_write_b128 v3, v[104:107]
    ds_write_b128 v3, v[108:111] offset:1024
    v_max3_u32 v10, v104, v106, v108
    v_max_u32 v10, v10, v110
    v_cmp_eq_u32 vcc, -1, v10
    s_cbranch_vccz CHF_LASTZ
    s_add_u32 s65, s65, 1
    s_cmp_gt_u32 s65, 262144
    s_cbranch_scc1 CHF_LASTZ
    buffer_load_dwordx4 v[104:107], v3, s[36:39], s59 offen sc1
    buffer_load_dwordx4 v[108:111], v3, s[36:39], s59 offen offset:1024 sc1
    s_branch CHF_LASTW
CHF_LASTZ:
    v_mov_b64 v[96:97], 0
    v_mov_b64 v[98:99], 0
    v_mov_b64 v[100:101], 0
    v_mov_b64 v[102:103], 0
CHF_LAST:
    s_waitcnt vmcnt(0) lgkmcnt(0)
    s_barrier
    ds_read_b64_tr_b16 v[16:17], v4 offset:0
    ds_read_b64_tr_b16 v[18:19], v4 offset:2048
    ds_read_b64_tr_b16 v[20:21], v4 offset:4096
    ds_read_b64_tr_b16 v[22:23], v4 offset:6144
    ds_read_b64_tr_b16 v[24:25], v4 offset:512
    ds_read_b64_tr_b16 v[26:27], v4 offset:2560
    ds_read_b64_tr_b16 v[28:29], v4 offset:4608
    ds_read_b64_tr_b16 v[30:31], v4 offset:6656
    ds_read_b64_tr_b16 v[32:33], v4 offset:1024
    ds_read_b64_tr_b16 v[34:35], v4 offset:3072
    ds_read_b64_tr_b16 v[36:37], v4 offset:5120
    ds_read_b64_tr_b16 v[38:39], v4 offset:7168
    ds_read_b64_tr_b16 v[40:41], v4 offset:1536
    ds_read_b64_tr_b16 v[42:43], v4 offset:3584
    ds_read_b64_tr_b16 v[44:45], v4 offset:5632
    ds_read_b64_tr_b16 v[46:47], v4 offset:7680
    buffer_store_dwordx2 v[92:93], v11, s[36:39], s63 offen sc1
    buffer_store_dwordx2 v[94:95], v11, s[36:39], s63 offen offset:2048 sc1
    s_add_u32 s63, s63, 0x20000
    v_mov_b64 v[104:105], 0
    v_mov_b64 v[106:107], 0
    v_mov_b64 v[108:109], 0
    v_mov_b64 v[110:111], 0
    s_waitcnt lgkmcnt(0)
    v_smfmac_f32_16x16x64_bf16 v[96:99], v[16:19], a[80:87], v0
    v_smfmac_f32_16x16x64_bf16 v[100:103], v[16:19], a[88:95], v0
    v_smfmac_f32_16x16x64_bf16 v[96:99], v[20:23], a[96:103], v0
    v_smfmac_f32_16x16x64_bf16 v[100:103], v[20:23], a[104:111], v0
    v_smfmac_f32_16x16x64_bf16 v[96:99], v[24:27], a[112:119], v0
    v_smfmac_f32_16x16x64_bf16 v[100:103], v[24:27], a[120:127], v0
    v_smfmac_f32_16x16x64_bf16 v[96:99], v[28:31], a[128:135], v0
    v_smfmac_f32_16x16x64_bf16 v[100:103], v[28:31], a[136:143], v0
    v_smfmac_f32_16x16x64_bf16 v[96:99], v[32:35], a[144:151], v0
    v_smfmac_f32_16x16x64_bf16 v[100:103], v[32:35], a[152:159], v0
    v_smfmac_f32_16x16x64_bf16 v[96:99], v[36:39], a[160:167], v0
    v_smfmac_f32_16x16x64_bf16 v[100:103], v[36:39], a[168:175], v0
    v_smfmac_f32_16x16x64_bf16 v[96:99], v[40:43], a[176:183], v0
    v_smfmac_f32_16x16x64_bf16 v[100:103], v[40:43], a[184:191], v0
    v_smfmac_f32_16x16x64_bf16 v[96:99], v[44:47], a[192:199], v0
    v_smfmac_f32_16x16x64_bf16 v[100:103], v[44:47], a[200:207], v0
    v_smfmac_f32_16x16x64_bf16 v[104:107], v[16:19], a[208:215], v0
    v_smfmac_f32_16x16x64_bf16 v[108:111], v[16:19], a[216:223], v0
    v_smfmac_f32_16x16x64_bf16 v[104:107], v[20:23], a[224:231], v0
    v_add_f32 v96, v96, v98
    v_smfmac_f32_16x16x64_bf16 v[108:111], v[20:23], a[232:239], v0
    v_add_f32 v97, v97, v99
    v_smfmac_f32_16x16x64_bf16 v[104:107], v[24:27], a[240:247], v0
    v_cvt_pk_bf16_f32 v92, v96, v97
    v_smfmac_f32_16x16x64_bf16 v[108:111], v[24:27], a[248:255], v0
    v_add_f32 v100, v100, v102
    v_smfmac_f32_16x16x64_bf16 v[104:107], v[28:31], v[112:119], v0
    v_add_f32 v101, v101, v103
    v_smfmac_f32_16x16x64_bf16 v[108:111], v[28:31], v[120:127], v0
    v_cvt_pk_bf16_f32 v93, v100, v101
    v_smfmac_f32_16x16x64_bf16 v[104:107], v[32:35], v[128:135], v0
    buffer_store_dwordx2 v[92:93], v11, s[36:39], s63 offen sc1
    v_smfmac_f32_16x16x64_bf16 v[108:111], v[32:35], v[136:143], v0
    v_smfmac_f32_16x16x64_bf16 v[104:107], v[36:39], v[144:151], v0
    v_smfmac_f32_16x16x64_bf16 v[108:111], v[36:39], v[152:159], v0
    v_smfmac_f32_16x16x64_bf16 v[104:107], v[40:43], v[160:167], v0
    v_smfmac_f32_16x16x64_bf16 v[108:111], v[40:43], v[168:175], v0
    v_smfmac_f32_16x16x64_bf16 v[104:107], v[44:47], v[176:183], v0
    v_smfmac_f32_16x16x64_bf16 v[108:111], v[44:47], v[184:191], v0
    s_nop 7
    v_pk_add_f32 v[104:105], v[104:105], v[106:107]
    v_cvt_pk_bf16_f32 v94, v104, v105
    v_pk_add_f32 v[108:109], v[108:109], v[110:111]
    v_cvt_pk_bf16_f32 v95, v108, v109
    buffer_store_dwordx2 v[94:95], v11, s[36:39], s63 offen offset:2048 sc1
    s_waitcnt vmcnt(0) lgkmcnt(0)
    s_barrier
    v_mov_b32 v10, 64
    s_mov_b64 exec, s[76:77]
    buffer_store_dword v10, off, s[36:39], s81 sc1
    s_branch KEND
CHAIN_SLOW:
    s_waitcnt vmcnt(0) lgkmcnt(0)
    s_add_u32 s68, s52, 1
    s_cmp_gt_u32 s64, s68
    s_cbranch_scc1 KRD_35
    s_waitcnt vmcnt(0)
    v_mbcnt_lo_u32_b32 v38, -1, 0
    v_mbcnt_hi_u32_b32 v38, -1, v38
    v_lshlrev_b32 v38, 2, v38
KR_36:
    s_lshl_b32 s67, s51, 8
    buffer_load_dword v10, v38, s[36:39], s67 offen sc1
    s_add_u32 s65, s65, 1
    s_waitcnt vmcnt(0)
    v_cmp_eq_u32 vcc, 0, v10
    s_ff1_i32_b64 s64, vcc
    s_cmp_gt_u32 s64, s68
    s_cbranch_scc1 KRD_35
    s_sleep 16
    s_cmp_lt_u32 s65, 262144
    s_cbranch_scc1 KR_36
    s_branch KRD_35
KRD_35:
    s_add_u32 s10, s61, 8192
    s_mov_b32 m0, s62
    v_mov_b32 v10, 0
    v_mov_b32 v90, 0
    s_branch CHS_ENTRY
CHS_LOOP_0:
    v_mov_b64 v[36:37], -1
    v_xor_b32 v8, 0x3C000, v8
    v_xor_b32 v9, 0x3C000, v9
    v_add_u32 v2, 0x2000, v2
    v_subrev_u32 v10, 0x6000, v2
    v_min_u32 v2, v2, v10
    s_add_u32 s66, s66, 0x2000
    s_cmp_eq_u32 s66, 0x6000
    s_cselect_b32 s66, 0, s66
    s_add_u32 s59, s66, 114688
    s_add_u32 s61, s61, 0x80000
    s_xor_b32 s62, s62, 0x3C000
    s_add_u32 s63, s63, 0x20000
    s_add_u32 s10, s61, 8192
    s_mov_b32 m0, s62
    s_mov_b32 s11, s52
    s_min_u32 s67, s52, 59
    s_add_u32 s67, s67, 1
    s_add_u32 s67, s67, s12
    s_and_b32 s12, s12, s13
    s_add_u32 s67, s67, s12
    s_and_b32 s12, s12, s14
    s_add_u32 s67, s67, s12
    s_and_b32 s12, s12, s15
    s_add_u32 s67, s67, s12
    s_cmp_ge_u32 s67, 64
    s_cselect_b32 s67, -1, s67
    s_max_u32 s64, s64, s67
    s_add_u32 s52, s52, 1
    s_min_u32 s67, s52, 59
    s_lshl_b32 s67, s67, 2
    s_add_u32 s67, s67, s58
    s_load_dwordx4 s[12:15], s[34:35], s67 glc
    ds_read_b128 v[48:51], v7 offset:0
    ds_read_b128 v[52:55], v7 offset:1024
    ds_read_b128 v[56:59], v7 offset:2048
    ds_read_b128 v[60:63], v7 offset:3072
    ds_read_b128 v[64:67], v7 offset:4096
    ds_read_b128 v[68:71], v7 offset:5120
    ds_read_b128 v[72:75], v7 offset:6144
    ds_read_b128 v[76:79], v7 offset:7168
    ds_read_b128 v[80:83], v7 offset:8192
    ds_read_b128 v[84:87], v7 offset:9216
    buffer_load_dwordx4 v[16:19], v1, s[36:39], s55 offen sc1
    buffer_load_dwordx4 v[20:23], v1, s[36:39], s56 offen sc1
    buffer_load_dwordx4 v[24:27], v1, s[36:39], s4 offen sc1
    buffer_load_dwordx4 v[28:31], v1, s[36:39], s5 offen sc1
    s_waitcnt vmcnt(3)
    v_mfma_f32_16x16x32_bf16 v[32:35], v[12:15], v[16:19], 0
    v_bitop3_b32 v10, v16, v18, s83 bitop3:0x7e
    s_waitcnt vmcnt(2)
    v_mfma_f32_16x16x32_bf16 v[32:35], v[12:15], v[20:23], v[32:35]
    v_bitop3_b32 v38, v20, v22, s83 bitop3:0x7e
    v_or_b32 v10, v10, v38
    s_waitcnt vmcnt(1)
    v_mfma_f32_16x16x32_bf16 v[32:35], v[12:15], v[24:27], v[32:35]
    v_bitop3_b32 v38, v24, v26, s83 bitop3:0x7e
    v_or_b32 v10, v10, v38
    s_waitcnt vmcnt(0)
    v_mfma_f32_16x16x32_bf16 v[32:35], v[12:15], v[28:31], v[32:35]
    v_bitop3_b32 v38, v28, v30, s83 bitop3:0x7e
    v_or_b32 v10, v10, v38
    v_and_b32 v10, 1, v10
    v_cmp_ne_u32 vcc, 0, v10
    s_cbranch_vccnz P1R_38
P1_37_OK:
    s_xor_b32 s83, s83, 1
    s_nop 1
    v_add_f32_dpp v32, v32, v32 row_ror:8 row_mask:0xf bank_mask:0xf
    v_add_f32_dpp v33, v33, v33 row_ror:8 row_mask:0xf bank_mask:0xf
    v_add_f32_dpp v34, v34, v34 row_ror:8 row_mask:0xf bank_mask:0xf
    v_add_f32_dpp v35, v35, v35 row_ror:8 row_mask:0xf bank_mask:0xf
    s_mov_b64 exec, s[72:73]
    v_cvt_pk_bf16_f32 v36, v32, v33
    v_cvt_pk_bf16_f32 v37, v34, v35
    s_mov_b64 exec, s[74:75]
    buffer_store_dwordx2 v[36:37], v2, s[36:39], s57 offen sc1
    s_mov_b64 exec, -1
    s_barrier
    s_add_u32 s68, s52, 1
    s_cmp_le_u32 s64, s68
    s_cbranch_scc1 KRS_42
KRD_41:
    s_sleep 2
    buffer_load_dwordx4 v[40:43], v3, s[36:39], s59 offen sc1
    buffer_load_dwordx4 v[44:47], v3, s[36:39], s59 offen offset:1024 sc1
    s_sleep 2
    buffer_load_dwordx4 v[104:107], v3, s[36:39], s59 offen sc1
    buffer_load_dwordx4 v[108:111], v3, s[36:39], s59 offen offset:1024 sc1
    s_cmp_ge_u32 s52, 63
    s_cbranch_scc1 CHS_LASTW
    v_mov_b32 v90, s11
    v_mov_b64 v[96:97], 0
    v_mov_b64 v[98:99], 0
    v_mov_b64 v[100:101], 0
    v_mov_b64 v[102:103], 0
    s_branch CHS_LOOP_AGW
CHS_LOOP_1:
    v_mov_b64 v[36:37], -1
    v_xor_b32 v8, 0x3C000, v8
    v_xor_b32 v9, 0x3C000, v9
    v_add_u32 v2, 0x2000, v2
    v_subrev_u32 v10, 0x6000, v2
    v_min_u32 v2, v2, v10
    s_add_u32 s66, s66, 0x2000
    s_cmp_eq_u32 s66, 0x6000
    s_cselect_b32 s66, 0, s66
    s_add_u32 s59, s66, 114688
    s_add_u32 s61, s61, 0x80000
    s_xor_b32 s62, s62, 0x3C000
    s_add_u32 s63, s63, 0x20000
    s_add_u32 s10, s61, 8192
    s_mov_b32 m0, s62
    s_mov_b32 s11, s52
    s_min_u32 s67, s52, 59
    s_add_u32 s67, s67, 1
    s_add_u32 s67, s67, s12
    s_and_b32 s12, s12, s13
    s_add_u32 s67, s67, s12
    s_and_b32 s12, s12, s14
    s_add_u32 s67, s67, s12
    s_and_b32 s12, s12, s15
    s_add_u32 s67, s67, s12
    s_cmp_ge_u32 s67, 64
    s_cselect_b32 s67, -1, s67
    s_max_u32 s64, s64, s67
    s_add_u32 s52, s52, 1
    s_min_u32 s67, s52, 59
    s_lshl_b32 s67, s67, 2
    s_add_u32 s67, s67, s58
    s_load_dwordx4 s[12:15], s[34:35], s67 glc
    ds_read_b128 v[48:51], v7 offset:0
    ds_read_b128 v[52:55], v7 offset:1024
    ds_read_b128 v[56:59], v7 offset:2048
    ds_read_b128 v[60:63], v7 offset:3072
    ds_read_b128 v[64:67], v7 offset:4096
    ds_read_b128 v[68:71], v7 offset:5120
    ds_read_b128 v[72:75], v7 offset:6144
    ds_read_b128 v[76:79], v7 offset:7168
    ds_read_b128 v[80:83], v7 offset:8192
    ds_read_b128 v[84:87], v7 offset:9216
    s_xor_b32 s83, s83, 1
    s_barrier
    s_add_u32 s68, s52, 1
    s_cmp_le_u32 s64, s68
    s_cbranch_scc1 KRS_48
KRD_47:
    s_sleep 2
    buffer_load_dwordx4 v[40:43], v3, s[36:39], s59 offen sc1
    buffer_load_dwordx4 v[44:47], v3, s[36:39], s59 offen offset:1024 sc1
    s_sleep 2
    buffer_load_dwordx4 v[104:107], v3, s[36:39], s59 offen sc1
    buffer_load_dwordx4 v[108:111], v3, s[36:39], s59 offen offset:1024 sc1
    s_cmp_ge_u32 s52, 63
    s_cbranch_scc1 CHS_LASTW
    v_mov_b32 v90, s11
    v_mov_b64 v[96:97], 0
    v_mov_b64 v[98:99], 0
    v_mov_b64 v[100:101], 0
    v_mov_b64 v[102:103], 0
    s_branch CHS_LOOP_AGW
CHS_LOOP_3:
    v_mov_b64 v[36:37], -1
    v_xor_b32 v8, 0x3C000, v8
    v_xor_b32 v9, 0x3C000, v9
    v_add_u32 v2, 0x2000, v2
    v_subrev_u32 v10, 0x6000, v2
    v_min_u32 v2, v2, v10
    s_add_u32 s66, s66, 0x2000
    s_cmp_eq_u32 s66, 0x6000
    s_cselect_b32 s66, 0, s66
    s_add_u32 s59, s66, 114688
    s_add_u32 s61, s61, 0x80000
    s_xor_b32 s62, s62, 0x3C000
    s_add_u32 s63, s63, 0x20000
    s_add_u32 s10, s61, 8192
    s_mov_b32 m0, s62
    s_mov_b32 s11, s52
    s_min_u32 s67, s52, 59
    s_add_u32 s67, s67, 1
    s_add_u32 s67, s67, s12
    s_and_b32 s12, s12, s13
    s_add_u32 s67, s67, s12
    s_and_b32 s12, s12, s14
    s_add_u32 s67, s67, s12
    s_and_b32 s12, s12, s15
    s_add_u32 s67, s67, s12
    s_cmp_ge_u32 s67, 64
    s_cselect_b32 s67, -1, s67
    s_max_u32 s64, s64, s67
    s_add_u32 s52, s52, 1
    s_min_u32 s67, s52, 59
    s_lshl_b32 s67, s67, 2
    s_add_u32 s67, s67, s58
    s_load_dwordx4 s[12:15], s[34:35], s67 glc
    ds_read_b128 v[48:51], v7 offset:0
    ds_read_b128 v[52:55], v7 offset:1024
    ds_read_b128 v[56:59], v7 offset:2048
    ds_read_b128 v[60:63], v7 offset:3072
    ds_read_b128 v[64:67], v7 offset:4096
    ds_read_b128 v[68:71], v7 offset:5120
    ds_read_b128 v[72:75], v7 offset:6144
    ds_read_b128 v[76:79], v7 offset:7168
    ds_read_b128 v[80:83], v7 offset:8192
    ds_read_b128 v[84:87], v7 offset:9216
    s_xor_b32 s83, s83, 1
    s_barrier
    s_add_u32 s68, s52, 1
    s_cmp_le_u32 s64, s68
    s_cbranch_scc1 KRS_54
KRD_53:
    s_sleep 2
    buffer_load_dwordx4 v[40:43], v3, s[36:39], s59 offen sc1
    buffer_load_dwordx4 v[44:47], v3, s[36:39], s59 offen offset:1024 sc1
    s_sleep 2
    buffer_load_dwordx4 v[104:107], v3, s[36:39], s59 offen sc1
    buffer_load_dwordx4 v[108:111], v3, s[36:39], s59 offen offset:1024 sc1
    s_cmp_ge_u32 s52, 63
    s_cbranch_scc1 CHS_LASTW
    v_mov_b32 v90, s11
    v_mov_b64 v[96:97], 0
    v_mov_b64 v[98:99], 0
    v_mov_b64 v[100:101], 0
    v_mov_b64 v[102:103], 0
    s_branch CHS_LOOP_AGW
.p2align 6
CHS_LOOP_2:
    v_mov_b64 v[36:37], -1
    v_xor_b32 v8, 0x3C000, v8
    v_xor_b32 v9, 0x3C000, v9
    v_add_u32 v2, 0x2000, v2
    v_subrev_u32 v10, 0x6000, v2
    v_min_u32 v2, v2, v10
    s_add_u32 s66, s66, 0x2000
    s_cmp_eq_u32 s66, 0x6000
    s_cselect_b32 s66, 0, s66
    s_add_u32 s59, s66, 114688
    s_add_u32 s61, s61, 0x80000
    s_xor_b32 s62, s62, 0x3C000
    s_add_u32 s63, s63, 0x20000
    s_add_u32 s10, s61, 8192
    s_mov_b32 m0, s62
    s_mov_b32 s11, s52
    s_min_u32 s67, s52, 59
    s_add_u32 s67, s67, 1
    s_add_u32 s67, s67, s12
    s_and_b32 s12, s12, s13
    s_add_u32 s67, s67, s12
    s_and_b32 s12, s12, s14
    s_add_u32 s67, s67, s12
    s_and_b32 s12, s12, s15
    s_add_u32 s67, s67, s12
    s_cmp_ge_u32 s67, 64
    s_cselect_b32 s67, -1, s67
    s_max_u32 s64, s64, s67
    s_add_u32 s52, s52, 1
    s_min_u32 s67, s52, 59
    s_lshl_b32 s67, s67, 2
    s_add_u32 s67, s67, s58
    s_load_dwordx4 s[12:15], s[34:35], s67 glc
    ds_read_b128 v[48:51], v7 offset:0
    ds_read_b128 v[52:55], v7 offset:1024
    ds_read_b128 v[56:59], v7 offset:2048
    ds_read_b128 v[60:63], v7 offset:3072
    ds_read_b128 v[64:67], v7 offset:4096
    ds_read_b128 v[68:71], v7 offset:5120
    ds_read_b128 v[72:75], v7 offset:6144
    ds_read_b128 v[76:79], v7 offset:7168
    ds_read_b128 v[80:83], v7 offset:8192
    ds_read_b128 v[84:87], v7 offset:9216
    buffer_load_dwordx4 v[16:19], v1, s[36:39], s55 offen sc1
    buffer_load_dwordx4 v[20:23], v1, s[36:39], s56 offen sc1
    buffer_load_dwordx4 v[24:27], v1, s[36:39], s4 offen sc1
    buffer_load_dwordx4 v[28:31], v1, s[36:39], s5 offen sc1
    s_sleep 2
    buffer_load_dwordx4 v[96:99], v1, s[36:39], s55 offen sc1
    buffer_load_dwordx4 v[100:103], v1, s[36:39], s56 offen sc1
    buffer_load_dwordx4 v[104:107], v1, s[36:39], s4 offen sc1
    buffer_load_dwordx4 v[108:111], v1, s[36:39], s5 offen sc1
    s_waitcnt vmcnt(7)
    v_mfma_f32_16x16x32_bf16 v[32:35], v[12:15], v[16:19], 0
    v_bitop3_b32 v10, v16, v18, s83 bitop3:0x7e
    s_waitcnt vmcnt(6)
    v_mfma_f32_16x16x32_bf16 v[32:35], v[12:15], v[20:23], v[32:35]
    v_bitop3_b32 v38, v20, v22, s83 bitop3:0x7e
    v_or_b32 v10, v10, v38
    s_waitcnt vmcnt(5)
    v_mfma_f32_16x16x32_bf16 v[32:35], v[12:15], v[24:27], v[32:35]
    v_bitop3_b32 v38, v24, v26, s83 bitop3:0x7e
    v_or_b32 v10, v10, v38
    s_waitcnt vmcnt(4)
    v_mfma_f32_16x16x32_bf16 v[32:35], v[12:15], v[28:31], v[32:35]
    v_bitop3_b32 v38, v28, v30, s83 bitop3:0x7e
    v_or_b32 v10, v10, v38
    v_and_b32 v10, 1, v10
    v_cmp_ne_u32 vcc, 0, v10
    s_cbranch_vccnz P1R_56
P1_55_OK:
    s_xor_b32 s83, s83, 1
    s_nop 1
    v_add_f32_dpp v32, v32, v32 row_ror:8 row_mask:0xf bank_mask:0xf
    v_add_f32_dpp v33, v33, v33 row_ror:8 row_mask:0xf bank_mask:0xf
    v_add_f32_dpp v34, v34, v34 row_ror:8 row_mask:0xf bank_mask:0xf
    v_add_f32_dpp v35, v35, v35 row_ror:8 row_mask:0xf bank_mask:0xf
    s_mov_b64 exec, s[72:73]
    v_cvt_pk_bf16_f32 v36, v32, v33
    v_cvt_pk_bf16_f32 v37, v34, v35
    s_mov_b64 exec, s[74:75]
    buffer_store_dwordx2 v[36:37], v2, s[36:39], s57 offen sc1
    s_mov_b64 exec, -1
    s_barrier
    s_add_u32 s68, s52, 1
    s_cmp_le_u32 s64, s68
    s_cbranch_scc1 KRS_60
KRD_59:
    s_sleep 2
    buffer_load_dwordx4 v[40:43], v3, s[36:39], s59 offen sc1
    buffer_load_dwordx4 v[44:47], v3, s[36:39], s59 offen offset:1024 sc1
    s_sleep 2
    buffer_load_dwordx4 v[104:107], v3, s[36:39], s59 offen sc1
    buffer_load_dwordx4 v[108:111], v3, s[36:39], s59 offen offset:1024 sc1
    s_cmp_ge_u32 s52, 63
    s_cbranch_scc1 CHS_LASTW
    v_mov_b32 v90, s11
    s_waitcnt vmcnt(4)
    v_mov_b64 v[96:97], 0
    v_mov_b64 v[98:99], 0
    v_mov_b64 v[100:101], 0
    v_mov_b64 v[102:103], 0
CHS_LOOP_AGW:
    s_waitcnt vmcnt(2)
    ds_write_b128 v3, v[40:43]
    ds_write_b128 v3, v[44:47] offset:1024
    v_max3_u32 v10, v40, v42, v44
    v_max_u32 v10, v10, v46
    v_cmp_eq_u32 vcc, -1, v10
    s_cbranch_vccnz P2R_58
P2_57_OK:
CHS_ENTRY:
    s_waitcnt lgkmcnt(0)
    s_barrier
    ds_read_b64_tr_b16 v[16:17], v4 offset:0
    ds_read_b64_tr_b16 v[18:19], v4 offset:2048
    ds_read_b64_tr_b16 v[20:21], v4 offset:4096
    ds_read_b64_tr_b16 v[22:23], v4 offset:6144
    ds_read_b64_tr_b16 v[24:25], v4 offset:512
    ds_read_b64_tr_b16 v[26:27], v4 offset:2560
    ds_read_b64_tr_b16 v[28:29], v4 offset:4608
    ds_read_b64_tr_b16 v[30:31], v4 offset:6656
    s_waitcnt lgkmcnt(6)
    v_smfmac_f32_16x16x64_bf16 v[96:99], v[16:19], v[48:55], v0
    ds_read_b64_tr_b16 v[32:33], v4 offset:1024
    buffer_load_dwordx4 v3, s[36:39], s61 offen offset:0 sc1 lds
    v_smfmac_f32_16x16x64_bf16 v[100:103], v[16:19], v[56:63], v0
    ds_read_b64_tr_b16 v[34:35], v4 offset:3072
    s_waitcnt lgkmcnt(6)
    v_smfmac_f32_16x16x64_bf16 v[96:99], v[20:23], v[64:71], v0
    ds_read_b64_tr_b16 v[36:37], v4 offset:5120
    buffer_load_dwordx4 v3, s[36:39], s61 offen offset:1024 sc1 lds
    v_smfmac_f32_16x16x64_bf16 v[100:103], v[20:23], v[72:79], v0
    ds_read_b64_tr_b16 v[38:39], v4 offset:7168
    s_waitcnt lgkmcnt(6)
    v_smfmac_f32_16x16x64_bf16 v[96:99], v[24:27], v[80:87], v0
    s_add_u32 m0, s62, 8192
    s_waitcnt lgkmcnt(4)
    v_smfmac_f32_16x16x64_bf16 v[96:99], v[28:31], a[0:7], v0
    s_waitcnt vmcnt(2)
    ds_read_b64_tr_b16 v[40:41], v4 offset:1536
    v_smfmac_f32_16x16x64_bf16 v[100:103], v[28:31], a[8:15], v0
    ds_read_b64_tr_b16 v[42:43], v4 offset:3584
    s_waitcnt lgkmcnt(4)
    v_smfmac_f32_16x16x64_bf16 v[96:99], v[32:35], a[16:23], v0
    ds_read_b64_tr_b16 v[44:45], v4 offset:5632
    buffer_load_dwordx4 v3, s[36:39], s10 offen offset:0 sc1 lds
    v_smfmac_f32_16x16x64_bf16 v[100:103], v[32:35], a[24:31], v0
    ds_read_b64_tr_b16 v[46:47], v4 offset:7680
    s_waitcnt lgkmcnt(4)
    v_smfmac_f32_16x16x64_bf16 v[96:99], v[36:39], a[32:39], v0
    ds_read_b128 v[48:51], v7 offset:10240
    buffer_load_dwordx4 v3, s[36:39], s10 offen offset:1024 sc1 lds
    v_smfmac_f32_16x16x64_bf16 v[100:103], v[36:39], a[40:47], v0
    ds_read_b128 v[52:55], v7 offset:11264
    s_waitcnt lgkmcnt(4)
    v_mov_b64 v[104:105], 0
    v_smfmac_f32_16x16x64_bf16 v[96:99], v[40:43], a[48:55], v0
    s_mov_b64 exec, s[76:77]
    buffer_store_dword v90, off, s[36:39], s81 sc1
    s_mov_b64 exec, -1
    v_smfmac_f32_16x16x64_bf16 v[100:103], v[40:43], a[56:63], v0
    s_waitcnt lgkmcnt(2)
    v_mov_b64 v[106:107], 0
    v_smfmac_f32_16x16x64_bf16 v[96:99], v[44:47], a[64:71], v0
    buffer_store_dwordx2 v[92:93], v11, s[36:39], s63 offen sc1
    v_mov_b64 v[108:109], 0
    v_smfmac_f32_16x16x64_bf16 v[100:103], v[44:47], a[72:79], v0
    s_waitcnt lgkmcnt(0)
    v_mov_b64 v[110:111], 0
    v_smfmac_f32_16x16x64_bf16 v[100:103], v[24:27], v[48:55], v0
    buffer_store_dwordx2 v[94:95], v11, s[36:39], s63 offen offset:2048 sc1
    v_smfmac_f32_16x16x64_bf16 v[104:107], v[16:19], a[80:87], v0
    v_add_f32 v96, v96, v98
    v_add_f32 v97, v97, v99
    v_smfmac_f32_16x16x64_bf16 v[108:111], v[16:19], a[88:95], v0
    v_cvt_pk_bf16_f32 v90, v96, v97
    v_add_f32 v100, v100, v102
    v_smfmac_f32_16x16x64_bf16 v[104:107], v[20:23], a[96:103], v0
    ds_write2_b32 v6, v90, v90 offset0:0 offset1:1
    v_add_f32 v101, v101, v103
    v_cvt_pk_bf16_f32 v91, v100, v101
    v_smfmac_f32_16x16x64_bf16 v[108:111], v[20:23], a[104:111], v0
    ds_write2_b32 v6, v91, v91 offset0:128 offset1:129
    v_smfmac_f32_16x16x64_bf16 v[104:107], v[24:27], a[112:119], v0
    ds_read_b128 v[64:67], v8 offset:0
    v_add_u32 v10, 4096, v6
    v_smfmac_f32_16x16x64_bf16 v[108:111], v[24:27], a[120:127], v0
    ds_read_b128 v[68:71], v8 offset:4096
    v_smfmac_f32_16x16x64_bf16 v[104:107], v[28:31], a[128:135], v0
    ds_read_b128 v[72:75], v8 offset:1024
    v_smfmac_f32_16x16x64_bf16 v[108:111], v[28:31], a[136:143], v0
    ds_read_b128 v[76:79], v8 offset:5120
    v_smfmac_f32_16x16x64_bf16 v[104:107], v[32:35], a[144:151], v0
    s_waitcnt lgkmcnt(4)
    s_barrier
    v_smfmac_f32_16x16x64_bf16 v[108:111], v[32:35], a[152:159], v0
    ds_read_b64_tr_b16 v[48:49], v4 offset:8192
    ds_read_b64_tr_b16 v[50:51], v4 offset:8704
    v_smfmac_f32_16x16x64_bf16 v[104:107], v[36:39], a[160:167], v0
    ds_read_b64_tr_b16 v[52:53], v4 offset:9216
    ds_read_b64_tr_b16 v[54:55], v4 offset:9728
    v_smfmac_f32_16x16x64_bf16 v[108:111], v[36:39], a[168:175], v0
    ds_read_b128 v[80:83], v8 offset:2048
    v_smfmac_f32_16x16x64_bf16 v[104:107], v[40:43], a[176:183], v0
    ds_read_b64_tr_b16 v[56:57], v4 offset:10240
    ds_read_b128 v[84:87], v8 offset:6144
    v_smfmac_f32_16x16x64_bf16 v[108:111], v[40:43], a[184:191], v0
    ds_read_b64_tr_b16 v[58:59], v4 offset:10752
    ds_read_b64_tr_b16 v[60:61], v4 offset:11264
    v_smfmac_f32_16x16x64_bf16 v[104:107], v[44:47], a[192:199], v0
    ds_read_b64_tr_b16 v[62:63], v4 offset:11776
    v_smfmac_f32_16x16x64_bf16 v[108:111], v[44:47], a[200:207], v0
    s_waitcnt lgkmcnt(6)
    v_mfma_f32_16x16x32_bf16 v[96:99], v[64:67], v[48:51], 0
    ds_read_b128 v[64:67], v8 offset:3072
    v_add_f32 v104, v104, v106
    v_add_f32 v105, v105, v107
    v_mfma_f32_16x16x32_bf16 v[100:103], v[68:71], v[48:51], 0
    ds_read_b128 v[68:71], v8 offset:7168
    v_cvt_pk_bf16_f32 v92, v104, v105
    v_add_f32 v108, v108, v110
    v_mfma_f32_16x16x32_bf16 v[96:99], v[72:75], v[52:55], v[96:99]
    ds_write2_b32 v10, v92, v92 offset0:0 offset1:1
    v_add_f32 v109, v109, v111
    v_cvt_pk_bf16_f32 v93, v108, v109
    v_mfma_f32_16x16x32_bf16 v[100:103], v[76:79], v[52:55], v[100:103]
    s_waitcnt lgkmcnt(3)
    v_mov_b64 v[104:105], 0
    v_mov_b64 v[106:107], 0
    v_mfma_f32_16x16x32_bf16 v[96:99], v[80:83], v[56:59], v[96:99]
    ds_write2_b32 v10, v93, v93 offset0:128 offset1:129
    v_mov_b64 v[108:109], 0
    v_mov_b64 v[110:111], 0
    v_mfma_f32_16x16x32_bf16 v[100:103], v[84:87], v[56:59], v[100:103]
    s_waitcnt lgkmcnt(2)
    v_mfma_f32_16x16x32_bf16 v[96:99], v[64:67], v[60:63], v[96:99]
    v_mfma_f32_16x16x32_bf16 v[100:103], v[68:71], v[60:63], v[100:103]
    v_smfmac_f32_16x16x64_bf16 v[104:107], v[16:19], a[208:215], v0
    v_smfmac_f32_16x16x64_bf16 v[108:111], v[16:19], a[216:223], v0
    v_max3_f32 v68, v96, v97, v98
    v_max3_f32 v69, v100, v101, v102
    v_smfmac_f32_16x16x64_bf16 v[104:107], v[20:23], a[224:231], v0
    v_max3_f32 v68, v68, v99, v103
    v_max_f32 v68, v68, v69
    v_smfmac_f32_16x16x64_bf16 v[108:111], v[20:23], a[232:239], v0
    s_waitcnt lgkmcnt(0)
    s_barrier
    v_smfmac_f32_16x16x64_bf16 v[104:107], v[24:27], a[240:247], v0
    ds_read_b64_tr_b16 v[72:73], v5 offset:12288
    ds_read_b64_tr_b16 v[74:75], v5 offset:12800
    v_smfmac_f32_16x16x64_bf16 v[108:111], v[24:27], a[248:255], v0
    ds_read_b64_tr_b16 v[76:77], v5 offset:13312
    ds_read_b64_tr_b16 v[78:79], v5 offset:13824
    v_smfmac_f32_16x16x64_bf16 v[104:107], v[28:31], v[112:119], v0
    ds_read_b64_tr_b16 v[80:81], v5 offset:14336
    v_smfmac_f32_16x16x64_bf16 v[108:111], v[28:31], v[120:127], v0
    ds_read_b64_tr_b16 v[82:83], v5 offset:14848
    v_smfmac_f32_16x16x64_bf16 v[104:107], v[32:35], v[128:135], v0
    ds_read_b64_tr_b16 v[84:85], v5 offset:15360
    ds_read_b64_tr_b16 v[86:87], v5 offset:15872
    v_smfmac_f32_16x16x64_bf16 v[108:111], v[32:35], v[136:143], v0
    ds_read_b128 v[16:19], v7 offset:12288
    s_waitcnt lgkmcnt(7)
    v_mfma_f32_16x16x32_bf16 v[64:67], v[72:75], v[48:51], 0
    s_waitcnt lgkmcnt(5)
    v_mfma_f32_16x16x32_bf16 v[64:67], v[76:79], v[52:55], v[64:67]
    s_waitcnt lgkmcnt(3)
    v_cndmask_b32 v88, v96, v98, s[78:79]
    v_cndmask_b32 v89, v97, v99, s[78:79]
    v_mfma_f32_16x16x32_bf16 v[64:67], v[80:83], v[56:59], v[64:67]
    s_waitcnt lgkmcnt(1)
    v_cndmask_b32 v90, v100, v102, s[78:79]
    v_cndmask_b32 v91, v101, v103, s[78:79]
    v_mfma_f32_16x16x32_bf16 v[64:67], v[84:87], v[60:63], v[64:67]
    ds_read_b64 v[50:51], v9 offset:0
    v_mov_b64 v[72:73], 0
    v_mov_b64 v[74:75], 0
    v_smfmac_f32_16x16x64_bf16 v[104:107], v[36:39], v[144:151], v0
    ds_read_b64 v[54:55], v9 offset:512
    ds_read_b64 v[58:59], v9 offset:1024
    v_mov_b64 v[76:77], 0
    v_smfmac_f32_16x16x64_bf16 v[108:111], v[36:39], v[152:159], v0
    ds_read_b64 v[62:63], v9 offset:1536
    ds_read_b128 v[20:23], v7 offset:13312
    v_max3_f32 v68, v68, v64, v65
    v_mov_b32 v69, v68
    v_smfmac_f32_16x16x64_bf16 v[104:107], v[40:43], v[160:167], v0
    ds_read_b128 v[24:27], v7 offset:14336
    ds_read_b128 v[28:31], v7 offset:15360
    v_permlane32_swap_b32 v68, v69
    v_max_f32 v68, v68, v69
    v_mov_b32 v69, v68
    v_smfmac_f32_16x16x64_bf16 v[108:111], v[40:43], v[168:175], v0
    ds_read_b128 v[32:35], v7 offset:16384
    ds_read_b128 v[36:39], v7 offset:17408
    v_permlane16_swap_b32 v68, v69
    v_max_f32 v68, v68, v69
    v_smfmac_f32_16x16x64_bf16 v[104:107], v[44:47], v[176:183], v0
    v_mul_f32 v68, s80, v68
    v_smfmac_f32_16x16x64_bf16 v[108:111], v[44:47], v[184:191], v0
    ds_read_b128 v[40:43], v7 offset:18432
    ds_read_b128 v[44:47], v7 offset:19456
    v_mov_b64 v[78:79], 0
    v_mov_b32 v82, 0
    v_mov_b64 v[84:85], s[8:9]
    v_mov_b64 v[86:87], s[8:9]
    v_fma_f32 v64, v64, s80, -v68
    v_fma_f32 v65, v65, s80, -v68
    v_fma_f32 v88, v88, s80, -v68
    v_fma_f32 v89, v89, s80, -v68
    v_fma_f32 v90, v90, s80, -v68
    v_fma_f32 v91, v91, s80, -v68
    v_exp_f32 v64, v64
    v_exp_f32 v65, v65
    v_exp_f32 v88, v88
    v_exp_f32 v89, v89
    v_exp_f32 v90, v90
    v_exp_f32 v91, v91
    v_cvt_pk_bf16_f32 v80, v64, v65
    v_cvt_pk_bf16_f32 v81, v88, v89
    v_cvt_pk_bf16_f32 v83, v90, v91
    v_permlane32_swap_b32 v80, v82
    v_cvt_pk_bf16_f32 v48, v104, v105
    v_cvt_pk_bf16_f32 v49, v106, v107
    v_mfma_f32_16x16x32_bf16 v[68:71], v[80:83], v[84:87], 0
    s_waitcnt lgkmcnt(7)
    v_cvt_pk_bf16_f32 v56, v108, v109
    v_cvt_pk_bf16_f32 v57, v110, v111
    v_smfmac_f32_16x16x64_bf16 v[72:75], v[80:83], v[48:55], v0
    s_nop 0
    v_smfmac_f32_16x16x64_bf16 v[76:79], v[80:83], v[56:63], v0
    v_add_f32 v68, v68, v70
    v_add_f32 v69, v69, v71
    v_rcp_f32 v68, v68
    v_rcp_f32 v69, v69
    v_add_f32 v72, v72, v74
    v_add_f32 v73, v73, v75
    v_mul_f32 v72, v72, v68
    v_mul_f32 v73, v73, v69
    v_add_f32 v76, v76, v78
    v_add_f32 v77, v77, v79
    v_mul_f32 v76, v76, v68
    v_mul_f32 v77, v77, v69
    v_cvt_pk_bf16_f32 v72, v72, v73
    v_cvt_pk_bf16_f32 v73, v76, v77
    ds_write_b64 v6, v[72:73]
    v_mov_b64 v[48:49], 0
    v_mov_b64 v[50:51], 0
    v_pk_add_f32 v[104:105], v[104:105], v[106:107]
    v_cvt_pk_bf16_f32 v94, v104, v105
    v_pk_add_f32 v[108:109], v[108:109], v[110:111]
    v_cvt_pk_bf16_f32 v95, v108, v109
    v_mfma_f32_32x32x16_bf16 v[96:111], v[48:51], v[48:51], 0
    v_mov_b64 v[52:53], 0
    v_mov_b64 v[54:55], 0
    v_mov_b64 v[56:57], 0
    v_mov_b64 v[58:59], 0
    v_mov_b64 v[60:61], 0
    v_mov_b64 v[62:63], 0
    s_waitcnt lgkmcnt(0)
    s_barrier
    ds_read_b64_tr_b16 v[64:65], v4 offset:8192
    ds_read_b64_tr_b16 v[66:67], v4 offset:9216
    ds_read_b64_tr_b16 v[68:69], v4 offset:10240
    ds_read_b64_tr_b16 v[70:71], v4 offset:11264
    s_waitcnt lgkmcnt(2)
    v_smfmac_f32_16x16x64_bf16 v[48:51], v[64:67], v[192:199], v0
    v_smfmac_f32_16x16x64_bf16 v[52:55], v[64:67], v[200:207], v0
    s_waitcnt lgkmcnt(0)
    v_smfmac_f32_16x16x64_bf16 v[48:51], v[68:71], v[16:23], v0
    ds_read_b128 v[16:19], v7 offset:20480
    ds_read_b128 v[20:23], v7 offset:21504
    v_smfmac_f32_16x16x64_bf16 v[52:55], v[68:71], v[24:31], v0
    ds_read_b128 v[24:27], v7 offset:22528
    ds_read_b128 v[28:31], v7 offset:23552
    v_smfmac_f32_16x16x64_bf16 v[56:59], v[64:67], v[208:215], v0
    s_nop 0
    v_add_f32 v48, v48, v50
    v_smfmac_f32_16x16x64_bf16 v[60:63], v[64:67], v[216:223], v0
    v_add_f32 v49, v49, v51
    v_cvt_pk_bf16_f32 v72, v48, v49
    v_smfmac_f32_16x16x64_bf16 v[56:59], v[68:71], v[32:39], v0
    ds_read_b128 v[32:35], v7 offset:24576
    ds_read_b128 v[36:39], v7 offset:25600
    v_add_f32 v52, v52, v54
    v_add_f32 v53, v53, v55
    v_smfmac_f32_16x16x64_bf16 v[60:63], v[68:71], v[40:47], v0
    ds_read_b128 v[40:43], v7 offset:26624
    ds_read_b128 v[44:47], v7 offset:27648
    v_and_or_b32 v72, v72, -2, s83
    v_cvt_pk_bf16_f32 v73, v52, v53
    v_smfmac_f32_16x16x64_bf16 v[96:99], v[64:67], v[224:231], v0
    buffer_store_dwordx2 v[72:73], v11, s[36:39], s53 offen offset:0 sc1
    v_add_f32 v56, v56, v58
    v_add_f32 v57, v57, v59
    v_smfmac_f32_16x16x64_bf16 v[100:103], v[64:67], v[232:239], v0
    s_waitcnt lgkmcnt(6)
    v_cvt_pk_bf16_f32 v74, v56, v57
    v_add_f32 v60, v60, v62
    v_smfmac_f32_16x16x64_bf16 v[96:99], v[68:71], v[16:23], v0
    s_waitcnt lgkmcnt(4)
    v_add_f32 v61, v61, v63
    v_and_or_b32 v74, v74, -2, s83
    v_smfmac_f32_16x16x64_bf16 v[100:103], v[68:71], v[24:31], v0
    v_cvt_pk_bf16_f32 v75, v60, v61
    v_smfmac_f32_16x16x64_bf16 v[104:107], v[64:67], v[240:247], v0
    buffer_store_dwordx2 v[74:75], v11, s[36:39], s53 offen offset:2048 sc1
    v_add_f32 v96, v96, v98
    v_add_f32 v97, v97, v99
    v_smfmac_f32_16x16x64_bf16 v[108:111], v[64:67], v[248:255], v0
    s_waitcnt lgkmcnt(2)
    v_cvt_pk_bf16_f32 v76, v96, v97
    v_add_f32 v100, v100, v102
    v_add_f32 v101, v101, v103
    v_smfmac_f32_16x16x64_bf16 v[104:107], v[68:71], v[32:39], v0
    s_waitcnt lgkmcnt(0)
    v_and_or_b32 v76, v76, -2, s83
    v_cvt_pk_bf16_f32 v77, v100, v101
    v_smfmac_f32_16x16x64_bf16 v[108:111], v[68:71], v[40:47], v0
    buffer_store_dwordx2 v[76:77], v11, s[36:39], s54 offen offset:0 sc1
    s_nop 2
    v_add_f32 v104, v104, v106
    v_add_f32 v105, v105, v107
    v_cvt_pk_bf16_f32 v78, v104, v105
    v_and_or_b32 v78, v78, -2, s83
    v_add_f32 v108, v108, v110
    v_add_f32 v109, v109, v111
    v_cvt_pk_bf16_f32 v79, v108, v109
    buffer_store_dwordx2 v[78:79], v11, s[36:39], s54 offen offset:2048 sc1
    s_cmp_eq_u32 s48, 2
    s_cbranch_scc1 CHS_LOOP_2
    s_cmp_eq_u32 s48, 0
    s_cbranch_scc1 CHS_LOOP_0
    s_cmp_eq_u32 s48, 1
    s_cbranch_scc1 CHS_LOOP_1
    s_branch CHS_LOOP_3
P1R_38:
    s_add_u32 s65, s65, 1
    s_cmp_gt_u32 s65, 262144
    s_cbranch_scc1 P1_37_OK
    s_mov_b64 exec, vcc
    buffer_load_dwordx4 v[16:19], v1, s[36:39], s55 offen sc1
    buffer_load_dwordx4 v[20:23], v1, s[36:39], s56 offen sc1
    buffer_load_dwordx4 v[24:27], v1, s[36:39], s4 offen sc1
    buffer_load_dwordx4 v[28:31], v1, s[36:39], s5 offen sc1
    s_mov_b64 exec, -1
    s_waitcnt vmcnt(3)
    v_mfma_f32_16x16x32_bf16 v[32:35], v[12:15], v[16:19], 0
    v_bitop3_b32 v10, v16, v18, s83 bitop3:0x7e
    s_waitcnt vmcnt(2)
    v_mfma_f32_16x16x32_bf16 v[32:35], v[12:15], v[20:23], v[32:35]
    v_bitop3_b32 v38, v20, v22, s83 bitop3:0x7e
    v_or_b32 v10, v10, v38
    s_waitcnt vmcnt(1)
    v_mfma_f32_16x16x32_bf16 v[32:35], v[12:15], v[24:27], v[32:35]
    v_bitop3_b32 v38, v24, v26, s83 bitop3:0x7e
    v_or_b32 v10, v10, v38
    s_waitcnt vmcnt(0)
    v_mfma_f32_16x16x32_bf16 v[32:35], v[12:15], v[28:31], v[32:35]
    v_bitop3_b32 v38, v28, v30, s83 bitop3:0x7e
    v_or_b32 v10, v10, v38
    v_and_b32 v10, 1, v10
    v_cmp_ne_u32 vcc, 0, v10
    s_cbranch_vccz P1_37_OK
    s_branch P1R_38
KRS_42:
    s_waitcnt vmcnt(0)
    v_mbcnt_lo_u32_b32 v31, -1, 0
    v_mbcnt_hi_u32_b32 v31, -1, v31
    v_lshlrev_b32 v31, 2, v31
KR_61:
    s_lshl_b32 s67, s51, 8
    buffer_load_dword v10, v31, s[36:39], s67 offen sc1
    s_add_u32 s65, s65, 1
    s_waitcnt vmcnt(0)
    v_cmp_eq_u32 vcc, 0, v10
    s_ff1_i32_b64 s64, vcc
    s_cmp_gt_u32 s64, s68
    s_cbranch_scc1 KRD_41
    s_sleep 16
    s_cmp_lt_u32 s65, 262144
    s_cbranch_scc1 KR_61
    s_branch KRD_41
KRS_48:
    s_waitcnt vmcnt(0)
    v_mbcnt_lo_u32_b32 v31, -1, 0
    v_mbcnt_hi_u32_b32 v31, -1, v31
    v_lshlrev_b32 v31, 2, v31
KR_62:
    s_lshl_b32 s67, s51, 8
    buffer_load_dword v10, v31, s[36:39], s67 offen sc1
    s_add_u32 s65, s65, 1
    s_waitcnt vmcnt(0)
    v_cmp_eq_u32 vcc, 0, v10
    s_ff1_i32_b64 s64, vcc
    s_cmp_gt_u32 s64, s68
    s_cbranch_scc1 KRD_47
    s_sleep 16
    s_cmp_lt_u32 s65, 262144
    s_cbranch_scc1 KR_62
    s_branch KRD_47
KRS_54:
    s_waitcnt vmcnt(0)
    v_mbcnt_lo_u32_b32 v31, -1, 0
    v_mbcnt_hi_u32_b32 v31, -1, v31
    v_lshlrev_b32 v31, 2, v31
KR_63:
    s_lshl_b32 s67, s51, 8
    buffer_load_dword v10, v31, s[36:39], s67 offen sc1
    s_add_u32 s65, s65, 1
    s_waitcnt vmcnt(0)
    v_cmp_eq_u32 vcc, 0, v10
    s_ff1_i32_b64 s64, vcc
    s_cmp_gt_u32 s64, s68
    s_cbranch_scc1 KRD_53
    s_sleep 16
    s_cmp_lt_u32 s65, 262144
    s_cbranch_scc1 KR_63
    s_branch KRD_53
P1R_56:
    s_add_u32 s65, s65, 1
    s_cmp_gt_u32 s65, 262144
    s_cbranch_scc1 P1_55_OK
    s_mov_b64 exec, vcc
    buffer_load_dwordx4 v[16:19], v1, s[36:39], s55 offen sc1
    buffer_load_dwordx4 v[20:23], v1, s[36:39], s56 offen sc1
    buffer_load_dwordx4 v[24:27], v1, s[36:39], s4 offen sc1
    buffer_load_dwordx4 v[28:31], v1, s[36:39], s5 offen sc1
    s_mov_b64 exec, -1
    s_waitcnt vmcnt(7)
    v_mfma_f32_16x16x32_bf16 v[32:35], v[12:15], v[96:99], 0
    v_bitop3_b32 v10, v96, v98, s83 bitop3:0x7e
    s_waitcnt vmcnt(6)
    v_mfma_f32_16x16x32_bf16 v[32:35], v[12:15], v[100:103], v[32:35]
    v_bitop3_b32 v38, v100, v102, s83 bitop3:0x7e
    v_or_b32 v10, v10, v38
    s_waitcnt vmcnt(5)
    v_mfma_f32_16x16x32_bf16 v[32:35], v[12:15], v[104:107], v[32:35]
    v_bitop3_b32 v38, v104, v106, s83 bitop3:0x7e
    v_or_b32 v10, v10, v38
    s_waitcnt vmcnt(4)
    v_mfma_f32_16x16x32_bf16 v[32:35], v[12:15], v[108:111], v[32:35]
    v_bitop3_b32 v38, v108, v110, s83 bitop3:0x7e
    v_or_b32 v10, v10, v38
    v_and_b32 v10, 1, v10
    v_cmp_ne_u32 vcc, 0, v10
    s_cbranch_vccz P1_55_OK
    s_add_u32 s65, s65, 1
    s_cmp_gt_u32 s65, 262144
    s_cbranch_scc1 P1_55_OK
    s_mov_b64 exec, vcc
    buffer_load_dwordx4 v[96:99], v1, s[36:39], s55 offen sc1
    buffer_load_dwordx4 v[100:103], v1, s[36:39], s56 offen sc1
    buffer_load_dwordx4 v[104:107], v1, s[36:39], s4 offen sc1
    buffer_load_dwordx4 v[108:111], v1, s[36:39], s5 offen sc1
    s_mov_b64 exec, -1
    s_waitcnt vmcnt(7)
    v_mfma_f32_16x16x32_bf16 v[32:35], v[12:15], v[16:19], 0
    v_bitop3_b32 v10, v16, v18, s83 bitop3:0x7e
    s_waitcnt vmcnt(6)
    v_mfma_f32_16x16x32_bf16 v[32:35], v[12:15], v[20:23], v[32:35]
    v_bitop3_b32 v38, v20, v22, s83 bitop3:0x7e
    v_or_b32 v10, v10, v38
    s_waitcnt vmcnt(5)
    v_mfma_f32_16x16x32_bf16 v[32:35], v[12:15], v[24:27], v[32:35]
    v_bitop3_b32 v38, v24, v26, s83 bitop3:0x7e
    v_or_b32 v10, v10, v38
    s_waitcnt vmcnt(4)
    v_mfma_f32_16x16x32_bf16 v[32:35], v[12:15], v[28:31], v[32:35]
    v_bitop3_b32 v38, v28, v30, s83 bitop3:0x7e
    v_or_b32 v10, v10, v38
    v_and_b32 v10, 1, v10
    v_cmp_ne_u32 vcc, 0, v10
    s_cbranch_vccz P1_55_OK
    s_branch P1R_56
KRS_60:
    s_waitcnt vmcnt(0)
    v_mbcnt_lo_u32_b32 v31, -1, 0
    v_mbcnt_hi_u32_b32 v31, -1, v31
    v_lshlrev_b32 v31, 2, v31
KR_64:
    s_lshl_b32 s67, s51, 8
    buffer_load_dword v10, v31, s[36:39], s67 offen sc1
    s_add_u32 s65, s65, 1
    s_waitcnt vmcnt(0)
    v_cmp_eq_u32 vcc, 0, v10
    s_ff1_i32_b64 s64, vcc
    s_cmp_gt_u32 s64, s68
    s_cbranch_scc1 KRD_59
    s_sleep 16
    s_cmp_lt_u32 s65, 262144
    s_cbranch_scc1 KR_64
    s_branch KRD_59
P2R_58:
    s_add_u32 s65, s65, 1
    s_cmp_gt_u32 s65, 262144
    s_cbranch_scc1 P2_57_OK
    s_mov_b64 exec, vcc
    buffer_load_dwordx4 v[40:43], v3, s[36:39], s59 offen sc1
    buffer_load_dwordx4 v[44:47], v3, s[36:39], s59 offen offset:1024 sc1
    s_mov_b64 exec, -1
    s_waitcnt vmcnt(2)
    ds_write_b128 v3, v[104:107]
    ds_write_b128 v3, v[108:111] offset:1024
    v_max3_u32 v10, v104, v106, v108
    v_max_u32 v10, v10, v110
    v_cmp_eq_u32 vcc, -1, v10
    s_cbranch_vccz P2_57_OK
    s_add_u32 s65, s65, 1
    s_cmp_gt_u32 s65, 262144
    s_cbranch_scc1 P2_57_OK
    s_mov_b64 exec, vcc
    buffer_load_dwordx4 v[104:107], v3, s[36:39], s59 offen sc1
    buffer_load_dwordx4 v[108:111], v3, s[36:39], s59 offen offset:1024 sc1
    s_mov_b64 exec, -1
    s_waitcnt vmcnt(2)
    ds_write_b128 v3, v[40:43]
    ds_write_b128 v3, v[44:47] offset:1024
    v_max3_u32 v10, v40, v42, v44
    v_max_u32 v10, v10, v46
    v_cmp_eq_u32 vcc, -1, v10
    s_cbranch_vccz P2_57_OK
    s_branch P2R_58
CHS_LASTW:
    s_waitcnt vmcnt(0)
    ds_write_b128 v3, v[104:107]
    ds_write_b128 v3, v[108:111] offset:1024
    v_max3_u32 v10, v104, v106, v108
    v_max_u32 v10, v10, v110
    v_cmp_eq_u32 vcc, -1, v10
    s_cbranch_vccz CHS_LASTZ
    s_add_u32 s65, s65, 1
    s_cmp_gt_u32 s65, 262144
    s_cbranch_scc1 CHS_LASTZ
    buffer_load_dwordx4 v[104:107], v3, s[36:39], s59 offen sc1
    buffer_load_dwordx4 v[108:111], v3, s[36:39], s59 offen offset:1024 sc1
    s_branch CHS_LASTW
CHS_LASTZ:
    v_mov_b64 v[96:97], 0
    v_mov_b64 v[98:99], 0
    v_mov_b64 v[100:101], 0
    v_mov_b64 v[102:103], 0
CHS_LAST:
    s_waitcnt vmcnt(0) lgkmcnt(0)
    s_barrier
    ds_read_b64_tr_b16 v[16:17], v4 offset:0
    ds_read_b64_tr_b16 v[18:19], v4 offset:2048
    ds_read_b64_tr_b16 v[20:21], v4 offset:4096
    ds_read_b64_tr_b16 v[22:23], v4 offset:6144
    ds_read_b64_tr_b16 v[24:25], v4 offset:512
    ds_read_b64_tr_b16 v[26:27], v4 offset:2560
    ds_read_b64_tr_b16 v[28:29], v4 offset:4608
    ds_read_b64_tr_b16 v[30:31], v4 offset:6656
    ds_read_b64_tr_b16 v[32:33], v4 offset:1024
    ds_read_b64_tr_b16 v[34:35], v4 offset:3072
    ds_read_b64_tr_b16 v[36:37], v4 offset:5120
    ds_read_b64_tr_b16 v[38:39], v4 offset:7168
    ds_read_b64_tr_b16 v[40:41], v4 offset:1536
    ds_read_b64_tr_b16 v[42:43], v4 offset:3584
    ds_read_b64_tr_b16 v[44:45], v4 offset:5632
    ds_read_b64_tr_b16 v[46:47], v4 offset:7680
    buffer_store_dwordx2 v[92:93], v11, s[36:39], s63 offen sc1
    buffer_store_dwordx2 v[94:95], v11, s[36:39], s63 offen offset:2048 sc1
    s_add_u32 s63, s63, 0x20000
    v_mov_b64 v[104:105], 0
    v_mov_b64 v[106:107], 0
    v_mov_b64 v[108:109], 0
    v_mov_b64 v[110:111], 0
    s_waitcnt lgkmcnt(0)
    v_smfmac_f32_16x16x64_bf16 v[96:99], v[16:19], a[80:87], v0
    v_smfmac_f32_16x16x64_bf16 v[100:103], v[16:19], a[88:95], v0
    v_smfmac_f32_16x16x64_bf16 v[96:99], v[20:23], a[96:103], v0
    v_smfmac_f32_16x16x64_bf16 v[100:103], v[20:23], a[104:111], v0
    v_smfmac_f32_16x16x64_bf16 v[96:99], v[24:27], a[112:119], v0
    v_smfmac_f32_16x16x64_bf16 v[100:103], v[24:27], a[120:127], v0
    v_smfmac_f32_16x16x64_bf16 v[96:99], v[28:31], a[128:135], v0
    v_smfmac_f32_16x16x64_bf16 v[100:103], v[28:31], a[136:143], v0
    v_smfmac_f32_16x16x64_bf16 v[96:99], v[32:35], a[144:151], v0
    v_smfmac_f32_16x16x64_bf16 v[100:103], v[32:35], a[152:159], v0
    v_smfmac_f32_16x16x64_bf16 v[96:99], v[36:39], a[160:167], v0
    v_smfmac_f32_16x16x64_bf16 v[100:103], v[36:39], a[168:175], v0
    v_smfmac_f32_16x16x64_bf16 v[96:99], v[40:43], a[176:183], v0
    v_smfmac_f32_16x16x64_bf16 v[100:103], v[40:43], a[184:191], v0
    v_smfmac_f32_16x16x64_bf16 v[96:99], v[44:47], a[192:199], v0
    v_smfmac_f32_16x16x64_bf16 v[100:103], v[44:47], a[200:207], v0
    v_smfmac_f32_16x16x64_bf16 v[104:107], v[16:19], a[208:215], v0
    v_smfmac_f32_16x16x64_bf16 v[108:111], v[16:19], a[216:223], v0
    v_smfmac_f32_16x16x64_bf16 v[104:107], v[20:23], a[224:231], v0
    v_add_f32 v96, v96, v98
    v_smfmac_f32_16x16x64_bf16 v[108:111], v[20:23], a[232:239], v0
    v_add_f32 v97, v97, v99
    v_smfmac_f32_16x16x64_bf16 v[104:107], v[24:27], a[240:247], v0
    v_cvt_pk_bf16_f32 v92, v96, v97
    v_smfmac_f32_16x16x64_bf16 v[108:111], v[24:27], a[248:255], v0
    v_add_f32 v100, v100, v102
    v_smfmac_f32_16x16x64_bf16 v[104:107], v[28:31], v[112:119], v0
    v_add_f32 v101, v101, v103
    v_smfmac_f32_16x16x64_bf16 v[108:111], v[28:31], v[120:127], v0
    v_cvt_pk_bf16_f32 v93, v100, v101
    v_smfmac_f32_16x16x64_bf16 v[104:107], v[32:35], v[128:135], v0
    buffer_store_dwordx2 v[92:93], v11, s[36:39], s63 offen sc1
    v_smfmac_f32_16x16x64_bf16 v[108:111], v[32:35], v[136:143], v0
    v_smfmac_f32_16x16x64_bf16 v[104:107], v[36:39], v[144:151], v0
    v_smfmac_f32_16x16x64_bf16 v[108:111], v[36:39], v[152:159], v0
    v_smfmac_f32_16x16x64_bf16 v[104:107], v[40:43], v[160:167], v0
    v_smfmac_f32_16x16x64_bf16 v[108:111], v[40:43], v[168:175], v0
    v_smfmac_f32_16x16x64_bf16 v[104:107], v[44:47], v[176:183], v0
    v_smfmac_f32_16x16x64_bf16 v[108:111], v[44:47], v[184:191], v0
    s_nop 7
    v_pk_add_f32 v[104:105], v[104:105], v[106:107]
    v_cvt_pk_bf16_f32 v94, v104, v105
    v_pk_add_f32 v[108:109], v[108:109], v[110:111]
    v_cvt_pk_bf16_f32 v95, v108, v109
    buffer_store_dwordx2 v[94:95], v11, s[36:39], s63 offen offset:2048 sc1
    s_waitcnt vmcnt(0) lgkmcnt(0)
    s_barrier
    v_mov_b32 v10, 64
    s_mov_b64 exec, s[76:77]
    buffer_store_dword v10, off, s[36:39], s81 sc1
    s_branch KEND
WORKER:
    s_sub_u32 s52, s50, 1
    s_mov_b32 s54, 0
    v_mov_b32 v15, v2
    v_and_b32 v1, 15, v0
    v_lshrrev_b32 v2, 4, v0
    v_lshlrev_b32 v3, 4, v0
    v_mov_b32 v5, v3
    s_lshr_b32 s67, s48, 1
    s_lshl_b32 s67, s67, 14
    s_and_b32 s68, s48, 1
    s_lshl_b32 s68, s68, 9
    s_add_u32 s67, s67, s68
    v_lshlrev_b32 v4, 10, v1
    v_lshl_add_u32 v4, v2, 4, v4
    v_add_u32 v4, s67, v4
    s_mov_b32 s84, s4
    s_mov_b32 s85, s5
    s_mov_b32 s86, 2097152
    s_mov_b32 s87, 0x20000
    s_cmp_lt_u32 s52, 3
    s_cbranch_scc1 PF_E
    s_lshl_b32 s68, s52, 5
    s_add_u32 s68, s68, s51
    v_lshlrev_b32 v16, 6, v15
    s_sub_u32 s68, s68, 96
    s_lshl_b32 s67, s68, 14
    v_add_u32 v17, s67, v16
    v_add_u32 v18, 0x200000, v17
    global_load_dword v248, v18, s[20:21]
    global_load_dword v249, v17, s[20:21]
    global_load_dword v250, v17, s[22:23]
    global_load_dword v251, v18, s[22:23]
    global_load_dword v248, v17, s[24:25]
    global_load_dword v249, v18, s[24:25]
    global_load_dword v250, v17, s[26:27]
    global_load_dword v251, v18, s[26:27]
PF_E:
    s_cmp_lt_u32 s52, 3
    s_cbranch_scc1 CV_END
    s_sub_u32 s58, s52, 3
    s_lshl_b32 s58, s58, 5
    s_add_u32 s58, s58, s51
    s_mov_b32 s40, s6
    s_mov_b32 s41, s7
    s_mov_b32 s42, 2097152
    s_mov_b32 s43, 0x20000
    s_mov_b32 s44, s8
    s_mov_b32 s45, s9
    s_mov_b32 s46, 2097152
    s_mov_b32 s47, 0x20000
    s_lshl_b32 s67, s48, 6
    v_add_u32 v16, s67, v0
    s_lshl_b32 s67, s58, 3
    v_lshlrev_b32 v17, 13, v16
    v_add_u32 v17, s67, v17
    v_subrev_u32 v18, 3072, v17
    buffer_load_dwordx2 v[32:33], v18, s[40:43], 0 offen offset:0
    buffer_load_dwordx2 v[34:35], v18, s[40:43], 0 offen offset:1024
    buffer_load_dwordx2 v[36:37], v18, s[40:43], 0 offen offset:2048
    v_add_u32 v19, 4096, v17
    buffer_load_dwordx2 v[38:39], v17, s[40:43], 0 offen offset:0
    buffer_load_dwordx2 v[56:57], v17, s[44:47], 0 offen offset:0
    buffer_load_dwordx2 v[40:41], v17, s[40:43], 0 offen offset:1024
    buffer_load_dwordx2 v[58:59], v17, s[44:47], 0 offen offset:1024
    buffer_load_dwordx2 v[42:43], v17, s[40:43], 0 offen offset:2048
    buffer_load_dwordx2 v[60:61], v17, s[44:47], 0 offen offset:2048
    buffer_load_dwordx2 v[44:45], v17, s[40:43], 0 offen offset:3072
    buffer_load_dwordx2 v[62:63], v17, s[44:47], 0 offen offset:3072
    buffer_load_dwordx2 v[46:47], v19, s[40:43], 0 offen offset:0
    buffer_load_dwordx2 v[64:65], v19, s[44:47], 0 offen offset:0
    buffer_load_dwordx2 v[48:49], v19, s[40:43], 0 offen offset:1024
    buffer_load_dwordx2 v[66:67], v19, s[44:47], 0 offen offset:1024
    buffer_load_dwordx2 v[50:51], v19, s[40:43], 0 offen offset:2048
    buffer_load_dwordx2 v[68:69], v19, s[44:47], 0 offen offset:2048
    buffer_load_dwordx2 v[52:53], v19, s[40:43], 0 offen offset:3072
    buffer_load_dwordx2 v[70:71], v19, s[44:47], 0 offen offset:3072
    s_lshl_b32 s68, s58, 2
    s_add_u32 s68, s68, s48
    s_lshl_b32 s56, s68, 12
    s_mul_i32 s55, s48, 16640
    s_add_u32 s55, s55, 32768
    s_add_u32 s88, s12, s56
    s_addc_u32 s89, s13, 0
    s_mov_b32 s90, 4096
    s_mov_b32 s91, 0x20000
    v_add_u32 v22, -64, v3
    v_add_u32 v23, -48, v3
    buffer_load_dwordx4 v[140:143], v22, s[88:91], 0 offen
    buffer_load_dwordx2 v[144:145], v23, s[88:91], 0 offen
    v_add_u32 v22, 960, v3
    v_add_u32 v23, 976, v3
    buffer_load_dwordx4 v[146:149], v22, s[88:91], 0 offen
    buffer_load_dwordx2 v[150:151], v23, s[88:91], 0 offen
    v_add_u32 v22, 1984, v3
    v_add_u32 v23, 2000, v3
    buffer_load_dwordx4 v[152:155], v22, s[88:91], 0 offen
    buffer_load_dwordx2 v[156:157], v23, s[88:91], 0 offen
    v_add_u32 v22, 3008, v3
    v_add_u32 v23, 3024, v3
    buffer_load_dwordx4 v[158:161], v22, s[88:91], 0 offen
    buffer_load_dwordx2 v[162:163], v23, s[88:91], 0 offen
    v_add_u32 v22, 4032, v3
    v_add_u32 v23, 4048, v3
    buffer_load_dwordx4 v[164:167], v22, s[88:91], 0 offen
    buffer_load_dwordx2 v[168:169], v23, s[88:91], 0 offen
    s_lshl_b32 s67, s58, 5
    s_load_dwordx8 s[92:99], s[10:11], s67
    s_lshl_b32 s67, s68, 1
    s_and_b32 s67, s67, -4
    s_load_dword s54, s[14:15], s67
    v_mov_b64 v[24:25], 0
    v_mov_b64 v[26:27], 0
    s_mul_i32 s57, s48, 7680
    v_add_u32 v20, s57, v3
    ds_write_b128 v20, v[24:27] offset:5120
    ds_write_b128 v20, v[24:27] offset:6144
    s_mov_b32 exec_hi, 0
    ds_write_b128 v20, v[24:27] offset:7168
    s_mov_b64 exec, -1
    v_lshlrev_b32 v20, 3, v16
    v_sub_u32 v20, 2040, v20
    v_lshrrev_b32 v21, 5, v20
    v_and_b32 v20, 31, v20
    v_mul_u32_u24 v21, 80, v21
    v_lshl_add_u32 v20, v20, 1, v21
    s_waitcnt vmcnt(10) lgkmcnt(0)
    v_cmp_eq_u32 vcc, 0, v16
    s_nop 1
    v_cndmask_b32 v32, v32, v24, vcc
    v_cndmask_b32 v33, v33, v24, vcc
    v_cndmask_b32 v34, v34, v24, vcc
    v_cndmask_b32 v35, v35, v24, vcc
    v_cndmask_b32 v36, v36, v24, vcc
    v_cndmask_b32 v37, v37, v24, vcc
    s_lshl_b32 s70, s92, 16
    s_and_b32 s71, s92, 0xffff0000
    s_lshl_b32 s72, s93, 16
    s_and_b32 s73, s93, 0xffff0000
    v_lshlrev_b32 v120, 16, v32
    v_lshlrev_b32 v121, 16, v34
    v_lshlrev_b32 v122, 16, v36
    v_lshlrev_b32 v123, 16, v38
    v_lshlrev_b32 v124, 16, v40
    v_lshlrev_b32 v125, 16, v42
    v_lshlrev_b32 v126, 16, v44
    v_lshlrev_b32 v127, 16, v46
    v_lshlrev_b32 v128, 16, v48
    v_lshlrev_b32 v129, 16, v50
    v_lshlrev_b32 v130, 16, v52
    v_mul_f32 v88, s73, v120
    v_mul_f32 v89, s73, v121
    v_cvt_pk_bf16_f32 v92, v88, v89
    v_lshlrev_b32 v88, 16, v92
    v_and_b32 v89, 0xffff0000, v92
    v_mul_f32 v90, s72, v121
    v_mul_f32 v91, s72, v122
    v_cvt_pk_bf16_f32 v92, v90, v91
    v_lshlrev_b32 v90, 16, v92
    v_and_b32 v91, 0xffff0000, v92
    v_add_f32 v88, v88, v90
    v_add_f32 v89, v89, v91
    v_cvt_pk_bf16_f32 v92, v88, v89
    v_lshlrev_b32 v88, 16, v92
    v_and_b32 v89, 0xffff0000, v92
    v_mul_f32 v90, s71, v122
    v_mul_f32 v91, s71, v123
    v_cvt_pk_bf16_f32 v92, v90, v91
    v_lshlrev_b32 v90, 16, v92
    v_and_b32 v91, 0xffff0000, v92
    v_add_f32 v88, v88, v90
    v_add_f32 v89, v89, v91
    v_cvt_pk_bf16_f32 v92, v88, v89
    v_lshlrev_b32 v88, 16, v92
    v_and_b32 v89, 0xffff0000, v92
    v_mul_f32 v90, s70, v123
    v_mul_f32 v91, s70, v124
    v_cvt_pk_bf16_f32 v92, v90, v91
    v_lshlrev_b32 v90, 16, v92
    v_and_b32 v91, 0xffff0000, v92
    v_add_f32 v88, v88, v90
    v_add_f32 v89, v89, v91
    v_cvt_pk_bf16_f32 v92, v88, v89
    v_lshlrev_b32 v88, 16, v92
    v_and_b32 v89, 0xffff0000, v92
    v_lshlrev_b32 v90, 16, v56
    v_lshlrev_b32 v91, 16, v58
    v_mul_f32 v88, v88, v90
    v_mul_f32 v89, v89, v91
    v_cvt_pk_bf16_f32 v115, v89, v88
    v_mul_f32 v88, s73, v122
    v_mul_f32 v89, s73, v123
    v_cvt_pk_bf16_f32 v92, v88, v89
    v_lshlrev_b32 v88, 16, v92
    v_and_b32 v89, 0xffff0000, v92
    v_mul_f32 v90, s72, v123
    v_mul_f32 v91, s72, v124
    v_cvt_pk_bf16_f32 v92, v90, v91
    v_lshlrev_b32 v90, 16, v92
    v_and_b32 v91, 0xffff0000, v92
    v_add_f32 v88, v88, v90
    v_add_f32 v89, v89, v91
    v_cvt_pk_bf16_f32 v92, v88, v89
    v_lshlrev_b32 v88, 16, v92
    v_and_b32 v89, 0xffff0000, v92
    v_mul_f32 v90, s71, v124
    v_mul_f32 v91, s71, v125
    v_cvt_pk_bf16_f32 v92, v90, v91
    v_lshlrev_b32 v90, 16, v92
    v_and_b32 v91, 0xffff0000, v92
    v_add_f32 v88, v88, v90
    v_add_f32 v89, v89, v91
    v_cvt_pk_bf16_f32 v92, v88, v89
    v_lshlrev_b32 v88, 16, v92
    v_and_b32 v89, 0xffff0000, v92
    v_mul_f32 v90, s70, v125
    v_mul_f32 v91, s70, v126
    v_cvt_pk_bf16_f32 v92, v90, v91
    v_lshlrev_b32 v90, 16, v92
    v_and_b32 v91, 0xffff0000, v92
    v_add_f32 v88, v88, v90
    v_add_f32 v89, v89, v91
    v_cvt_pk_bf16_f32 v92, v88, v89
    v_lshlrev_b32 v88, 16, v92
    v_and_b32 v89, 0xffff0000, v92
    v_lshlrev_b32 v90, 16, v60
    v_lshlrev_b32 v91, 16, v62
    v_mul_f32 v88, v88, v90
    v_mul_f32 v89, v89, v91
    v_cvt_pk_bf16_f32 v114, v89, v88
    v_mul_f32 v88, s73, v124
    v_mul_f32 v89, s73, v125
    v_cvt_pk_bf16_f32 v92, v88, v89
    v_lshlrev_b32 v88, 16, v92
    v_and_b32 v89, 0xffff0000, v92
    v_mul_f32 v90, s72, v125
    v_mul_f32 v91, s72, v126
    v_cvt_pk_bf16_f32 v92, v90, v91
    v_lshlrev_b32 v90, 16, v92
    v_and_b32 v91, 0xffff0000, v92
    v_add_f32 v88, v88, v90
    v_add_f32 v89, v89, v91
    v_cvt_pk_bf16_f32 v92, v88, v89
    v_lshlrev_b32 v88, 16, v92
    v_and_b32 v89, 0xffff0000, v92
    v_mul_f32 v90, s71, v126
    v_mul_f32 v91, s71, v127
    v_cvt_pk_bf16_f32 v92, v90, v91
    v_lshlrev_b32 v90, 16, v92
    v_and_b32 v91, 0xffff0000, v92
    v_add_f32 v88, v88, v90
    v_add_f32 v89, v89, v91
    v_cvt_pk_bf16_f32 v92, v88, v89
    v_lshlrev_b32 v88, 16, v92
    v_and_b32 v89, 0xffff0000, v92
    v_mul_f32 v90, s70, v127
    v_mul_f32 v91, s70, v128
    v_cvt_pk_bf16_f32 v92, v90, v91
    v_lshlrev_b32 v90, 16, v92
    v_and_b32 v91, 0xffff0000, v92
    v_add_f32 v88, v88, v90
    v_add_f32 v89, v89, v91
    v_cvt_pk_bf16_f32 v92, v88, v89
    v_lshlrev_b32 v88, 16, v92
    v_and_b32 v89, 0xffff0000, v92
    v_lshlrev_b32 v90, 16, v64
    v_lshlrev_b32 v91, 16, v66
    v_mul_f32 v88, v88, v90
    v_mul_f32 v89, v89, v91
    v_cvt_pk_bf16_f32 v113, v89, v88
    v_mul_f32 v88, s73, v126
    v_mul_f32 v89, s73, v127
    v_cvt_pk_bf16_f32 v92, v88, v89
    v_lshlrev_b32 v88, 16, v92
    v_and_b32 v89, 0xffff0000, v92
    v_mul_f32 v90, s72, v127
    v_mul_f32 v91, s72, v128
    v_cvt_pk_bf16_f32 v92, v90, v91
    v_lshlrev_b32 v90, 16, v92
    v_and_b32 v91, 0xffff0000, v92
    v_add_f32 v88, v88, v90
    v_add_f32 v89, v89, v91
    v_cvt_pk_bf16_f32 v92, v88, v89
    v_lshlrev_b32 v88, 16, v92
    v_and_b32 v89, 0xffff0000, v92
    v_mul_f32 v90, s71, v128
    v_mul_f32 v91, s71, v129
    v_cvt_pk_bf16_f32 v92, v90, v91
    v_lshlrev_b32 v90, 16, v92
    v_and_b32 v91, 0xffff0000, v92
    v_add_f32 v88, v88, v90
    v_add_f32 v89, v89, v91
    v_cvt_pk_bf16_f32 v92, v88, v89
    v_lshlrev_b32 v88, 16, v92
    v_and_b32 v89, 0xffff0000, v92
    v_mul_f32 v90, s70, v129
    v_mul_f32 v91, s70, v130
    v_cvt_pk_bf16_f32 v92, v90, v91
    v_lshlrev_b32 v90, 16, v92
    v_and_b32 v91, 0xffff0000, v92
    v_add_f32 v88, v88, v90
    v_add_f32 v89, v89, v91
    v_cvt_pk_bf16_f32 v92, v88, v89
    v_lshlrev_b32 v88, 16, v92
    v_and_b32 v89, 0xffff0000, v92
    v_lshlrev_b32 v90, 16, v68
    v_lshlrev_b32 v91, 16, v70
    v_mul_f32 v88, v88, v90
    v_mul_f32 v89, v89, v91
    v_cvt_pk_bf16_f32 v112, v89, v88
    ds_write_b128 v20, v[112:115] offset:0
    s_nop 1
    s_lshl_b32 s70, s94, 16
    s_and_b32 s71, s94, 0xffff0000
    s_lshl_b32 s72, s95, 16
    s_and_b32 s73, s95, 0xffff0000
    v_and_b32 v120, 0xffff0000, v32
    v_and_b32 v121, 0xffff0000, v34
    v_and_b32 v122, 0xffff0000, v36
    v_and_b32 v123, 0xffff0000, v38
    v_and_b32 v124, 0xffff0000, v40
    v_and_b32 v125, 0xffff0000, v42
    v_and_b32 v126, 0xffff0000, v44
    v_and_b32 v127, 0xffff0000, v46
    v_and_b32 v128, 0xffff0000, v48
    v_and_b32 v129, 0xffff0000, v50
    v_and_b32 v130, 0xffff0000, v52
    v_mul_f32 v88, s73, v120
    v_mul_f32 v89, s73, v121
    v_cvt_pk_bf16_f32 v92, v88, v89
    v_lshlrev_b32 v88, 16, v92
    v_and_b32 v89, 0xffff0000, v92
    v_mul_f32 v90, s72, v121
    v_mul_f32 v91, s72, v122
    v_cvt_pk_bf16_f32 v92, v90, v91
    v_lshlrev_b32 v90, 16, v92
    v_and_b32 v91, 0xffff0000, v92
    v_add_f32 v88, v88, v90
    v_add_f32 v89, v89, v91
    v_cvt_pk_bf16_f32 v92, v88, v89
    v_lshlrev_b32 v88, 16, v92
    v_and_b32 v89, 0xffff0000, v92
    v_mul_f32 v90, s71, v122
    v_mul_f32 v91, s71, v123
    v_cvt_pk_bf16_f32 v92, v90, v91
    v_lshlrev_b32 v90, 16, v92
    v_and_b32 v91, 0xffff0000, v92
    v_add_f32 v88, v88, v90
    v_add_f32 v89, v89, v91
    v_cvt_pk_bf16_f32 v92, v88, v89
    v_lshlrev_b32 v88, 16, v92
    v_and_b32 v89, 0xffff0000, v92
    v_mul_f32 v90, s70, v123
    v_mul_f32 v91, s70, v124
    v_cvt_pk_bf16_f32 v92, v90, v91
    v_lshlrev_b32 v90, 16, v92
    v_and_b32 v91, 0xffff0000, v92
    v_add_f32 v88, v88, v90
    v_add_f32 v89, v89, v91
    v_cvt_pk_bf16_f32 v92, v88, v89
    v_lshlrev_b32 v88, 16, v92
    v_and_b32 v89, 0xffff0000, v92
    v_and_b32 v90, 0xffff0000, v56
    v_and_b32 v91, 0xffff0000, v58
    v_mul_f32 v88, v88, v90
    v_mul_f32 v89, v89, v91
    v_cvt_pk_bf16_f32 v115, v89, v88
    v_mul_f32 v88, s73, v122
    v_mul_f32 v89, s73, v123
    v_cvt_pk_bf16_f32 v92, v88, v89
    v_lshlrev_b32 v88, 16, v92
    v_and_b32 v89, 0xffff0000, v92
    v_mul_f32 v90, s72, v123
    v_mul_f32 v91, s72, v124
    v_cvt_pk_bf16_f32 v92, v90, v91
    v_lshlrev_b32 v90, 16, v92
    v_and_b32 v91, 0xffff0000, v92
    v_add_f32 v88, v88, v90
    v_add_f32 v89, v89, v91
    v_cvt_pk_bf16_f32 v92, v88, v89
    v_lshlrev_b32 v88, 16, v92
    v_and_b32 v89, 0xffff0000, v92
    v_mul_f32 v90, s71, v124
    v_mul_f32 v91, s71, v125
    v_cvt_pk_bf16_f32 v92, v90, v91
    v_lshlrev_b32 v90, 16, v92
    v_and_b32 v91, 0xffff0000, v92
    v_add_f32 v88, v88, v90
    v_add_f32 v89, v89, v91
    v_cvt_pk_bf16_f32 v92, v88, v89
    v_lshlrev_b32 v88, 16, v92
    v_and_b32 v89, 0xffff0000, v92
    v_mul_f32 v90, s70, v125
    v_mul_f32 v91, s70, v126
    v_cvt_pk_bf16_f32 v92, v90, v91
    v_lshlrev_b32 v90, 16, v92
    v_and_b32 v91, 0xffff0000, v92
    v_add_f32 v88, v88, v90
    v_add_f32 v89, v89, v91
    v_cvt_pk_bf16_f32 v92, v88, v89
    v_lshlrev_b32 v88, 16, v92
    v_and_b32 v89, 0xffff0000, v92
    v_and_b32 v90, 0xffff0000, v60
    v_and_b32 v91, 0xffff0000, v62
    v_mul_f32 v88, v88, v90
    v_mul_f32 v89, v89, v91
    v_cvt_pk_bf16_f32 v114, v89, v88
    v_mul_f32 v88, s73, v124
    v_mul_f32 v89, s73, v125
    v_cvt_pk_bf16_f32 v92, v88, v89
    v_lshlrev_b32 v88, 16, v92
    v_and_b32 v89, 0xffff0000, v92
    v_mul_f32 v90, s72, v125
    v_mul_f32 v91, s72, v126
    v_cvt_pk_bf16_f32 v92, v90, v91
    v_lshlrev_b32 v90, 16, v92
    v_and_b32 v91, 0xffff0000, v92
    v_add_f32 v88, v88, v90
    v_add_f32 v89, v89, v91
    v_cvt_pk_bf16_f32 v92, v88, v89
    v_lshlrev_b32 v88, 16, v92
    v_and_b32 v89, 0xffff0000, v92
    v_mul_f32 v90, s71, v126
    v_mul_f32 v91, s71, v127
    v_cvt_pk_bf16_f32 v92, v90, v91
    v_lshlrev_b32 v90, 16, v92
    v_and_b32 v91, 0xffff0000, v92
    v_add_f32 v88, v88, v90
    v_add_f32 v89, v89, v91
    v_cvt_pk_bf16_f32 v92, v88, v89
    v_lshlrev_b32 v88, 16, v92
    v_and_b32 v89, 0xffff0000, v92
    v_mul_f32 v90, s70, v127
    v_mul_f32 v91, s70, v128
    v_cvt_pk_bf16_f32 v92, v90, v91
    v_lshlrev_b32 v90, 16, v92
    v_and_b32 v91, 0xffff0000, v92
    v_add_f32 v88, v88, v90
    v_add_f32 v89, v89, v91
    v_cvt_pk_bf16_f32 v92, v88, v89
    v_lshlrev_b32 v88, 16, v92
    v_and_b32 v89, 0xffff0000, v92
    v_and_b32 v90, 0xffff0000, v64
    v_and_b32 v91, 0xffff0000, v66
    v_mul_f32 v88, v88, v90
    v_mul_f32 v89, v89, v91
    v_cvt_pk_bf16_f32 v113, v89, v88
    v_mul_f32 v88, s73, v126
    v_mul_f32 v89, s73, v127
    v_cvt_pk_bf16_f32 v92, v88, v89
    v_lshlrev_b32 v88, 16, v92
    v_and_b32 v89, 0xffff0000, v92
    v_mul_f32 v90, s72, v127
    v_mul_f32 v91, s72, v128
    v_cvt_pk_bf16_f32 v92, v90, v91
    v_lshlrev_b32 v90, 16, v92
    v_and_b32 v91, 0xffff0000, v92
    v_add_f32 v88, v88, v90
    v_add_f32 v89, v89, v91
    v_cvt_pk_bf16_f32 v92, v88, v89
    v_lshlrev_b32 v88, 16, v92
    v_and_b32 v89, 0xffff0000, v92
    v_mul_f32 v90, s71, v128
    v_mul_f32 v91, s71, v129
    v_cvt_pk_bf16_f32 v92, v90, v91
    v_lshlrev_b32 v90, 16, v92
    v_and_b32 v91, 0xffff0000, v92
    v_add_f32 v88, v88, v90
    v_add_f32 v89, v89, v91
    v_cvt_pk_bf16_f32 v92, v88, v89
    v_lshlrev_b32 v88, 16, v92
    v_and_b32 v89, 0xffff0000, v92
    v_mul_f32 v90, s70, v129
    v_mul_f32 v91, s70, v130
    v_cvt_pk_bf16_f32 v92, v90, v91
    v_lshlrev_b32 v90, 16, v92
    v_and_b32 v91, 0xffff0000, v92
    v_add_f32 v88, v88, v90
    v_add_f32 v89, v89, v91
    v_cvt_pk_bf16_f32 v92, v88, v89
    v_lshlrev_b32 v88, 16, v92
    v_and_b32 v89, 0xffff0000, v92
    v_and_b32 v90, 0xffff0000, v68
    v_and_b32 v91, 0xffff0000, v70
    v_mul_f32 v88, v88, v90
    v_mul_f32 v89, v89, v91
    v_cvt_pk_bf16_f32 v112, v89, v88
    ds_write_b128 v20, v[112:115] offset:7680
    s_nop 1
    s_lshl_b32 s70, s96, 16
    s_and_b32 s71, s96, 0xffff0000
    s_lshl_b32 s72, s97, 16
    s_and_b32 s73, s97, 0xffff0000
    v_lshlrev_b32 v120, 16, v33
    v_lshlrev_b32 v121, 16, v35
    v_lshlrev_b32 v122, 16, v37
    v_lshlrev_b32 v123, 16, v39
    v_lshlrev_b32 v124, 16, v41
    v_lshlrev_b32 v125, 16, v43
    v_lshlrev_b32 v126, 16, v45
    v_lshlrev_b32 v127, 16, v47
    v_lshlrev_b32 v128, 16, v49
    v_lshlrev_b32 v129, 16, v51
    v_lshlrev_b32 v130, 16, v53
    v_mul_f32 v88, s73, v120
    v_mul_f32 v89, s73, v121
    v_cvt_pk_bf16_f32 v92, v88, v89
    v_lshlrev_b32 v88, 16, v92
    v_and_b32 v89, 0xffff0000, v92
    v_mul_f32 v90, s72, v121
    v_mul_f32 v91, s72, v122
    v_cvt_pk_bf16_f32 v92, v90, v91
    v_lshlrev_b32 v90, 16, v92
    v_and_b32 v91, 0xffff0000, v92
    v_add_f32 v88, v88, v90
    v_add_f32 v89, v89, v91
    v_cvt_pk_bf16_f32 v92, v88, v89
    v_lshlrev_b32 v88, 16, v92
    v_and_b32 v89, 0xffff0000, v92
    v_mul_f32 v90, s71, v122
    v_mul_f32 v91, s71, v123
    v_cvt_pk_bf16_f32 v92, v90, v91
    v_lshlrev_b32 v90, 16, v92
    v_and_b32 v91, 0xffff0000, v92
    v_add_f32 v88, v88, v90
    v_add_f32 v89, v89, v91
    v_cvt_pk_bf16_f32 v92, v88, v89
    v_lshlrev_b32 v88, 16, v92
    v_and_b32 v89, 0xffff0000, v92
    v_mul_f32 v90, s70, v123
    v_mul_f32 v91, s70, v124
    v_cvt_pk_bf16_f32 v92, v90, v91
    v_lshlrev_b32 v90, 16, v92
    v_and_b32 v91, 0xffff0000, v92
    v_add_f32 v88, v88, v90
    v_add_f32 v89, v89, v91
    v_cvt_pk_bf16_f32 v92, v88, v89
    v_lshlrev_b32 v88, 16, v92
    v_and_b32 v89, 0xffff0000, v92
    v_lshlrev_b32 v90, 16, v57
    v_lshlrev_b32 v91, 16, v59
    v_mul_f32 v88, v88, v90
    v_mul_f32 v89, v89, v91
    v_cvt_pk_bf16_f32 v115, v89, v88
    v_mul_f32 v88, s73, v122
    v_mul_f32 v89, s73, v123
    v_cvt_pk_bf16_f32 v92, v88, v89
    v_lshlrev_b32 v88, 16, v92
    v_and_b32 v89, 0xffff0000, v92
    v_mul_f32 v90, s72, v123
    v_mul_f32 v91, s72, v124
    v_cvt_pk_bf16_f32 v92, v90, v91
    v_lshlrev_b32 v90, 16, v92
    v_and_b32 v91, 0xffff0000, v92
    v_add_f32 v88, v88, v90
    v_add_f32 v89, v89, v91
    v_cvt_pk_bf16_f32 v92, v88, v89
    v_lshlrev_b32 v88, 16, v92
    v_and_b32 v89, 0xffff0000, v92
    v_mul_f32 v90, s71, v124
    v_mul_f32 v91, s71, v125
    v_cvt_pk_bf16_f32 v92, v90, v91
    v_lshlrev_b32 v90, 16, v92
    v_and_b32 v91, 0xffff0000, v92
    v_add_f32 v88, v88, v90
    v_add_f32 v89, v89, v91
    v_cvt_pk_bf16_f32 v92, v88, v89
    v_lshlrev_b32 v88, 16, v92
    v_and_b32 v89, 0xffff0000, v92
    v_mul_f32 v90, s70, v125
    v_mul_f32 v91, s70, v126
    v_cvt_pk_bf16_f32 v92, v90, v91
    v_lshlrev_b32 v90, 16, v92
    v_and_b32 v91, 0xffff0000, v92
    v_add_f32 v88, v88, v90
    v_add_f32 v89, v89, v91
    v_cvt_pk_bf16_f32 v92, v88, v89
    v_lshlrev_b32 v88, 16, v92
    v_and_b32 v89, 0xffff0000, v92
    v_lshlrev_b32 v90, 16, v61
    v_lshlrev_b32 v91, 16, v63
    v_mul_f32 v88, v88, v90
    v_mul_f32 v89, v89, v91
    v_cvt_pk_bf16_f32 v114, v89, v88
    v_mul_f32 v88, s73, v124
    v_mul_f32 v89, s73, v125
    v_cvt_pk_bf16_f32 v92, v88, v89
    v_lshlrev_b32 v88, 16, v92
    v_and_b32 v89, 0xffff0000, v92
    v_mul_f32 v90, s72, v125
    v_mul_f32 v91, s72, v126
    v_cvt_pk_bf16_f32 v92, v90, v91
    v_lshlrev_b32 v90, 16, v92
    v_and_b32 v91, 0xffff0000, v92
    v_add_f32 v88, v88, v90
    v_add_f32 v89, v89, v91
    v_cvt_pk_bf16_f32 v92, v88, v89
    v_lshlrev_b32 v88, 16, v92
    v_and_b32 v89, 0xffff0000, v92
    v_mul_f32 v90, s71, v126
    v_mul_f32 v91, s71, v127
    v_cvt_pk_bf16_f32 v92, v90, v91
    v_lshlrev_b32 v90, 16, v92
    v_and_b32 v91, 0xffff0000, v92
    v_add_f32 v88, v88, v90
    v_add_f32 v89, v89, v91
    v_cvt_pk_bf16_f32 v92, v88, v89
    v_lshlrev_b32 v88, 16, v92
    v_and_b32 v89, 0xffff0000, v92
    v_mul_f32 v90, s70, v127
    v_mul_f32 v91, s70, v128
    v_cvt_pk_bf16_f32 v92, v90, v91
    v_lshlrev_b32 v90, 16, v92
    v_and_b32 v91, 0xffff0000, v92
    v_add_f32 v88, v88, v90
    v_add_f32 v89, v89, v91
    v_cvt_pk_bf16_f32 v92, v88, v89
    v_lshlrev_b32 v88, 16, v92
    v_and_b32 v89, 0xffff0000, v92
    v_lshlrev_b32 v90, 16, v65
    v_lshlrev_b32 v91, 16, v67
    v_mul_f32 v88, v88, v90
    v_mul_f32 v89, v89, v91
    v_cvt_pk_bf16_f32 v113, v89, v88
    v_mul_f32 v88, s73, v126
    v_mul_f32 v89, s73, v127
    v_cvt_pk_bf16_f32 v92, v88, v89
    v_lshlrev_b32 v88, 16, v92
    v_and_b32 v89, 0xffff0000, v92
    v_mul_f32 v90, s72, v127
    v_mul_f32 v91, s72, v128
    v_cvt_pk_bf16_f32 v92, v90, v91
    v_lshlrev_b32 v90, 16, v92
    v_and_b32 v91, 0xffff0000, v92
    v_add_f32 v88, v88, v90
    v_add_f32 v89, v89, v91
    v_cvt_pk_bf16_f32 v92, v88, v89
    v_lshlrev_b32 v88, 16, v92
    v_and_b32 v89, 0xffff0000, v92
    v_mul_f32 v90, s71, v128
    v_mul_f32 v91, s71, v129
    v_cvt_pk_bf16_f32 v92, v90, v91
    v_lshlrev_b32 v90, 16, v92
    v_and_b32 v91, 0xffff0000, v92
    v_add_f32 v88, v88, v90
    v_add_f32 v89, v89, v91
    v_cvt_pk_bf16_f32 v92, v88, v89
    v_lshlrev_b32 v88, 16, v92
    v_and_b32 v89, 0xffff0000, v92
    v_mul_f32 v90, s70, v129
    v_mul_f32 v91, s70, v130
    v_cvt_pk_bf16_f32 v92, v90, v91
    v_lshlrev_b32 v90, 16, v92
    v_and_b32 v91, 0xffff0000, v92
    v_add_f32 v88, v88, v90
    v_add_f32 v89, v89, v91
    v_cvt_pk_bf16_f32 v92, v88, v89
    v_lshlrev_b32 v88, 16, v92
    v_and_b32 v89, 0xffff0000, v92
    v_lshlrev_b32 v90, 16, v69
    v_lshlrev_b32 v91, 16, v71
    v_mul_f32 v88, v88, v90
    v_mul_f32 v89, v89, v91
    v_cvt_pk_bf16_f32 v112, v89, v88
    ds_write_b128 v20, v[112:115] offset:15360
    s_nop 1
    s_lshl_b32 s70, s98, 16
    s_and_b32 s71, s98, 0xffff0000
    s_lshl_b32 s72, s99, 16
    s_and_b32 s73, s99, 0xffff0000
    v_and_b32 v120, 0xffff0000, v33
    v_and_b32 v121, 0xffff0000, v35
    v_and_b32 v122, 0xffff0000, v37
    v_and_b32 v123, 0xffff0000, v39
    v_and_b32 v124, 0xffff0000, v41
    v_and_b32 v125, 0xffff0000, v43
    v_and_b32 v126, 0xffff0000, v45
    v_and_b32 v127, 0xffff0000, v47
    v_and_b32 v128, 0xffff0000, v49
    v_and_b32 v129, 0xffff0000, v51
    v_and_b32 v130, 0xffff0000, v53
    v_mul_f32 v88, s73, v120
    v_mul_f32 v89, s73, v121
    v_cvt_pk_bf16_f32 v92, v88, v89
    v_lshlrev_b32 v88, 16, v92
    v_and_b32 v89, 0xffff0000, v92
    v_mul_f32 v90, s72, v121
    v_mul_f32 v91, s72, v122
    v_cvt_pk_bf16_f32 v92, v90, v91
    v_lshlrev_b32 v90, 16, v92
    v_and_b32 v91, 0xffff0000, v92
    v_add_f32 v88, v88, v90
    v_add_f32 v89, v89, v91
    v_cvt_pk_bf16_f32 v92, v88, v89
    v_lshlrev_b32 v88, 16, v92
    v_and_b32 v89, 0xffff0000, v92
    v_mul_f32 v90, s71, v122
    v_mul_f32 v91, s71, v123
    v_cvt_pk_bf16_f32 v92, v90, v91
    v_lshlrev_b32 v90, 16, v92
    v_and_b32 v91, 0xffff0000, v92
    v_add_f32 v88, v88, v90
    v_add_f32 v89, v89, v91
    v_cvt_pk_bf16_f32 v92, v88, v89
    v_lshlrev_b32 v88, 16, v92
    v_and_b32 v89, 0xffff0000, v92
    v_mul_f32 v90, s70, v123
    v_mul_f32 v91, s70, v124
    v_cvt_pk_bf16_f32 v92, v90, v91
    v_lshlrev_b32 v90, 16, v92
    v_and_b32 v91, 0xffff0000, v92
    v_add_f32 v88, v88, v90
    v_add_f32 v89, v89, v91
    v_cvt_pk_bf16_f32 v92, v88, v89
    v_lshlrev_b32 v88, 16, v92
    v_and_b32 v89, 0xffff0000, v92
    v_and_b32 v90, 0xffff0000, v57
    v_and_b32 v91, 0xffff0000, v59
    v_mul_f32 v88, v88, v90
    v_mul_f32 v89, v89, v91
    v_cvt_pk_bf16_f32 v115, v89, v88
    v_mul_f32 v88, s73, v122
    v_mul_f32 v89, s73, v123
    v_cvt_pk_bf16_f32 v92, v88, v89
    v_lshlrev_b32 v88, 16, v92
    v_and_b32 v89, 0xffff0000, v92
    v_mul_f32 v90, s72, v123
    v_mul_f32 v91, s72, v124
    v_cvt_pk_bf16_f32 v92, v90, v91
    v_lshlrev_b32 v90, 16, v92
    v_and_b32 v91, 0xffff0000, v92
    v_add_f32 v88, v88, v90
    v_add_f32 v89, v89, v91
    v_cvt_pk_bf16_f32 v92, v88, v89
    v_lshlrev_b32 v88, 16, v92
    v_and_b32 v89, 0xffff0000, v92
    v_mul_f32 v90, s71, v124
    v_mul_f32 v91, s71, v125
    v_cvt_pk_bf16_f32 v92, v90, v91
    v_lshlrev_b32 v90, 16, v92
    v_and_b32 v91, 0xffff0000, v92
    v_add_f32 v88, v88, v90
    v_add_f32 v89, v89, v91
    v_cvt_pk_bf16_f32 v92, v88, v89
    v_lshlrev_b32 v88, 16, v92
    v_and_b32 v89, 0xffff0000, v92
    v_mul_f32 v90, s70, v125
    v_mul_f32 v91, s70, v126
    v_cvt_pk_bf16_f32 v92, v90, v91
    v_lshlrev_b32 v90, 16, v92
    v_and_b32 v91, 0xffff0000, v92
    v_add_f32 v88, v88, v90
    v_add_f32 v89, v89, v91
    v_cvt_pk_bf16_f32 v92, v88, v89
    v_lshlrev_b32 v88, 16, v92
    v_and_b32 v89, 0xffff0000, v92
    v_and_b32 v90, 0xffff0000, v61
    v_and_b32 v91, 0xffff0000, v63
    v_mul_f32 v88, v88, v90
    v_mul_f32 v89, v89, v91
    v_cvt_pk_bf16_f32 v114, v89, v88
    v_mul_f32 v88, s73, v124
    v_mul_f32 v89, s73, v125
    v_cvt_pk_bf16_f32 v92, v88, v89
    v_lshlrev_b32 v88, 16, v92
    v_and_b32 v89, 0xffff0000, v92
    v_mul_f32 v90, s72, v125
    v_mul_f32 v91, s72, v126
    v_cvt_pk_bf16_f32 v92, v90, v91
    v_lshlrev_b32 v90, 16, v92
    v_and_b32 v91, 0xffff0000, v92
    v_add_f32 v88, v88, v90
    v_add_f32 v89, v89, v91
    v_cvt_pk_bf16_f32 v92, v88, v89
    v_lshlrev_b32 v88, 16, v92
    v_and_b32 v89, 0xffff0000, v92
    v_mul_f32 v90, s71, v126
    v_mul_f32 v91, s71, v127
    v_cvt_pk_bf16_f32 v92, v90, v91
    v_lshlrev_b32 v90, 16, v92
    v_and_b32 v91, 0xffff0000, v92
    v_add_f32 v88, v88, v90
    v_add_f32 v89, v89, v91
    v_cvt_pk_bf16_f32 v92, v88, v89
    v_lshlrev_b32 v88, 16, v92
    v_and_b32 v89, 0xffff0000, v92
    v_mul_f32 v90, s70, v127
    v_mul_f32 v91, s70, v128
    v_cvt_pk_bf16_f32 v92, v90, v91
    v_lshlrev_b32 v90, 16, v92
    v_and_b32 v91, 0xffff0000, v92
    v_add_f32 v88, v88, v90
    v_add_f32 v89, v89, v91
    v_cvt_pk_bf16_f32 v92, v88, v89
    v_lshlrev_b32 v88, 16, v92
    v_and_b32 v89, 0xffff0000, v92
    v_and_b32 v90, 0xffff0000, v65
    v_and_b32 v91, 0xffff0000, v67
    v_mul_f32 v88, v88, v90
    v_mul_f32 v89, v89, v91
    v_cvt_pk_bf16_f32 v113, v89, v88
    v_mul_f32 v88, s73, v126
    v_mul_f32 v89, s73, v127
    v_cvt_pk_bf16_f32 v92, v88, v89
    v_lshlrev_b32 v88, 16, v92
    v_and_b32 v89, 0xffff0000, v92
    v_mul_f32 v90, s72, v127
    v_mul_f32 v91, s72, v128
    v_cvt_pk_bf16_f32 v92, v90, v91
    v_lshlrev_b32 v90, 16, v92
    v_and_b32 v91, 0xffff0000, v92
    v_add_f32 v88, v88, v90
    v_add_f32 v89, v89, v91
    v_cvt_pk_bf16_f32 v92, v88, v89
    v_lshlrev_b32 v88, 16, v92
    v_and_b32 v89, 0xffff0000, v92
    v_mul_f32 v90, s71, v128
    v_mul_f32 v91, s71, v129
    v_cvt_pk_bf16_f32 v92, v90, v91
    v_lshlrev_b32 v90, 16, v92
    v_and_b32 v91, 0xffff0000, v92
    v_add_f32 v88, v88, v90
    v_add_f32 v89, v89, v91
    v_cvt_pk_bf16_f32 v92, v88, v89
    v_lshlrev_b32 v88, 16, v92
    v_and_b32 v89, 0xffff0000, v92
    v_mul_f32 v90, s70, v129
    v_mul_f32 v91, s70, v130
    v_cvt_pk_bf16_f32 v92, v90, v91
    v_lshlrev_b32 v90, 16, v92
    v_and_b32 v91, 0xffff0000, v92
    v_add_f32 v88, v88, v90
    v_add_f32 v89, v89, v91
    v_cvt_pk_bf16_f32 v92, v88, v89
    v_lshlrev_b32 v88, 16, v92
    v_and_b32 v89, 0xffff0000, v92
    v_and_b32 v90, 0xffff0000, v69
    v_and_b32 v91, 0xffff0000, v71
    v_mul_f32 v88, v88, v90
    v_mul_f32 v89, v89, v91
    v_cvt_pk_bf16_f32 v112, v89, v88
    ds_write_b128 v20, v[112:115] offset:23040
    s_nop 1
    s_waitcnt vmcnt(0)
    v_add_u32 v22, s55, v3
    v_alignbyte_b32 v88, v141, v140, 2
    v_alignbyte_b32 v89, v142, v141, 2
    v_alignbyte_b32 v90, v143, v142, 2
    v_alignbyte_b32 v91, v144, v143, 2
    v_alignbyte_b32 v92, v142, v141, 2
    v_alignbyte_b32 v93, v143, v142, 2
    v_alignbyte_b32 v94, v144, v143, 2
    v_alignbyte_b32 v95, v145, v144, 2
    v_mov_b32 v96, v141
    v_mov_b32 v97, v142
    v_mov_b32 v98, v143
    v_mov_b32 v99, v144
    ds_write_b128 v22, v[140:143] offset:0
    ds_write_b128 v22, v[88:91] offset:4160
    ds_write_b128 v22, v[96:99] offset:8320
    ds_write_b128 v22, v[92:95] offset:12480
    s_waitcnt lgkmcnt(0)
    v_alignbyte_b32 v88, v147, v146, 2
    v_alignbyte_b32 v89, v148, v147, 2
    v_alignbyte_b32 v90, v149, v148, 2
    v_alignbyte_b32 v91, v150, v149, 2
    v_alignbyte_b32 v92, v148, v147, 2
    v_alignbyte_b32 v93, v149, v148, 2
    v_alignbyte_b32 v94, v150, v149, 2
    v_alignbyte_b32 v95, v151, v150, 2
    v_mov_b32 v96, v147
    v_mov_b32 v97, v148
    v_mov_b32 v98, v149
    v_mov_b32 v99, v150
    ds_write_b128 v22, v[146:149] offset:1024
    ds_write_b128 v22, v[88:91] offset:5184
    ds_write_b128 v22, v[96:99] offset:9344
    ds_write_b128 v22, v[92:95] offset:13504
    s_waitcnt lgkmcnt(0)
    v_alignbyte_b32 v88, v153, v152, 2
    v_alignbyte_b32 v89, v154, v153, 2
    v_alignbyte_b32 v90, v155, v154, 2
    v_alignbyte_b32 v91, v156, v155, 2
    v_alignbyte_b32 v92, v154, v153, 2
    v_alignbyte_b32 v93, v155, v154, 2
    v_alignbyte_b32 v94, v156, v155, 2
    v_alignbyte_b32 v95, v157, v156, 2
    v_mov_b32 v96, v153
    v_mov_b32 v97, v154
    v_mov_b32 v98, v155
    v_mov_b32 v99, v156
    ds_write_b128 v22, v[152:155] offset:2048
    ds_write_b128 v22, v[88:91] offset:6208
    ds_write_b128 v22, v[96:99] offset:10368
    ds_write_b128 v22, v[92:95] offset:14528
    s_waitcnt lgkmcnt(0)
    v_alignbyte_b32 v88, v159, v158, 2
    v_alignbyte_b32 v89, v160, v159, 2
    v_alignbyte_b32 v90, v161, v160, 2
    v_alignbyte_b32 v91, v162, v161, 2
    v_alignbyte_b32 v92, v160, v159, 2
    v_alignbyte_b32 v93, v161, v160, 2
    v_alignbyte_b32 v94, v162, v161, 2
    v_alignbyte_b32 v95, v163, v162, 2
    v_mov_b32 v96, v159
    v_mov_b32 v97, v160
    v_mov_b32 v98, v161
    v_mov_b32 v99, v162
    ds_write_b128 v22, v[158:161] offset:3072
    ds_write_b128 v22, v[88:91] offset:7232
    ds_write_b128 v22, v[96:99] offset:11392
    ds_write_b128 v22, v[92:95] offset:15552
    s_waitcnt lgkmcnt(0)
    s_mov_b64 exec, 15
    v_alignbyte_b32 v88, v165, v164, 2
    v_alignbyte_b32 v89, v166, v165, 2
    v_alignbyte_b32 v90, v167, v166, 2
    v_alignbyte_b32 v91, v168, v167, 2
    v_alignbyte_b32 v92, v166, v165, 2
    v_alignbyte_b32 v93, v167, v166, 2
    v_alignbyte_b32 v94, v168, v167, 2
    v_alignbyte_b32 v95, v169, v168, 2
    v_mov_b32 v96, v165
    v_mov_b32 v97, v166
    v_mov_b32 v98, v167
    v_mov_b32 v99, v168
    ds_write_b128 v22, v[164:167] offset:4096
    ds_write_b128 v22, v[88:91] offset:8256
    ds_write_b128 v22, v[96:99] offset:12416
    ds_write_b128 v22, v[92:95] offset:16576
    s_waitcnt lgkmcnt(0)
    s_mov_b64 exec, -1
    s_barrier
    v_and_b32 v16, 31, v0
    v_lshrrev_b32 v17, 5, v0
    v_lshl_add_u32 v18, v17, 3, v16
    v_add_u32 v18, 1, v18
    v_and_b32 v19, 3, v18
    v_and_b32 v18, -4, v18
    v_mul_u32_u24 v19, 4160, v19
    v_lshl_add_u32 v18, v18, 1, v19
    v_add_u32 v18, s55, v18
    v_sub_u32 v19, 63, v16
    v_mul_u32_u24 v19, 80, v19
    v_lshl_add_u32 v19, v17, 4, v19
    v_add_u32 v19, s57, v19
    v_subrev_u32 v21, 2560, v19
    ds_read_b64 v[64:65], v18 offset:0
    ds_read_b64 v[66:67], v18 offset:8
    ds_read_b128 v[68:71], v19 offset:0
    ds_read_b128 v[72:75], v21 offset:0
    ds_read_b64 v[76:77], v18 offset:2048
    ds_read_b64 v[78:79], v18 offset:2056
    ds_read_b64 v[80:81], v18 offset:32
    ds_read_b64 v[82:83], v18 offset:40
    ds_read_b128 v[84:87], v19 offset:32
    ds_read_b128 v[88:91], v21 offset:32
    ds_read_b64 v[92:93], v18 offset:2080
    ds_read_b64 v[94:95], v18 offset:2088
    s_waitcnt lgkmcnt(6)
    v_mfma_f32_32x32x16_bf16 v[32:47], v[64:67], v[68:71], 0
    ds_read_b64 v[96:97], v18 offset:64
    ds_read_b64 v[98:99], v18 offset:72
    ds_read_b128 v[100:103], v19 offset:80
    ds_read_b128 v[104:107], v21 offset:80
    ds_read_b64 v[108:109], v18 offset:2112
    ds_read_b64 v[110:111], v18 offset:2120
    v_mfma_f32_32x32x16_bf16 v[48:63], v[64:67], v[72:75], 0
    v_mfma_f32_32x32x16_bf16 v[48:63], v[76:79], v[68:71], v[48:63]
    s_waitcnt lgkmcnt(6)
    v_mfma_f32_32x32x16_bf16 v[32:47], v[80:83], v[84:87], v[32:47]
    ds_read_b64 v[64:65], v18 offset:96
    ds_read_b64 v[66:67], v18 offset:104
    ds_read_b128 v[68:71], v19 offset:112
    ds_read_b128 v[72:75], v21 offset:112
    ds_read_b64 v[76:77], v18 offset:2144
    ds_read_b64 v[78:79], v18 offset:2152
    v_mfma_f32_32x32x16_bf16 v[48:63], v[80:83], v[88:91], v[48:63]
    v_mfma_f32_32x32x16_bf16 v[48:63], v[92:95], v[84:87], v[48:63]
    s_waitcnt lgkmcnt(6)
    v_mfma_f32_32x32x16_bf16 v[32:47], v[96:99], v[100:103], v[32:47]
    ds_read_b64 v[80:81], v18 offset:128
    ds_read_b64 v[82:83], v18 offset:136
    ds_read_b128 v[84:87], v19 offset:160
    ds_read_b128 v[88:91], v21 offset:160
    ds_read_b64 v[92:93], v18 offset:2176
    ds_read_b64 v[94:95], v18 offset:2184
    v_mfma_f32_32x32x16_bf16 v[48:63], v[96:99], v[104:107], v[48:63]
    v_mfma_f32_32x32x16_bf16 v[48:63], v[108:111], v[100:103], v[48:63]
    s_waitcnt lgkmcnt(6)
    v_mfma_f32_32x32x16_bf16 v[32:47], v[64:67], v[68:71], v[32:47]
    ds_read_b64 v[96:97], v18 offset:160
    ds_read_b64 v[98:99], v18 offset:168
    ds_read_b128 v[100:103], v19 offset:192
    ds_read_b128 v[104:107], v21 offset:192
    ds_read_b64 v[108:109], v18 offset:2208
    ds_read_b64 v[110:111], v18 offset:2216
    v_mfma_f32_32x32x16_bf16 v[48:63], v[64:67], v[72:75], v[48:63]
    v_mfma_f32_32x32x16_bf16 v[48:63], v[76:79], v[68:71], v[48:63]
    s_waitcnt lgkmcnt(6)
    v_mfma_f32_32x32x16_bf16 v[32:47], v[80:83], v[84:87], v[32:47]
    ds_read_b64 v[64:65], v18 offset:192
    ds_read_b64 v[66:67], v18 offset:200
    ds_read_b128 v[68:71], v19 offset:240
    ds_read_b128 v[72:75], v21 offset:240
    ds_read_b64 v[76:77], v18 offset:2240
    ds_read_b64 v[78:79], v18 offset:2248
    v_mfma_f32_32x32x16_bf16 v[48:63], v[80:83], v[88:91], v[48:63]
    v_mfma_f32_32x32x16_bf16 v[48:63], v[92:95], v[84:87], v[48:63]
    s_waitcnt lgkmcnt(6)
    v_mfma_f32_32x32x16_bf16 v[32:47], v[96:99], v[100:103], v[32:47]
    ds_read_b64 v[80:81], v18 offset:224
    ds_read_b64 v[82:83], v18 offset:232
    ds_read_b128 v[84:87], v19 offset:272
    ds_read_b128 v[88:91], v21 offset:272
    ds_read_b64 v[92:93], v18 offset:2272
    ds_read_b64 v[94:95], v18 offset:2280
    v_mfma_f32_32x32x16_bf16 v[48:63], v[96:99], v[104:107], v[48:63]
    v_mfma_f32_32x32x16_bf16 v[48:63], v[108:111], v[100:103], v[48:63]
    s_waitcnt lgkmcnt(6)
    v_mfma_f32_32x32x16_bf16 v[32:47], v[64:67], v[68:71], v[32:47]
    ds_read_b64 v[96:97], v18 offset:256
    ds_read_b64 v[98:99], v18 offset:264
    ds_read_b128 v[100:103], v19 offset:320
    ds_read_b128 v[104:107], v21 offset:320
    ds_read_b64 v[108:109], v18 offset:2304
    ds_read_b64 v[110:111], v18 offset:2312
    v_mfma_f32_32x32x16_bf16 v[48:63], v[64:67], v[72:75], v[48:63]
    v_mfma_f32_32x32x16_bf16 v[48:63], v[76:79], v[68:71], v[48:63]
    s_waitcnt lgkmcnt(6)
    v_mfma_f32_32x32x16_bf16 v[32:47], v[80:83], v[84:87], v[32:47]
    ds_read_b64 v[64:65], v18 offset:288
    ds_read_b64 v[66:67], v18 offset:296
    ds_read_b128 v[68:71], v19 offset:352
    ds_read_b128 v[72:75], v21 offset:352
    ds_read_b64 v[76:77], v18 offset:2336
    ds_read_b64 v[78:79], v18 offset:2344
    v_mfma_f32_32x32x16_bf16 v[48:63], v[80:83], v[88:91], v[48:63]
    v_mfma_f32_32x32x16_bf16 v[48:63], v[92:95], v[84:87], v[48:63]
    s_waitcnt lgkmcnt(6)
    v_mfma_f32_32x32x16_bf16 v[32:47], v[96:99], v[100:103], v[32:47]
    ds_read_b64 v[80:81], v18 offset:320
    ds_read_b64 v[82:83], v18 offset:328
    ds_read_b128 v[84:87], v19 offset:400
    ds_read_b128 v[88:91], v21 offset:400
    ds_read_b64 v[92:93], v18 offset:2368
    ds_read_b64 v[94:95], v18 offset:2376
    v_mfma_f32_32x32x16_bf16 v[48:63], v[96:99], v[104:107], v[48:63]
    v_mfma_f32_32x32x16_bf16 v[48:63], v[108:111], v[100:103], v[48:63]
    s_waitcnt lgkmcnt(6)
    v_mfma_f32_32x32x16_bf16 v[32:47], v[64:67], v[68:71], v[32:47]
    ds_read_b64 v[96:97], v18 offset:352
    ds_read_b64 v[98:99], v18 offset:360
    ds_read_b128 v[100:103], v19 offset:432
    ds_read_b128 v[104:107], v21 offset:432
    ds_read_b64 v[108:109], v18 offset:2400
    ds_read_b64 v[110:111], v18 offset:2408
    v_mfma_f32_32x32x16_bf16 v[48:63], v[64:67], v[72:75], v[48:63]
    v_mfma_f32_32x32x16_bf16 v[48:63], v[76:79], v[68:71], v[48:63]
    s_waitcnt lgkmcnt(6)
    v_mfma_f32_32x32x16_bf16 v[32:47], v[80:83], v[84:87], v[32:47]
    ds_read_b64 v[64:65], v18 offset:384
    ds_read_b64 v[66:67], v18 offset:392
    ds_read_b128 v[68:71], v19 offset:480
    ds_read_b128 v[72:75], v21 offset:480
    ds_read_b64 v[76:77], v18 offset:2432
    ds_read_b64 v[78:79], v18 offset:2440
    v_mfma_f32_32x32x16_bf16 v[48:63], v[80:83], v[88:91], v[48:63]
    v_mfma_f32_32x32x16_bf16 v[48:63], v[92:95], v[84:87], v[48:63]
    s_waitcnt lgkmcnt(6)
    v_mfma_f32_32x32x16_bf16 v[32:47], v[96:99], v[100:103], v[32:47]
    ds_read_b64 v[80:81], v18 offset:416
    ds_read_b64 v[82:83], v18 offset:424
    ds_read_b128 v[84:87], v19 offset:512
    ds_read_b128 v[88:91], v21 offset:512
    ds_read_b64 v[92:93], v18 offset:2464
    ds_read_b64 v[94:95], v18 offset:2472
    v_mfma_f32_32x32x16_bf16 v[48:63], v[96:99], v[104:107], v[48:63]
    v_mfma_f32_32x32x16_bf16 v[48:63], v[108:111], v[100:103], v[48:63]
    s_waitcnt lgkmcnt(6)
    v_mfma_f32_32x32x16_bf16 v[32:47], v[64:67], v[68:71], v[32:47]
    ds_read_b64 v[96:97], v18 offset:448
    ds_read_b64 v[98:99], v18 offset:456
    ds_read_b128 v[100:103], v19 offset:560
    ds_read_b128 v[104:107], v21 offset:560
    ds_read_b64 v[108:109], v18 offset:2496
    ds_read_b64 v[110:111], v18 offset:2504
    v_mfma_f32_32x32x16_bf16 v[48:63], v[64:67], v[72:75], v[48:63]
    v_mfma_f32_32x32x16_bf16 v[48:63], v[76:79], v[68:71], v[48:63]
    s_waitcnt lgkmcnt(6)
    v_mfma_f32_32x32x16_bf16 v[32:47], v[80:83], v[84:87], v[32:47]
    ds_read_b64 v[64:65], v18 offset:480
    ds_read_b64 v[66:67], v18 offset:488
    ds_read_b128 v[68:71], v19 offset:592
    ds_read_b128 v[72:75], v21 offset:592
    ds_read_b64 v[76:77], v18 offset:2528
    ds_read_b64 v[78:79], v18 offset:2536
    v_mfma_f32_32x32x16_bf16 v[48:63], v[80:83], v[88:91], v[48:63]
    v_mfma_f32_32x32x16_bf16 v[48:63], v[92:95], v[84:87], v[48:63]
    s_waitcnt lgkmcnt(6)
    v_mfma_f32_32x32x16_bf16 v[32:47], v[96:99], v[100:103], v[32:47]
    ds_read_b64 v[80:81], v18 offset:512
    ds_read_b64 v[82:83], v18 offset:520
    ds_read_b128 v[84:87], v19 offset:640
    ds_read_b128 v[88:91], v21 offset:640
    ds_read_b64 v[92:93], v18 offset:2560
    ds_read_b64 v[94:95], v18 offset:2568
    v_mfma_f32_32x32x16_bf16 v[48:63], v[96:99], v[104:107], v[48:63]
    v_mfma_f32_32x32x16_bf16 v[48:63], v[108:111], v[100:103], v[48:63]
    s_waitcnt lgkmcnt(6)
    v_mfma_f32_32x32x16_bf16 v[32:47], v[64:67], v[68:71], v[32:47]
    ds_read_b64 v[96:97], v18 offset:544
    ds_read_b64 v[98:99], v18 offset:552
    ds_read_b128 v[100:103], v19 offset:672
    ds_read_b128 v[104:107], v21 offset:672
    ds_read_b64 v[108:109], v18 offset:2592
    ds_read_b64 v[110:111], v18 offset:2600
    v_mfma_f32_32x32x16_bf16 v[48:63], v[64:67], v[72:75], v[48:63]
    v_mfma_f32_32x32x16_bf16 v[48:63], v[76:79], v[68:71], v[48:63]
    s_waitcnt lgkmcnt(6)
    v_mfma_f32_32x32x16_bf16 v[32:47], v[80:83], v[84:87], v[32:47]
    ds_read_b64 v[64:65], v18 offset:576
    ds_read_b64 v[66:67], v18 offset:584
    ds_read_b128 v[68:71], v19 offset:720
    ds_read_b128 v[72:75], v21 offset:720
    ds_read_b64 v[76:77], v18 offset:2624
    ds_read_b64 v[78:79], v18 offset:2632
    v_mfma_f32_32x32x16_bf16 v[48:63], v[80:83], v[88:91], v[48:63]
    v_mfma_f32_32x32x16_bf16 v[48:63], v[92:95], v[84:87], v[48:63]
    s_waitcnt lgkmcnt(6)
    v_mfma_f32_32x32x16_bf16 v[32:47], v[96:99], v[100:103], v[32:47]
    ds_read_b64 v[80:81], v18 offset:608
    ds_read_b64 v[82:83], v18 offset:616
    ds_read_b128 v[84:87], v19 offset:752
    ds_read_b128 v[88:91], v21 offset:752
    ds_read_b64 v[92:93], v18 offset:2656
    ds_read_b64 v[94:95], v18 offset:2664
    v_mfma_f32_32x32x16_bf16 v[48:63], v[96:99], v[104:107], v[48:63]
    v_mfma_f32_32x32x16_bf16 v[48:63], v[108:111], v[100:103], v[48:63]
    s_waitcnt lgkmcnt(6)
    v_mfma_f32_32x32x16_bf16 v[32:47], v[64:67], v[68:71], v[32:47]
    ds_read_b64 v[96:97], v18 offset:640
    ds_read_b64 v[98:99], v18 offset:648
    ds_read_b128 v[100:103], v19 offset:800
    ds_read_b128 v[104:107], v21 offset:800
    ds_read_b64 v[108:109], v18 offset:2688
    ds_read_b64 v[110:111], v18 offset:2696
    v_mfma_f32_32x32x16_bf16 v[48:63], v[64:67], v[72:75], v[48:63]
    v_mfma_f32_32x32x16_bf16 v[48:63], v[76:79], v[68:71], v[48:63]
    s_waitcnt lgkmcnt(6)
    v_mfma_f32_32x32x16_bf16 v[32:47], v[80:83], v[84:87], v[32:47]
    ds_read_b64 v[64:65], v18 offset:672
    ds_read_b64 v[66:67], v18 offset:680
    ds_read_b128 v[68:71], v19 offset:832
    ds_read_b128 v[72:75], v21 offset:832
    ds_read_b64 v[76:77], v18 offset:2720
    ds_read_b64 v[78:79], v18 offset:2728
    v_mfma_f32_32x32x16_bf16 v[48:63], v[80:83], v[88:91], v[48:63]
    v_mfma_f32_32x32x16_bf16 v[48:63], v[92:95], v[84:87], v[48:63]
    s_waitcnt lgkmcnt(6)
    v_mfma_f32_32x32x16_bf16 v[32:47], v[96:99], v[100:103], v[32:47]
    ds_read_b64 v[80:81], v18 offset:704
    ds_read_b64 v[82:83], v18 offset:712
    ds_read_b128 v[84:87], v19 offset:880
    ds_read_b128 v[88:91], v21 offset:880
    ds_read_b64 v[92:93], v18 offset:2752
    ds_read_b64 v[94:95], v18 offset:2760
    v_mfma_f32_32x32x16_bf16 v[48:63], v[96:99], v[104:107], v[48:63]
    v_mfma_f32_32x32x16_bf16 v[48:63], v[108:111], v[100:103], v[48:63]
    s_waitcnt lgkmcnt(6)
    v_mfma_f32_32x32x16_bf16 v[32:47], v[64:67], v[68:71], v[32:47]
    ds_read_b64 v[96:97], v18 offset:736
    ds_read_b64 v[98:99], v18 offset:744
    ds_read_b128 v[100:103], v19 offset:912
    ds_read_b128 v[104:107], v21 offset:912
    ds_read_b64 v[108:109], v18 offset:2784
    ds_read_b64 v[110:111], v18 offset:2792
    v_mfma_f32_32x32x16_bf16 v[48:63], v[64:67], v[72:75], v[48:63]
    v_mfma_f32_32x32x16_bf16 v[48:63], v[76:79], v[68:71], v[48:63]
    s_waitcnt lgkmcnt(6)
    v_mfma_f32_32x32x16_bf16 v[32:47], v[80:83], v[84:87], v[32:47]
    ds_read_b64 v[64:65], v18 offset:768
    ds_read_b64 v[66:67], v18 offset:776
    ds_read_b128 v[68:71], v19 offset:960
    ds_read_b128 v[72:75], v21 offset:960
    ds_read_b64 v[76:77], v18 offset:2816
    ds_read_b64 v[78:79], v18 offset:2824
    v_mfma_f32_32x32x16_bf16 v[48:63], v[80:83], v[88:91], v[48:63]
    v_mfma_f32_32x32x16_bf16 v[48:63], v[92:95], v[84:87], v[48:63]
    s_waitcnt lgkmcnt(6)
    v_mfma_f32_32x32x16_bf16 v[32:47], v[96:99], v[100:103], v[32:47]
    ds_read_b64 v[80:81], v18 offset:800
    ds_read_b64 v[82:83], v18 offset:808
    ds_read_b128 v[84:87], v19 offset:992
    ds_read_b128 v[88:91], v21 offset:992
    ds_read_b64 v[92:93], v18 offset:2848
    ds_read_b64 v[94:95], v18 offset:2856
    v_mfma_f32_32x32x16_bf16 v[48:63], v[96:99], v[104:107], v[48:63]
    v_mfma_f32_32x32x16_bf16 v[48:63], v[108:111], v[100:103], v[48:63]
    s_waitcnt lgkmcnt(6)
    v_mfma_f32_32x32x16_bf16 v[32:47], v[64:67], v[68:71], v[32:47]
    ds_read_b64 v[96:97], v18 offset:832
    ds_read_b64 v[98:99], v18 offset:840
    ds_read_b128 v[100:103], v19 offset:1040
    ds_read_b128 v[104:107], v21 offset:1040
    ds_read_b64 v[108:109], v18 offset:2880
    ds_read_b64 v[110:111], v18 offset:2888
    v_mfma_f32_32x32x16_bf16 v[48:63], v[64:67], v[72:75], v[48:63]
    v_mfma_f32_32x32x16_bf16 v[48:63], v[76:79], v[68:71], v[48:63]
    s_waitcnt lgkmcnt(6)
    v_mfma_f32_32x32x16_bf16 v[32:47], v[80:83], v[84:87], v[32:47]
    ds_read_b64 v[64:65], v18 offset:864
    ds_read_b64 v[66:67], v18 offset:872
    ds_read_b128 v[68:71], v19 offset:1072
    ds_read_b128 v[72:75], v21 offset:1072
    ds_read_b64 v[76:77], v18 offset:2912
    ds_read_b64 v[78:79], v18 offset:2920
    v_mfma_f32_32x32x16_bf16 v[48:63], v[80:83], v[88:91], v[48:63]
    v_mfma_f32_32x32x16_bf16 v[48:63], v[92:95], v[84:87], v[48:63]
    s_waitcnt lgkmcnt(6)
    v_mfma_f32_32x32x16_bf16 v[32:47], v[96:99], v[100:103], v[32:47]
    ds_read_b64 v[80:81], v18 offset:896
    ds_read_b64 v[82:83], v18 offset:904
    ds_read_b128 v[84:87], v19 offset:1120
    ds_read_b128 v[88:91], v21 offset:1120
    ds_read_b64 v[92:93], v18 offset:2944
    ds_read_b64 v[94:95], v18 offset:2952
    v_mfma_f32_32x32x16_bf16 v[48:63], v[96:99], v[104:107], v[48:63]
    v_mfma_f32_32x32x16_bf16 v[48:63], v[108:111], v[100:103], v[48:63]
    s_waitcnt lgkmcnt(6)
    v_mfma_f32_32x32x16_bf16 v[32:47], v[64:67], v[68:71], v[32:47]
    ds_read_b64 v[96:97], v18 offset:928
    ds_read_b64 v[98:99], v18 offset:936
    ds_read_b128 v[100:103], v19 offset:1152
    ds_read_b128 v[104:107], v21 offset:1152
    ds_read_b64 v[108:109], v18 offset:2976
    ds_read_b64 v[110:111], v18 offset:2984
    v_mfma_f32_32x32x16_bf16 v[48:63], v[64:67], v[72:75], v[48:63]
    v_mfma_f32_32x32x16_bf16 v[48:63], v[76:79], v[68:71], v[48:63]
    s_waitcnt lgkmcnt(6)
    v_mfma_f32_32x32x16_bf16 v[32:47], v[80:83], v[84:87], v[32:47]
    ds_read_b64 v[64:65], v18 offset:960
    ds_read_b64 v[66:67], v18 offset:968
    ds_read_b128 v[68:71], v19 offset:1200
    ds_read_b128 v[72:75], v21 offset:1200
    ds_read_b64 v[76:77], v18 offset:3008
    ds_read_b64 v[78:79], v18 offset:3016
    v_mfma_f32_32x32x16_bf16 v[48:63], v[80:83], v[88:91], v[48:63]
    v_mfma_f32_32x32x16_bf16 v[48:63], v[92:95], v[84:87], v[48:63]
    s_waitcnt lgkmcnt(6)
    v_mfma_f32_32x32x16_bf16 v[32:47], v[96:99], v[100:103], v[32:47]
    ds_read_b64 v[80:81], v18 offset:992
    ds_read_b64 v[82:83], v18 offset:1000
    ds_read_b128 v[84:87], v19 offset:1232
    ds_read_b128 v[88:91], v21 offset:1232
    ds_read_b64 v[92:93], v18 offset:3040
    ds_read_b64 v[94:95], v18 offset:3048
    v_mfma_f32_32x32x16_bf16 v[48:63], v[96:99], v[104:107], v[48:63]
    v_mfma_f32_32x32x16_bf16 v[48:63], v[108:111], v[100:103], v[48:63]
    s_waitcnt lgkmcnt(6)
    v_mfma_f32_32x32x16_bf16 v[32:47], v[64:67], v[68:71], v[32:47]
    ds_read_b64 v[96:97], v18 offset:1024
    ds_read_b64 v[98:99], v18 offset:1032
    ds_read_b128 v[100:103], v19 offset:1280
    ds_read_b128 v[104:107], v21 offset:1280
    ds_read_b64 v[108:109], v18 offset:3072
    ds_read_b64 v[110:111], v18 offset:3080
    v_mfma_f32_32x32x16_bf16 v[48:63], v[64:67], v[72:75], v[48:63]
    v_mfma_f32_32x32x16_bf16 v[48:63], v[76:79], v[68:71], v[48:63]
    s_waitcnt lgkmcnt(6)
    v_mfma_f32_32x32x16_bf16 v[32:47], v[80:83], v[84:87], v[32:47]
    ds_read_b64 v[64:65], v18 offset:1056
    ds_read_b64 v[66:67], v18 offset:1064
    ds_read_b128 v[68:71], v19 offset:1312
    ds_read_b128 v[72:75], v21 offset:1312
    ds_read_b64 v[76:77], v18 offset:3104
    ds_read_b64 v[78:79], v18 offset:3112
    v_mfma_f32_32x32x16_bf16 v[48:63], v[80:83], v[88:91], v[48:63]
    v_mfma_f32_32x32x16_bf16 v[48:63], v[92:95], v[84:87], v[48:63]
    s_waitcnt lgkmcnt(6)
    v_mfma_f32_32x32x16_bf16 v[32:47], v[96:99], v[100:103], v[32:47]
    ds_read_b64 v[80:81], v18 offset:1088
    ds_read_b64 v[82:83], v18 offset:1096
    ds_read_b128 v[84:87], v19 offset:1360
    ds_read_b128 v[88:91], v21 offset:1360
    ds_read_b64 v[92:93], v18 offset:3136
    ds_read_b64 v[94:95], v18 offset:3144
    v_mfma_f32_32x32x16_bf16 v[48:63], v[96:99], v[104:107], v[48:63]
    v_mfma_f32_32x32x16_bf16 v[48:63], v[108:111], v[100:103], v[48:63]
    s_waitcnt lgkmcnt(6)
    v_mfma_f32_32x32x16_bf16 v[32:47], v[64:67], v[68:71], v[32:47]
    ds_read_b64 v[96:97], v18 offset:1120
    ds_read_b64 v[98:99], v18 offset:1128
    ds_read_b128 v[100:103], v19 offset:1392
    ds_read_b128 v[104:107], v21 offset:1392
    ds_read_b64 v[108:109], v18 offset:3168
    ds_read_b64 v[110:111], v18 offset:3176
    v_mfma_f32_32x32x16_bf16 v[48:63], v[64:67], v[72:75], v[48:63]
    v_mfma_f32_32x32x16_bf16 v[48:63], v[76:79], v[68:71], v[48:63]
    s_waitcnt lgkmcnt(6)
    v_mfma_f32_32x32x16_bf16 v[32:47], v[80:83], v[84:87], v[32:47]
    ds_read_b64 v[64:65], v18 offset:1152
    ds_read_b64 v[66:67], v18 offset:1160
    ds_read_b128 v[68:71], v19 offset:1440
    ds_read_b128 v[72:75], v21 offset:1440
    ds_read_b64 v[76:77], v18 offset:3200
    ds_read_b64 v[78:79], v18 offset:3208
    v_mfma_f32_32x32x16_bf16 v[48:63], v[80:83], v[88:91], v[48:63]
    v_mfma_f32_32x32x16_bf16 v[48:63], v[92:95], v[84:87], v[48:63]
    s_waitcnt lgkmcnt(6)
    v_mfma_f32_32x32x16_bf16 v[32:47], v[96:99], v[100:103], v[32:47]
    ds_read_b64 v[80:81], v18 offset:1184
    ds_read_b64 v[82:83], v18 offset:1192
    ds_read_b128 v[84:87], v19 offset:1472
    ds_read_b128 v[88:91], v21 offset:1472
    ds_read_b64 v[92:93], v18 offset:3232
    ds_read_b64 v[94:95], v18 offset:3240
    v_mfma_f32_32x32x16_bf16 v[48:63], v[96:99], v[104:107], v[48:63]
    v_mfma_f32_32x32x16_bf16 v[48:63], v[108:111], v[100:103], v[48:63]
    s_waitcnt lgkmcnt(6)
    v_mfma_f32_32x32x16_bf16 v[32:47], v[64:67], v[68:71], v[32:47]
    ds_read_b64 v[96:97], v18 offset:1216
    ds_read_b64 v[98:99], v18 offset:1224
    ds_read_b128 v[100:103], v19 offset:1520
    ds_read_b128 v[104:107], v21 offset:1520
    ds_read_b64 v[108:109], v18 offset:3264
    ds_read_b64 v[110:111], v18 offset:3272
    v_mfma_f32_32x32x16_bf16 v[48:63], v[64:67], v[72:75], v[48:63]
    v_mfma_f32_32x32x16_bf16 v[48:63], v[76:79], v[68:71], v[48:63]
    s_waitcnt lgkmcnt(6)
    v_mfma_f32_32x32x16_bf16 v[32:47], v[80:83], v[84:87], v[32:47]
    ds_read_b64 v[64:65], v18 offset:1248
    ds_read_b64 v[66:67], v18 offset:1256
    ds_read_b128 v[68:71], v19 offset:1552
    ds_read_b128 v[72:75], v21 offset:1552
    ds_read_b64 v[76:77], v18 offset:3296
    ds_read_b64 v[78:79], v18 offset:3304
    v_mfma_f32_32x32x16_bf16 v[48:63], v[80:83], v[88:91], v[48:63]
    v_mfma_f32_32x32x16_bf16 v[48:63], v[92:95], v[84:87], v[48:63]
    s_waitcnt lgkmcnt(6)
    v_mfma_f32_32x32x16_bf16 v[32:47], v[96:99], v[100:103], v[32:47]
    ds_read_b64 v[80:81], v18 offset:1280
    ds_read_b64 v[82:83], v18 offset:1288
    ds_read_b128 v[84:87], v19 offset:1600
    ds_read_b128 v[88:91], v21 offset:1600
    ds_read_b64 v[92:93], v18 offset:3328
    ds_read_b64 v[94:95], v18 offset:3336
    v_mfma_f32_32x32x16_bf16 v[48:63], v[96:99], v[104:107], v[48:63]
    v_mfma_f32_32x32x16_bf16 v[48:63], v[108:111], v[100:103], v[48:63]
    s_waitcnt lgkmcnt(6)
    v_mfma_f32_32x32x16_bf16 v[32:47], v[64:67], v[68:71], v[32:47]
    ds_read_b64 v[96:97], v18 offset:1312
    ds_read_b64 v[98:99], v18 offset:1320
    ds_read_b128 v[100:103], v19 offset:1632
    ds_read_b128 v[104:107], v21 offset:1632
    ds_read_b64 v[108:109], v18 offset:3360
    ds_read_b64 v[110:111], v18 offset:3368
    v_mfma_f32_32x32x16_bf16 v[48:63], v[64:67], v[72:75], v[48:63]
    v_mfma_f32_32x32x16_bf16 v[48:63], v[76:79], v[68:71], v[48:63]
    s_waitcnt lgkmcnt(6)
    v_mfma_f32_32x32x16_bf16 v[32:47], v[80:83], v[84:87], v[32:47]
    ds_read_b64 v[64:65], v18 offset:1344
    ds_read_b64 v[66:67], v18 offset:1352
    ds_read_b128 v[68:71], v19 offset:1680
    ds_read_b128 v[72:75], v21 offset:1680
    ds_read_b64 v[76:77], v18 offset:3392
    ds_read_b64 v[78:79], v18 offset:3400
    v_mfma_f32_32x32x16_bf16 v[48:63], v[80:83], v[88:91], v[48:63]
    v_mfma_f32_32x32x16_bf16 v[48:63], v[92:95], v[84:87], v[48:63]
    s_waitcnt lgkmcnt(6)
    v_mfma_f32_32x32x16_bf16 v[32:47], v[96:99], v[100:103], v[32:47]
    ds_read_b64 v[80:81], v18 offset:1376
    ds_read_b64 v[82:83], v18 offset:1384
    ds_read_b128 v[84:87], v19 offset:1712
    ds_read_b128 v[88:91], v21 offset:1712
    ds_read_b64 v[92:93], v18 offset:3424
    ds_read_b64 v[94:95], v18 offset:3432
    v_mfma_f32_32x32x16_bf16 v[48:63], v[96:99], v[104:107], v[48:63]
    v_mfma_f32_32x32x16_bf16 v[48:63], v[108:111], v[100:103], v[48:63]
    s_waitcnt lgkmcnt(6)
    v_mfma_f32_32x32x16_bf16 v[32:47], v[64:67], v[68:71], v[32:47]
    ds_read_b64 v[96:97], v18 offset:1408
    ds_read_b64 v[98:99], v18 offset:1416
    ds_read_b128 v[100:103], v19 offset:1760
    ds_read_b128 v[104:107], v21 offset:1760
    ds_read_b64 v[108:109], v18 offset:3456
    ds_read_b64 v[110:111], v18 offset:3464
    v_mfma_f32_32x32x16_bf16 v[48:63], v[64:67], v[72:75], v[48:63]
    v_mfma_f32_32x32x16_bf16 v[48:63], v[76:79], v[68:71], v[48:63]
    s_waitcnt lgkmcnt(6)
    v_mfma_f32_32x32x16_bf16 v[32:47], v[80:83], v[84:87], v[32:47]
    ds_read_b64 v[64:65], v18 offset:1440
    ds_read_b64 v[66:67], v18 offset:1448
    ds_read_b128 v[68:71], v19 offset:1792
    ds_read_b128 v[72:75], v21 offset:1792
    ds_read_b64 v[76:77], v18 offset:3488
    ds_read_b64 v[78:79], v18 offset:3496
    v_mfma_f32_32x32x16_bf16 v[48:63], v[80:83], v[88:91], v[48:63]
    v_mfma_f32_32x32x16_bf16 v[48:63], v[92:95], v[84:87], v[48:63]
    s_waitcnt lgkmcnt(6)
    v_mfma_f32_32x32x16_bf16 v[32:47], v[96:99], v[100:103], v[32:47]
    ds_read_b64 v[80:81], v18 offset:1472
    ds_read_b64 v[82:83], v18 offset:1480
    ds_read_b128 v[84:87], v19 offset:1840
    ds_read_b128 v[88:91], v21 offset:1840
    ds_read_b64 v[92:93], v18 offset:3520
    ds_read_b64 v[94:95], v18 offset:3528
    v_mfma_f32_32x32x16_bf16 v[48:63], v[96:99], v[104:107], v[48:63]
    v_mfma_f32_32x32x16_bf16 v[48:63], v[108:111], v[100:103], v[48:63]
    s_waitcnt lgkmcnt(6)
    v_mfma_f32_32x32x16_bf16 v[32:47], v[64:67], v[68:71], v[32:47]
    ds_read_b64 v[96:97], v18 offset:1504
    ds_read_b64 v[98:99], v18 offset:1512
    ds_read_b128 v[100:103], v19 offset:1872
    ds_read_b128 v[104:107], v21 offset:1872
    ds_read_b64 v[108:109], v18 offset:3552
    ds_read_b64 v[110:111], v18 offset:3560
    v_mfma_f32_32x32x16_bf16 v[48:63], v[64:67], v[72:75], v[48:63]
    v_mfma_f32_32x32x16_bf16 v[48:63], v[76:79], v[68:71], v[48:63]
    s_waitcnt lgkmcnt(6)
    v_mfma_f32_32x32x16_bf16 v[32:47], v[80:83], v[84:87], v[32:47]
    ds_read_b64 v[64:65], v18 offset:1536
    ds_read_b64 v[66:67], v18 offset:1544
    ds_read_b128 v[68:71], v19 offset:1920
    ds_read_b128 v[72:75], v21 offset:1920
    ds_read_b64 v[76:77], v18 offset:3584
    ds_read_b64 v[78:79], v18 offset:3592
    v_mfma_f32_32x32x16_bf16 v[48:63], v[80:83], v[88:91], v[48:63]
    v_mfma_f32_32x32x16_bf16 v[48:63], v[92:95], v[84:87], v[48:63]
    s_waitcnt lgkmcnt(6)
    v_mfma_f32_32x32x16_bf16 v[32:47], v[96:99], v[100:103], v[32:47]
    ds_read_b64 v[80:81], v18 offset:1568
    ds_read_b64 v[82:83], v18 offset:1576
    ds_read_b128 v[84:87], v19 offset:1952
    ds_read_b128 v[88:91], v21 offset:1952
    ds_read_b64 v[92:93], v18 offset:3616
    ds_read_b64 v[94:95], v18 offset:3624
    v_mfma_f32_32x32x16_bf16 v[48:63], v[96:99], v[104:107], v[48:63]
    v_mfma_f32_32x32x16_bf16 v[48:63], v[108:111], v[100:103], v[48:63]
    s_waitcnt lgkmcnt(6)
    v_mfma_f32_32x32x16_bf16 v[32:47], v[64:67], v[68:71], v[32:47]
    ds_read_b64 v[96:97], v18 offset:1600
    ds_read_b64 v[98:99], v18 offset:1608
    ds_read_b128 v[100:103], v19 offset:2000
    ds_read_b128 v[104:107], v21 offset:2000
    ds_read_b64 v[108:109], v18 offset:3648
    ds_read_b64 v[110:111], v18 offset:3656
    v_mfma_f32_32x32x16_bf16 v[48:63], v[64:67], v[72:75], v[48:63]
    v_mfma_f32_32x32x16_bf16 v[48:63], v[76:79], v[68:71], v[48:63]
    s_waitcnt lgkmcnt(6)
    v_mfma_f32_32x32x16_bf16 v[32:47], v[80:83], v[84:87], v[32:47]
    ds_read_b64 v[64:65], v18 offset:1632
    ds_read_b64 v[66:67], v18 offset:1640
    ds_read_b128 v[68:71], v19 offset:2032
    ds_read_b128 v[72:75], v21 offset:2032
    ds_read_b64 v[76:77], v18 offset:3680
    ds_read_b64 v[78:79], v18 offset:3688
    v_mfma_f32_32x32x16_bf16 v[48:63], v[80:83], v[88:91], v[48:63]
    v_mfma_f32_32x32x16_bf16 v[48:63], v[92:95], v[84:87], v[48:63]
    s_waitcnt lgkmcnt(6)
    v_mfma_f32_32x32x16_bf16 v[32:47], v[96:99], v[100:103], v[32:47]
    ds_read_b64 v[80:81], v18 offset:1664
    ds_read_b64 v[82:83], v18 offset:1672
    ds_read_b128 v[84:87], v19 offset:2080
    ds_read_b128 v[88:91], v21 offset:2080
    ds_read_b64 v[92:93], v18 offset:3712
    ds_read_b64 v[94:95], v18 offset:3720
    v_mfma_f32_32x32x16_bf16 v[48:63], v[96:99], v[104:107], v[48:63]
    v_mfma_f32_32x32x16_bf16 v[48:63], v[108:111], v[100:103], v[48:63]
    s_waitcnt lgkmcnt(6)
    v_mfma_f32_32x32x16_bf16 v[32:47], v[64:67], v[68:71], v[32:47]
    ds_read_b64 v[96:97], v18 offset:1696
    ds_read_b64 v[98:99], v18 offset:1704
    ds_read_b128 v[100:103], v19 offset:2112
    ds_read_b128 v[104:107], v21 offset:2112
    ds_read_b64 v[108:109], v18 offset:3744
    ds_read_b64 v[110:111], v18 offset:3752
    v_mfma_f32_32x32x16_bf16 v[48:63], v[64:67], v[72:75], v[48:63]
    v_mfma_f32_32x32x16_bf16 v[48:63], v[76:79], v[68:71], v[48:63]
    s_waitcnt lgkmcnt(6)
    v_mfma_f32_32x32x16_bf16 v[32:47], v[80:83], v[84:87], v[32:47]
    ds_read_b64 v[64:65], v18 offset:1728
    ds_read_b64 v[66:67], v18 offset:1736
    ds_read_b128 v[68:71], v19 offset:2160
    ds_read_b128 v[72:75], v21 offset:2160
    ds_read_b64 v[76:77], v18 offset:3776
    ds_read_b64 v[78:79], v18 offset:3784
    v_mfma_f32_32x32x16_bf16 v[48:63], v[80:83], v[88:91], v[48:63]
    v_mfma_f32_32x32x16_bf16 v[48:63], v[92:95], v[84:87], v[48:63]
    s_waitcnt lgkmcnt(6)
    v_mfma_f32_32x32x16_bf16 v[32:47], v[96:99], v[100:103], v[32:47]
    ds_read_b64 v[80:81], v18 offset:1760
    ds_read_b64 v[82:83], v18 offset:1768
    ds_read_b128 v[84:87], v19 offset:2192
    ds_read_b128 v[88:91], v21 offset:2192
    ds_read_b64 v[92:93], v18 offset:3808
    ds_read_b64 v[94:95], v18 offset:3816
    v_mfma_f32_32x32x16_bf16 v[48:63], v[96:99], v[104:107], v[48:63]
    v_mfma_f32_32x32x16_bf16 v[48:63], v[108:111], v[100:103], v[48:63]
    s_waitcnt lgkmcnt(6)
    v_mfma_f32_32x32x16_bf16 v[32:47], v[64:67], v[68:71], v[32:47]
    ds_read_b64 v[96:97], v18 offset:1792
    ds_read_b64 v[98:99], v18 offset:1800
    ds_read_b128 v[100:103], v19 offset:2240
    ds_read_b128 v[104:107], v21 offset:2240
    ds_read_b64 v[108:109], v18 offset:3840
    ds_read_b64 v[110:111], v18 offset:3848
    v_mfma_f32_32x32x16_bf16 v[48:63], v[64:67], v[72:75], v[48:63]
    v_mfma_f32_32x32x16_bf16 v[48:63], v[76:79], v[68:71], v[48:63]
    s_waitcnt lgkmcnt(6)
    v_mfma_f32_32x32x16_bf16 v[32:47], v[80:83], v[84:87], v[32:47]
    ds_read_b64 v[64:65], v18 offset:1824
    ds_read_b64 v[66:67], v18 offset:1832
    ds_read_b128 v[68:71], v19 offset:2272
    ds_read_b128 v[72:75], v21 offset:2272
    ds_read_b64 v[76:77], v18 offset:3872
    ds_read_b64 v[78:79], v18 offset:3880
    v_mfma_f32_32x32x16_bf16 v[48:63], v[80:83], v[88:91], v[48:63]
    v_mfma_f32_32x32x16_bf16 v[48:63], v[92:95], v[84:87], v[48:63]
    s_waitcnt lgkmcnt(6)
    v_mfma_f32_32x32x16_bf16 v[32:47], v[96:99], v[100:103], v[32:47]
    ds_read_b64 v[80:81], v18 offset:1856
    ds_read_b64 v[82:83], v18 offset:1864
    ds_read_b128 v[84:87], v19 offset:2320
    ds_read_b128 v[88:91], v21 offset:2320
    ds_read_b64 v[92:93], v18 offset:3904
    ds_read_b64 v[94:95], v18 offset:3912
    v_mfma_f32_32x32x16_bf16 v[48:63], v[96:99], v[104:107], v[48:63]
    v_mfma_f32_32x32x16_bf16 v[48:63], v[108:111], v[100:103], v[48:63]
    s_waitcnt lgkmcnt(6)
    v_mfma_f32_32x32x16_bf16 v[32:47], v[64:67], v[68:71], v[32:47]
    ds_read_b64 v[96:97], v18 offset:1888
    ds_read_b64 v[98:99], v18 offset:1896
    ds_read_b128 v[100:103], v19 offset:2352
    ds_read_b128 v[104:107], v21 offset:2352
    ds_read_b64 v[108:109], v18 offset:3936
    ds_read_b64 v[110:111], v18 offset:3944
    v_mfma_f32_32x32x16_bf16 v[48:63], v[64:67], v[72:75], v[48:63]
    v_mfma_f32_32x32x16_bf16 v[48:63], v[76:79], v[68:71], v[48:63]
    s_waitcnt lgkmcnt(6)
    v_mfma_f32_32x32x16_bf16 v[32:47], v[80:83], v[84:87], v[32:47]
    ds_read_b64 v[64:65], v18 offset:1920
    ds_read_b64 v[66:67], v18 offset:1928
    ds_read_b128 v[68:71], v19 offset:2400
    ds_read_b128 v[72:75], v21 offset:2400
    ds_read_b64 v[76:77], v18 offset:3968
    ds_read_b64 v[78:79], v18 offset:3976
    v_mfma_f32_32x32x16_bf16 v[48:63], v[80:83], v[88:91], v[48:63]
    v_mfma_f32_32x32x16_bf16 v[48:63], v[92:95], v[84:87], v[48:63]
    s_waitcnt lgkmcnt(6)
    v_mfma_f32_32x32x16_bf16 v[32:47], v[96:99], v[100:103], v[32:47]
    ds_read_b64 v[80:81], v18 offset:1952
    ds_read_b64 v[82:83], v18 offset:1960
    ds_read_b128 v[84:87], v19 offset:2432
    ds_read_b128 v[88:91], v21 offset:2432
    ds_read_b64 v[92:93], v18 offset:4000
    ds_read_b64 v[94:95], v18 offset:4008
    v_mfma_f32_32x32x16_bf16 v[48:63], v[96:99], v[104:107], v[48:63]
    v_mfma_f32_32x32x16_bf16 v[48:63], v[108:111], v[100:103], v[48:63]
    s_waitcnt lgkmcnt(6)
    v_mfma_f32_32x32x16_bf16 v[32:47], v[64:67], v[68:71], v[32:47]
    ds_read_b64 v[96:97], v18 offset:1984
    ds_read_b64 v[98:99], v18 offset:1992
    ds_read_b128 v[100:103], v19 offset:2480
    ds_read_b128 v[104:107], v21 offset:2480
    ds_read_b64 v[108:109], v18 offset:4032
    ds_read_b64 v[110:111], v18 offset:4040
    v_mfma_f32_32x32x16_bf16 v[48:63], v[64:67], v[72:75], v[48:63]
    v_mfma_f32_32x32x16_bf16 v[48:63], v[76:79], v[68:71], v[48:63]
    s_waitcnt lgkmcnt(6)
    v_mfma_f32_32x32x16_bf16 v[32:47], v[80:83], v[84:87], v[32:47]
    ds_read_b64 v[64:65], v18 offset:2016
    ds_read_b64 v[66:67], v18 offset:2024
    ds_read_b128 v[68:71], v19 offset:2512
    ds_read_b128 v[72:75], v21 offset:2512
    ds_read_b64 v[76:77], v18 offset:4064
    ds_read_b64 v[78:79], v18 offset:4072
    v_mfma_f32_32x32x16_bf16 v[48:63], v[80:83], v[88:91], v[48:63]
    v_mfma_f32_32x32x16_bf16 v[48:63], v[92:95], v[84:87], v[48:63]
    s_waitcnt lgkmcnt(6)
    v_mfma_f32_32x32x16_bf16 v[32:47], v[96:99], v[100:103], v[32:47]
    v_mfma_f32_32x32x16_bf16 v[48:63], v[96:99], v[104:107], v[48:63]
    v_mfma_f32_32x32x16_bf16 v[48:63], v[108:111], v[100:103], v[48:63]
    s_waitcnt lgkmcnt(0)
    v_mfma_f32_32x32x16_bf16 v[32:47], v[64:67], v[68:71], v[32:47]
    v_mfma_f32_32x32x16_bf16 v[48:63], v[64:67], v[72:75], v[48:63]
    v_mfma_f32_32x32x16_bf16 v[48:63], v[76:79], v[68:71], v[48:63]
    s_bitcmp1_b32 s68, 0
    s_cbranch_scc1 CV_D1
    s_lshl_b32 s54, s54, 16
CV_D1:
    s_and_b32 s54, s54, 0xffff0000
    v_lshlrev_b32 v22, 5, v17
    v_sub_u32 v22, v19, v22
    v_lshl_add_u32 v22, v17, 3, v22
    v_lshlrev_b32 v23, 6, v16
    v_lshl_add_u32 v23, v17, 3, v23
    s_lshl_b32 s56, s68, 12
    s_add_u32 s56, s56, 85983232
    v_subrev_u32 v24, 2560, v22
    ds_read_b64 v[64:65], v22 offset:56
    ds_read_b64 v[66:67], v22 offset:40
    ds_read_b64 v[68:69], v22 offset:24
    ds_read_b64 v[70:71], v22 offset:8
    ds_read_b64 v[72:73], v24 offset:56
    ds_read_b64 v[74:75], v24 offset:40
    ds_read_b64 v[76:77], v24 offset:24
    ds_read_b64 v[78:79], v24 offset:8
    s_waitcnt lgkmcnt(0)
    s_nop 7
    v_and_b32 v96, 0xffff0000, v65
    v_lshlrev_b32 v97, 16, v65
    v_and_b32 v98, 0xffff0000, v64
    v_lshlrev_b32 v99, 16, v64
    v_mul_f32 v96, s54, v96
    v_mul_f32 v97, s54, v97
    v_mul_f32 v98, s54, v98
    v_mul_f32 v99, s54, v99
    v_cvt_pk_bf16_f32 v100, v96, v97
    v_lshlrev_b32 v96, 16, v100
    v_and_b32 v97, 0xffff0000, v100
    v_cvt_pk_bf16_f32 v100, v98, v99
    v_lshlrev_b32 v98, 16, v100
    v_and_b32 v99, 0xffff0000, v100
    v_cvt_pk_bf16_f32 v100, v32, v33
    v_lshlrev_b32 v32, 16, v100
    v_and_b32 v33, 0xffff0000, v100
    v_cvt_pk_bf16_f32 v100, v34, v35
    v_lshlrev_b32 v34, 16, v100
    v_and_b32 v35, 0xffff0000, v100
    v_add_f32 v32, v32, v96
    v_add_f32 v33, v33, v97
    v_add_f32 v34, v34, v98
    v_add_f32 v35, v35, v99
    v_cvt_pk_bf16_f32 v32, v32, v33
    v_cvt_pk_bf16_f32 v33, v34, v35
    buffer_store_dwordx2 v[32:33], v23, s[36:39], s56 offen offset:0 sc1
    v_and_b32 v96, 0xffff0000, v67
    v_lshlrev_b32 v97, 16, v67
    v_and_b32 v98, 0xffff0000, v66
    v_lshlrev_b32 v99, 16, v66
    v_mul_f32 v96, s54, v96
    v_mul_f32 v97, s54, v97
    v_mul_f32 v98, s54, v98
    v_mul_f32 v99, s54, v99
    v_cvt_pk_bf16_f32 v100, v96, v97
    v_lshlrev_b32 v96, 16, v100
    v_and_b32 v97, 0xffff0000, v100
    v_cvt_pk_bf16_f32 v100, v98, v99
    v_lshlrev_b32 v98, 16, v100
    v_and_b32 v99, 0xffff0000, v100
    v_cvt_pk_bf16_f32 v100, v36, v37
    v_lshlrev_b32 v36, 16, v100
    v_and_b32 v37, 0xffff0000, v100
    v_cvt_pk_bf16_f32 v100, v38, v39
    v_lshlrev_b32 v38, 16, v100
    v_and_b32 v39, 0xffff0000, v100
    v_add_f32 v36, v36, v96
    v_add_f32 v37, v37, v97
    v_add_f32 v38, v38, v98
    v_add_f32 v39, v39, v99
    v_cvt_pk_bf16_f32 v36, v36, v37
    v_cvt_pk_bf16_f32 v37, v38, v39
    buffer_store_dwordx2 v[36:37], v23, s[36:39], s56 offen offset:16 sc1
    v_and_b32 v96, 0xffff0000, v69
    v_lshlrev_b32 v97, 16, v69
    v_and_b32 v98, 0xffff0000, v68
    v_lshlrev_b32 v99, 16, v68
    v_mul_f32 v96, s54, v96
    v_mul_f32 v97, s54, v97
    v_mul_f32 v98, s54, v98
    v_mul_f32 v99, s54, v99
    v_cvt_pk_bf16_f32 v100, v96, v97
    v_lshlrev_b32 v96, 16, v100
    v_and_b32 v97, 0xffff0000, v100
    v_cvt_pk_bf16_f32 v100, v98, v99
    v_lshlrev_b32 v98, 16, v100
    v_and_b32 v99, 0xffff0000, v100
    v_cvt_pk_bf16_f32 v100, v40, v41
    v_lshlrev_b32 v40, 16, v100
    v_and_b32 v41, 0xffff0000, v100
    v_cvt_pk_bf16_f32 v100, v42, v43
    v_lshlrev_b32 v42, 16, v100
    v_and_b32 v43, 0xffff0000, v100
    v_add_f32 v40, v40, v96
    v_add_f32 v41, v41, v97
    v_add_f32 v42, v42, v98
    v_add_f32 v43, v43, v99
    v_cvt_pk_bf16_f32 v40, v40, v41
    v_cvt_pk_bf16_f32 v41, v42, v43
    buffer_store_dwordx2 v[40:41], v23, s[36:39], s56 offen offset:32 sc1
    v_and_b32 v96, 0xffff0000, v71
    v_lshlrev_b32 v97, 16, v71
    v_and_b32 v98, 0xffff0000, v70
    v_lshlrev_b32 v99, 16, v70
    v_mul_f32 v96, s54, v96
    v_mul_f32 v97, s54, v97
    v_mul_f32 v98, s54, v98
    v_mul_f32 v99, s54, v99
    v_cvt_pk_bf16_f32 v100, v96, v97
    v_lshlrev_b32 v96, 16, v100
    v_and_b32 v97, 0xffff0000, v100
    v_cvt_pk_bf16_f32 v100, v98, v99
    v_lshlrev_b32 v98, 16, v100
    v_and_b32 v99, 0xffff0000, v100
    v_cvt_pk_bf16_f32 v100, v44, v45
    v_lshlrev_b32 v44, 16, v100
    v_and_b32 v45, 0xffff0000, v100
    v_cvt_pk_bf16_f32 v100, v46, v47
    v_lshlrev_b32 v46, 16, v100
    v_and_b32 v47, 0xffff0000, v100
    v_add_f32 v44, v44, v96
    v_add_f32 v45, v45, v97
    v_add_f32 v46, v46, v98
    v_add_f32 v47, v47, v99
    v_cvt_pk_bf16_f32 v44, v44, v45
    v_cvt_pk_bf16_f32 v45, v46, v47
    buffer_store_dwordx2 v[44:45], v23, s[36:39], s56 offen offset:48 sc1
    v_and_b32 v96, 0xffff0000, v73
    v_lshlrev_b32 v97, 16, v73
    v_and_b32 v98, 0xffff0000, v72
    v_lshlrev_b32 v99, 16, v72
    v_mul_f32 v96, s54, v96
    v_mul_f32 v97, s54, v97
    v_mul_f32 v98, s54, v98
    v_mul_f32 v99, s54, v99
    v_cvt_pk_bf16_f32 v100, v96, v97
    v_lshlrev_b32 v96, 16, v100
    v_and_b32 v97, 0xffff0000, v100
    v_cvt_pk_bf16_f32 v100, v98, v99
    v_lshlrev_b32 v98, 16, v100
    v_and_b32 v99, 0xffff0000, v100
    v_cvt_pk_bf16_f32 v100, v48, v49
    v_lshlrev_b32 v48, 16, v100
    v_and_b32 v49, 0xffff0000, v100
    v_cvt_pk_bf16_f32 v100, v50, v51
    v_lshlrev_b32 v50, 16, v100
    v_and_b32 v51, 0xffff0000, v100
    v_add_f32 v48, v48, v96
    v_add_f32 v49, v49, v97
    v_add_f32 v50, v50, v98
    v_add_f32 v51, v51, v99
    v_cvt_pk_bf16_f32 v48, v48, v49
    v_cvt_pk_bf16_f32 v49, v50, v51
    buffer_store_dwordx2 v[48:49], v23, s[36:39], s56 offen offset:2048 sc1
    v_and_b32 v96, 0xffff0000, v75
    v_lshlrev_b32 v97, 16, v75
    v_and_b32 v98, 0xffff0000, v74
    v_lshlrev_b32 v99, 16, v74
    v_mul_f32 v96, s54, v96
    v_mul_f32 v97, s54, v97
    v_mul_f32 v98, s54, v98
    v_mul_f32 v99, s54, v99
    v_cvt_pk_bf16_f32 v100, v96, v97
    v_lshlrev_b32 v96, 16, v100
    v_and_b32 v97, 0xffff0000, v100
    v_cvt_pk_bf16_f32 v100, v98, v99
    v_lshlrev_b32 v98, 16, v100
    v_and_b32 v99, 0xffff0000, v100
    v_cvt_pk_bf16_f32 v100, v52, v53
    v_lshlrev_b32 v52, 16, v100
    v_and_b32 v53, 0xffff0000, v100
    v_cvt_pk_bf16_f32 v100, v54, v55
    v_lshlrev_b32 v54, 16, v100
    v_and_b32 v55, 0xffff0000, v100
    v_add_f32 v52, v52, v96
    v_add_f32 v53, v53, v97
    v_add_f32 v54, v54, v98
    v_add_f32 v55, v55, v99
    v_cvt_pk_bf16_f32 v52, v52, v53
    v_cvt_pk_bf16_f32 v53, v54, v55
    buffer_store_dwordx2 v[52:53], v23, s[36:39], s56 offen offset:2064 sc1
    v_and_b32 v96, 0xffff0000, v77
    v_lshlrev_b32 v97, 16, v77
    v_and_b32 v98, 0xffff0000, v76
    v_lshlrev_b32 v99, 16, v76
    v_mul_f32 v96, s54, v96
    v_mul_f32 v97, s54, v97
    v_mul_f32 v98, s54, v98
    v_mul_f32 v99, s54, v99
    v_cvt_pk_bf16_f32 v100, v96, v97
    v_lshlrev_b32 v96, 16, v100
    v_and_b32 v97, 0xffff0000, v100
    v_cvt_pk_bf16_f32 v100, v98, v99
    v_lshlrev_b32 v98, 16, v100
    v_and_b32 v99, 0xffff0000, v100
    v_cvt_pk_bf16_f32 v100, v56, v57
    v_lshlrev_b32 v56, 16, v100
    v_and_b32 v57, 0xffff0000, v100
    v_cvt_pk_bf16_f32 v100, v58, v59
    v_lshlrev_b32 v58, 16, v100
    v_and_b32 v59, 0xffff0000, v100
    v_add_f32 v56, v56, v96
    v_add_f32 v57, v57, v97
    v_add_f32 v58, v58, v98
    v_add_f32 v59, v59, v99
    v_cvt_pk_bf16_f32 v56, v56, v57
    v_cvt_pk_bf16_f32 v57, v58, v59
    buffer_store_dwordx2 v[56:57], v23, s[36:39], s56 offen offset:2080 sc1
    v_and_b32 v96, 0xffff0000, v79
    v_lshlrev_b32 v97, 16, v79
    v_and_b32 v98, 0xffff0000, v78
    v_lshlrev_b32 v99, 16, v78
    v_mul_f32 v96, s54, v96
    v_mul_f32 v97, s54, v97
    v_mul_f32 v98, s54, v98
    v_mul_f32 v99, s54, v99
    v_cvt_pk_bf16_f32 v100, v96, v97
    v_lshlrev_b32 v96, 16, v100
    v_and_b32 v97, 0xffff0000, v100
    v_cvt_pk_bf16_f32 v100, v98, v99
    v_lshlrev_b32 v98, 16, v100
    v_and_b32 v99, 0xffff0000, v100
    v_cvt_pk_bf16_f32 v100, v60, v61
    v_lshlrev_b32 v60, 16, v100
    v_and_b32 v61, 0xffff0000, v100
    v_cvt_pk_bf16_f32 v100, v62, v63
    v_lshlrev_b32 v62, 16, v100
    v_and_b32 v63, 0xffff0000, v100
    v_add_f32 v60, v60, v96
    v_add_f32 v61, v61, v97
    v_add_f32 v62, v62, v98
    v_add_f32 v63, v63, v99
    v_cvt_pk_bf16_f32 v60, v60, v61
    v_cvt_pk_bf16_f32 v61, v62, v63
    buffer_store_dwordx2 v[60:61], v23, s[36:39], s56 offen offset:2096 sc1
    s_waitcnt vmcnt(0)
    s_barrier
    v_mbcnt_lo_u32_b32 v25, -1, 0
    v_mbcnt_hi_u32_b32 v25, -1, v25
    v_lshlrev_b32 v25, 2, v25
WI_65:
    global_load_dword v24, v25, s[32:33] sc1
    s_add_u32 s65, s65, 1
    s_waitcnt vmcnt(0)
    v_readlane_b32 s67, v24, 18
    s_cmp_ge_u32 s67, 60
    s_cbranch_scc1 WID_66
    s_sleep 16
    s_cmp_lt_u32 s65, 262144
    s_cbranch_scc1 WI_65
WID_66:
    s_lshl_b32 s58, s58, 2
    s_add_u32 s58, s58, 20480
    v_mov_b32 v6, 1
    v_mov_b32 v7, s58
    s_mov_b64 exec, s[76:77]
    buffer_store_dword v6, v7, s[36:39], 0 offen sc1
    s_mov_b64 exec, -1
CV_END:
    v_and_b32 v18, 3, v0
    v_lshrrev_b32 v19, 2, v0
    s_lshl_b32 s67, s51, 8
    s_lshl_b32 s68, s48, 6
    s_add_u32 s67, s67, s68
    v_lshlrev_b32 v20, 13, v19
    v_lshl_add_u32 v20, v18, 4, v20
    v_add_u32 v20, s67, v20
    s_lshl_b32 s67, s48, 20
    s_lshl_b32 s68, s51, 5
    s_add_u32 s67, s67, s68
    v_lshrrev_b32 v21, 1, v0
    v_lshlrev_b32 v21, 10, v21
    v_and_b32 v24, 1, v0
    v_lshl_add_u32 v21, v24, 4, v21
    v_add_u32 v21, s67, v21
    s_mul_i32 s60, s48, 24576
    s_add_u32 s60, s60, 65536
    v_lshrrev_b32 v24, 2, v1
    v_lshl_add_u32 v22, v2, 3, v24
    v_lshlrev_b32 v22, 6, v22
    v_lshl_add_u32 v22, v18, 3, v22
    v_add_u32 v22, s60, v22
    v_lshl_add_u32 v23, v2, 2, v24
    v_lshlrev_b32 v23, 5, v23
    v_lshl_add_u32 v23, v18, 3, v23
    v_add_u32 v23, s60, v23
    s_mov_b32 s40, s22
    s_mov_b32 s41, s23
    s_mov_b32 s42, 4194304
    s_mov_b32 s43, 0x20000
    s_mov_b32 s44, s24
    s_mov_b32 s45, s25
    s_mov_b32 s46, 4194304
    s_mov_b32 s47, 0x20000
    s_cmp_lt_u32 s52, 3
    s_cselect_b32 s61, 3, 4
    s_cselect_b32 s66, 30, 64
    s_cselect_b32 s67, 0, 27
    s_add_u32 s53, s52, s67
    s_lshl_b32 s56, s53, 15
    s_lshl_b32 s55, s48, 13
    v_mov_b32 v5, v3
    s_add_u32 m0, s55, 0
    s_add_u32 s67, s56, 0
    buffer_load_dwordx4 v4, s[84:87], s67 offen lds
    s_add_u32 m0, s55, 1024
    s_add_u32 s67, s56, 64
    buffer_load_dwordx4 v4, s[84:87], s67 offen lds
    s_add_u32 m0, s55, 2048
    s_add_u32 s67, s56, 128
    buffer_load_dwordx4 v4, s[84:87], s67 offen lds
    s_add_u32 m0, s55, 3072
    s_add_u32 s67, s56, 192
    buffer_load_dwordx4 v4, s[84:87], s67 offen lds
    s_add_u32 m0, s55, 4096
    s_add_u32 s67, s56, 256
    buffer_load_dwordx4 v4, s[84:87], s67 offen lds
    s_add_u32 m0, s55, 5120
    s_add_u32 s67, s56, 320
    buffer_load_dwordx4 v4, s[84:87], s67 offen lds
    s_add_u32 m0, s55, 6144
    s_add_u32 s67, s56, 384
    buffer_load_dwordx4 v4, s[84:87], s67 offen lds
    s_add_u32 m0, s55, 7168
    s_add_u32 s67, s56, 448
    buffer_load_dwordx4 v4, s[84:87], s67 offen lds
    s_cmp_lt_u32 s52, 3
    s_cbranch_scc1 PA_W1
    s_add_u32 m0, s60, 0
    s_mov_b32 s67, 0
    buffer_load_dwordx4 v20, s[40:43], s67 offen lds
    s_add_u32 m0, s60, 1024
    s_mov_b32 s67, 131072
    buffer_load_dwordx4 v20, s[40:43], s67 offen lds
    s_waitcnt vmcnt(1)
    s_add_u32 m0, s60, 2048
    s_mov_b32 s67, 262144
    buffer_load_dwordx4 v20, s[40:43], s67 offen lds
    s_waitcnt vmcnt(1)
    s_add_u32 m0, s60, 3072
    s_mov_b32 s67, 393216
    buffer_load_dwordx4 v20, s[40:43], s67 offen lds
    s_waitcnt vmcnt(1)
    s_add_u32 m0, s60, 4096
    s_mov_b32 s67, 524288
    buffer_load_dwordx4 v20, s[40:43], s67 offen lds
    s_waitcnt vmcnt(1)
    s_add_u32 m0, s60, 5120
    s_mov_b32 s67, 655360
    buffer_load_dwordx4 v20, s[40:43], s67 offen lds
    ds_read_b64_tr_b16 a[0:1], v22 offset:0
    ds_read_b64_tr_b16 a[2:3], v22 offset:256
    ds_read_b64_tr_b16 a[4:5], v22 offset:2048
    ds_read_b64_tr_b16 a[6:7], v22 offset:2304
    ds_read_b64_tr_b16 a[64:65], v22 offset:32
    ds_read_b64_tr_b16 a[66:67], v22 offset:288
    ds_read_b64_tr_b16 a[68:69], v22 offset:2080
    ds_read_b64_tr_b16 a[70:71], v22 offset:2336
    s_waitcnt lgkmcnt(0)
    s_waitcnt vmcnt(1)
    s_add_u32 m0, s60, 6144
    s_mov_b32 s67, 786432
    buffer_load_dwordx4 v20, s[40:43], s67 offen lds
    s_waitcnt vmcnt(1)
    s_add_u32 m0, s60, 7168
    s_mov_b32 s67, 917504
    buffer_load_dwordx4 v20, s[40:43], s67 offen lds
    s_waitcnt vmcnt(1)
    s_add_u32 m0, s60, 8192
    s_mov_b32 s67, 1048576
    buffer_load_dwordx4 v20, s[40:43], s67 offen lds
    s_waitcnt vmcnt(1)
    s_add_u32 m0, s60, 9216
    s_mov_b32 s67, 1179648
    buffer_load_dwordx4 v20, s[40:43], s67 offen lds
    ds_read_b64_tr_b16 a[8:9], v22 offset:4096
    ds_read_b64_tr_b16 a[10:11], v22 offset:4352
    ds_read_b64_tr_b16 a[12:13], v22 offset:6144
    ds_read_b64_tr_b16 a[14:15], v22 offset:6400
    ds_read_b64_tr_b16 a[72:73], v22 offset:4128
    ds_read_b64_tr_b16 a[74:75], v22 offset:4384
    ds_read_b64_tr_b16 a[76:77], v22 offset:6176
    ds_read_b64_tr_b16 a[78:79], v22 offset:6432
    s_waitcnt lgkmcnt(0)
    s_waitcnt vmcnt(1)
    s_add_u32 m0, s60, 10240
    s_mov_b32 s67, 1310720
    buffer_load_dwordx4 v20, s[40:43], s67 offen lds
    s_waitcnt vmcnt(1)
    s_add_u32 m0, s60, 11264
    s_mov_b32 s67, 1441792
    buffer_load_dwordx4 v20, s[40:43], s67 offen lds
    s_waitcnt vmcnt(1)
    s_add_u32 m0, s60, 12288
    s_mov_b32 s67, 1572864
    buffer_load_dwordx4 v20, s[40:43], s67 offen lds
    s_waitcnt vmcnt(1)
    s_add_u32 m0, s60, 13312
    s_mov_b32 s67, 1703936
    buffer_load_dwordx4 v20, s[40:43], s67 offen lds
    ds_read_b64_tr_b16 a[16:17], v22 offset:8192
    ds_read_b64_tr_b16 a[18:19], v22 offset:8448
    ds_read_b64_tr_b16 a[20:21], v22 offset:10240
    ds_read_b64_tr_b16 a[22:23], v22 offset:10496
    ds_read_b64_tr_b16 a[80:81], v22 offset:8224
    ds_read_b64_tr_b16 a[82:83], v22 offset:8480
    ds_read_b64_tr_b16 a[84:85], v22 offset:10272
    ds_read_b64_tr_b16 a[86:87], v22 offset:10528
    s_waitcnt lgkmcnt(0)
    s_waitcnt vmcnt(1)
    s_add_u32 m0, s60, 14336
    s_mov_b32 s67, 1835008
    buffer_load_dwordx4 v20, s[40:43], s67 offen lds
    s_waitcnt vmcnt(1)
    s_add_u32 m0, s60, 15360
    s_mov_b32 s67, 1966080
    buffer_load_dwordx4 v20, s[40:43], s67 offen lds
    s_waitcnt vmcnt(1)
    s_add_u32 m0, s60, 16384
    s_mov_b32 s67, 2097152
    buffer_load_dwordx4 v20, s[40:43], s67 offen lds
    s_waitcnt vmcnt(1)
    s_add_u32 m0, s60, 17408
    s_mov_b32 s67, 2228224
    buffer_load_dwordx4 v20, s[40:43], s67 offen lds
    ds_read_b64_tr_b16 a[24:25], v22 offset:12288
    ds_read_b64_tr_b16 a[26:27], v22 offset:12544
    ds_read_b64_tr_b16 a[28:29], v22 offset:14336
    ds_read_b64_tr_b16 a[30:31], v22 offset:14592
    ds_read_b64_tr_b16 a[88:89], v22 offset:12320
    ds_read_b64_tr_b16 a[90:91], v22 offset:12576
    ds_read_b64_tr_b16 a[92:93], v22 offset:14368
    ds_read_b64_tr_b16 a[94:95], v22 offset:14624
    s_waitcnt lgkmcnt(0)
    s_waitcnt vmcnt(1)
    s_add_u32 m0, s60, 18432
    s_mov_b32 s67, 2359296
    buffer_load_dwordx4 v20, s[40:43], s67 offen lds
    s_waitcnt vmcnt(1)
    s_add_u32 m0, s60, 19456
    s_mov_b32 s67, 2490368
    buffer_load_dwordx4 v20, s[40:43], s67 offen lds
    s_waitcnt vmcnt(1)
    s_add_u32 m0, s60, 20480
    s_mov_b32 s67, 2621440
    buffer_load_dwordx4 v20, s[40:43], s67 offen lds
    s_waitcnt vmcnt(1)
    s_add_u32 m0, s60, 21504
    s_mov_b32 s67, 2752512
    buffer_load_dwordx4 v20, s[40:43], s67 offen lds
    ds_read_b64_tr_b16 a[32:33], v22 offset:16384
    ds_read_b64_tr_b16 a[34:35], v22 offset:16640
    ds_read_b64_tr_b16 a[36:37], v22 offset:18432
    ds_read_b64_tr_b16 a[38:39], v22 offset:18688
    ds_read_b64_tr_b16 a[96:97], v22 offset:16416
    ds_read_b64_tr_b16 a[98:99], v22 offset:16672
    ds_read_b64_tr_b16 a[100:101], v22 offset:18464
    ds_read_b64_tr_b16 a[102:103], v22 offset:18720
    s_waitcnt lgkmcnt(0)
    s_waitcnt vmcnt(1)
    s_add_u32 m0, s60, 22528
    s_mov_b32 s67, 2883584
    buffer_load_dwordx4 v20, s[40:43], s67 offen lds
    s_waitcnt vmcnt(1)
    s_add_u32 m0, s60, 23552
    s_mov_b32 s67, 3014656
    buffer_load_dwordx4 v20, s[40:43], s67 offen lds
    s_waitcnt vmcnt(1)
    s_add_u32 m0, s60, 0
    s_mov_b32 s67, 3145728
    buffer_load_dwordx4 v20, s[40:43], s67 offen lds
    s_waitcnt vmcnt(1)
    s_add_u32 m0, s60, 1024
    s_mov_b32 s67, 3276800
    buffer_load_dwordx4 v20, s[40:43], s67 offen lds
    ds_read_b64_tr_b16 a[40:41], v22 offset:20480
    ds_read_b64_tr_b16 a[42:43], v22 offset:20736
    ds_read_b64_tr_b16 a[44:45], v22 offset:22528
    ds_read_b64_tr_b16 a[46:47], v22 offset:22784
    ds_read_b64_tr_b16 a[104:105], v22 offset:20512
    ds_read_b64_tr_b16 a[106:107], v22 offset:20768
    ds_read_b64_tr_b16 a[108:109], v22 offset:22560
    ds_read_b64_tr_b16 a[110:111], v22 offset:22816
    s_waitcnt lgkmcnt(0)
    s_waitcnt vmcnt(1)
    s_add_u32 m0, s60, 2048
    s_mov_b32 s67, 3407872
    buffer_load_dwordx4 v20, s[40:43], s67 offen lds
    s_waitcnt vmcnt(1)
    s_add_u32 m0, s60, 3072
    s_mov_b32 s67, 3538944
    buffer_load_dwordx4 v20, s[40:43], s67 offen lds
    s_waitcnt vmcnt(1)
    s_add_u32 m0, s60, 4096
    s_mov_b32 s67, 3670016
    buffer_load_dwordx4 v20, s[40:43], s67 offen lds
    s_waitcnt vmcnt(1)
    s_add_u32 m0, s60, 5120
    s_mov_b32 s67, 3801088
    buffer_load_dwordx4 v20, s[40:43], s67 offen lds
    ds_read_b64_tr_b16 a[48:49], v22 offset:0
    ds_read_b64_tr_b16 a[50:51], v22 offset:256
    ds_read_b64_tr_b16 a[52:53], v22 offset:2048
    ds_read_b64_tr_b16 a[54:55], v22 offset:2304
    ds_read_b64_tr_b16 a[112:113], v22 offset:32
    ds_read_b64_tr_b16 a[114:115], v22 offset:288
    ds_read_b64_tr_b16 a[116:117], v22 offset:2080
    ds_read_b64_tr_b16 a[118:119], v22 offset:2336
    s_waitcnt lgkmcnt(0)
    s_waitcnt vmcnt(1)
    s_add_u32 m0, s60, 6144
    s_mov_b32 s67, 3932160
    buffer_load_dwordx4 v20, s[40:43], s67 offen lds
    s_waitcnt vmcnt(1)
    s_add_u32 m0, s60, 7168
    s_mov_b32 s67, 4063232
    buffer_load_dwordx4 v20, s[40:43], s67 offen lds
    s_waitcnt vmcnt(1)
    s_add_u32 m0, s60, 8192
    s_mov_b32 s67, 0
    buffer_load_dwordx4 v20, s[44:47], s67 offen lds
    s_waitcnt vmcnt(1)
    s_add_u32 m0, s60, 9216
    s_mov_b32 s67, 131072
    buffer_load_dwordx4 v20, s[44:47], s67 offen lds
    ds_read_b64_tr_b16 a[56:57], v22 offset:4096
    ds_read_b64_tr_b16 a[58:59], v22 offset:4352
    ds_read_b64_tr_b16 a[60:61], v22 offset:6144
    ds_read_b64_tr_b16 a[62:63], v22 offset:6400
    ds_read_b64_tr_b16 a[120:121], v22 offset:4128
    ds_read_b64_tr_b16 a[122:123], v22 offset:4384
    ds_read_b64_tr_b16 a[124:125], v22 offset:6176
    ds_read_b64_tr_b16 a[126:127], v22 offset:6432
    s_waitcnt lgkmcnt(0)
    s_waitcnt vmcnt(1)
    s_add_u32 m0, s60, 10240
    s_mov_b32 s67, 262144
    buffer_load_dwordx4 v20, s[44:47], s67 offen lds
    s_waitcnt vmcnt(1)
    s_add_u32 m0, s60, 11264
    s_mov_b32 s67, 393216
    buffer_load_dwordx4 v20, s[44:47], s67 offen lds
    s_waitcnt vmcnt(1)
    s_add_u32 m0, s60, 12288
    s_mov_b32 s67, 524288
    buffer_load_dwordx4 v20, s[44:47], s67 offen lds
    s_waitcnt vmcnt(1)
    s_add_u32 m0, s60, 13312
    s_mov_b32 s67, 655360
    buffer_load_dwordx4 v20, s[44:47], s67 offen lds
    ds_read_b64_tr_b16 a[128:129], v22 offset:8192
    ds_read_b64_tr_b16 a[130:131], v22 offset:8448
    ds_read_b64_tr_b16 a[132:133], v22 offset:10240
    ds_read_b64_tr_b16 a[134:135], v22 offset:10496
    ds_read_b64_tr_b16 a[192:193], v22 offset:8224
    ds_read_b64_tr_b16 a[194:195], v22 offset:8480
    ds_read_b64_tr_b16 a[196:197], v22 offset:10272
    ds_read_b64_tr_b16 a[198:199], v22 offset:10528
    s_waitcnt lgkmcnt(0)
    s_waitcnt vmcnt(1)
    s_add_u32 m0, s60, 14336
    s_mov_b32 s67, 786432
    buffer_load_dwordx4 v20, s[44:47], s67 offen lds
    s_waitcnt vmcnt(1)
    s_add_u32 m0, s60, 15360
    s_mov_b32 s67, 917504
    buffer_load_dwordx4 v20, s[44:47], s67 offen lds
    s_waitcnt vmcnt(1)
    s_add_u32 m0, s60, 16384
    s_mov_b32 s67, 1048576
    buffer_load_dwordx4 v20, s[44:47], s67 offen lds
    s_waitcnt vmcnt(1)
    s_add_u32 m0, s60, 17408
    s_mov_b32 s67, 1179648
    buffer_load_dwordx4 v20, s[44:47], s67 offen lds
    ds_read_b64_tr_b16 a[136:137], v22 offset:12288
    ds_read_b64_tr_b16 a[138:139], v22 offset:12544
    ds_read_b64_tr_b16 a[140:141], v22 offset:14336
    ds_read_b64_tr_b16 a[142:143], v22 offset:14592
    ds_read_b64_tr_b16 a[200:201], v22 offset:12320
    ds_read_b64_tr_b16 a[202:203], v22 offset:12576
    ds_read_b64_tr_b16 a[204:205], v22 offset:14368
    ds_read_b64_tr_b16 a[206:207], v22 offset:14624
    s_waitcnt lgkmcnt(0)
    s_waitcnt vmcnt(1)
    s_add_u32 m0, s60, 18432
    s_mov_b32 s67, 1310720
    buffer_load_dwordx4 v20, s[44:47], s67 offen lds
    s_waitcnt vmcnt(1)
    s_add_u32 m0, s60, 19456
    s_mov_b32 s67, 1441792
    buffer_load_dwordx4 v20, s[44:47], s67 offen lds
    s_waitcnt vmcnt(1)
    s_add_u32 m0, s60, 20480
    s_mov_b32 s67, 1572864
    buffer_load_dwordx4 v20, s[44:47], s67 offen lds
    s_waitcnt vmcnt(1)
    s_add_u32 m0, s60, 21504
    s_mov_b32 s67, 1703936
    buffer_load_dwordx4 v20, s[44:47], s67 offen lds
    ds_read_b64_tr_b16 a[144:145], v22 offset:16384
    ds_read_b64_tr_b16 a[146:147], v22 offset:16640
    ds_read_b64_tr_b16 a[148:149], v22 offset:18432
    ds_read_b64_tr_b16 a[150:151], v22 offset:18688
    ds_read_b64_tr_b16 a[208:209], v22 offset:16416
    ds_read_b64_tr_b16 a[210:211], v22 offset:16672
    ds_read_b64_tr_b16 a[212:213], v22 offset:18464
    ds_read_b64_tr_b16 a[214:215], v22 offset:18720
    s_waitcnt lgkmcnt(0)
    s_waitcnt vmcnt(1)
    s_add_u32 m0, s60, 22528
    s_mov_b32 s67, 1835008
    buffer_load_dwordx4 v20, s[44:47], s67 offen lds
    s_waitcnt vmcnt(1)
    s_add_u32 m0, s60, 23552
    s_mov_b32 s67, 1966080
    buffer_load_dwordx4 v20, s[44:47], s67 offen lds
    s_waitcnt vmcnt(1)
    s_add_u32 m0, s60, 0
    s_mov_b32 s67, 2097152
    buffer_load_dwordx4 v20, s[44:47], s67 offen lds
    s_waitcnt vmcnt(1)
    s_add_u32 m0, s60, 1024
    s_mov_b32 s67, 2228224
    buffer_load_dwordx4 v20, s[44:47], s67 offen lds
    ds_read_b64_tr_b16 a[152:153], v22 offset:20480
    ds_read_b64_tr_b16 a[154:155], v22 offset:20736
    ds_read_b64_tr_b16 a[156:157], v22 offset:22528
    ds_read_b64_tr_b16 a[158:159], v22 offset:22784
    ds_read_b64_tr_b16 a[216:217], v22 offset:20512
    ds_read_b64_tr_b16 a[218:219], v22 offset:20768
    ds_read_b64_tr_b16 a[220:221], v22 offset:22560
    ds_read_b64_tr_b16 a[222:223], v22 offset:22816
    s_waitcnt lgkmcnt(0)
    s_waitcnt vmcnt(1)
    s_add_u32 m0, s60, 2048
    s_mov_b32 s67, 2359296
    buffer_load_dwordx4 v20, s[44:47], s67 offen lds
    s_waitcnt vmcnt(1)
    s_add_u32 m0, s60, 3072
    s_mov_b32 s67, 2490368
    buffer_load_dwordx4 v20, s[44:47], s67 offen lds
    s_waitcnt vmcnt(1)
    s_add_u32 m0, s60, 4096
    s_mov_b32 s67, 2621440
    buffer_load_dwordx4 v20, s[44:47], s67 offen lds
    s_waitcnt vmcnt(1)
    s_add_u32 m0, s60, 5120
    s_mov_b32 s67, 2752512
    buffer_load_dwordx4 v20, s[44:47], s67 offen lds
    ds_read_b64_tr_b16 a[160:161], v22 offset:0
    ds_read_b64_tr_b16 a[162:163], v22 offset:256
    ds_read_b64_tr_b16 a[164:165], v22 offset:2048
    ds_read_b64_tr_b16 a[166:167], v22 offset:2304
    ds_read_b64_tr_b16 a[224:225], v22 offset:32
    ds_read_b64_tr_b16 a[226:227], v22 offset:288
    ds_read_b64_tr_b16 a[228:229], v22 offset:2080
    ds_read_b64_tr_b16 a[230:231], v22 offset:2336
    s_waitcnt lgkmcnt(0)
    s_waitcnt vmcnt(1)
    s_add_u32 m0, s60, 6144
    s_mov_b32 s67, 2883584
    buffer_load_dwordx4 v20, s[44:47], s67 offen lds
    s_waitcnt vmcnt(1)
    s_add_u32 m0, s60, 7168
    s_mov_b32 s67, 3014656
    buffer_load_dwordx4 v20, s[44:47], s67 offen lds
    s_waitcnt vmcnt(1)
    s_add_u32 m0, s60, 8192
    s_mov_b32 s67, 3145728
    buffer_load_dwordx4 v20, s[44:47], s67 offen lds
    s_waitcnt vmcnt(1)
    s_add_u32 m0, s60, 9216
    s_mov_b32 s67, 3276800
    buffer_load_dwordx4 v20, s[44:47], s67 offen lds
    ds_read_b64_tr_b16 a[168:169], v22 offset:4096
    ds_read_b64_tr_b16 a[170:171], v22 offset:4352
    ds_read_b64_tr_b16 a[172:173], v22 offset:6144
    ds_read_b64_tr_b16 a[174:175], v22 offset:6400
    ds_read_b64_tr_b16 a[232:233], v22 offset:4128
    ds_read_b64_tr_b16 a[234:235], v22 offset:4384
    ds_read_b64_tr_b16 a[236:237], v22 offset:6176
    ds_read_b64_tr_b16 a[238:239], v22 offset:6432
    s_waitcnt lgkmcnt(0)
    s_waitcnt vmcnt(1)
    s_add_u32 m0, s60, 10240
    s_mov_b32 s67, 3407872
    buffer_load_dwordx4 v20, s[44:47], s67 offen lds
    s_waitcnt vmcnt(1)
    s_add_u32 m0, s60, 11264
    s_mov_b32 s67, 3538944
    buffer_load_dwordx4 v20, s[44:47], s67 offen lds
    s_waitcnt vmcnt(1)
    s_add_u32 m0, s60, 12288
    s_mov_b32 s67, 3670016
    buffer_load_dwordx4 v20, s[44:47], s67 offen lds
    s_waitcnt vmcnt(1)
    s_add_u32 m0, s60, 13312
    s_mov_b32 s67, 3801088
    buffer_load_dwordx4 v20, s[44:47], s67 offen lds
    ds_read_b64_tr_b16 a[176:177], v22 offset:8192
    ds_read_b64_tr_b16 a[178:179], v22 offset:8448
    ds_read_b64_tr_b16 a[180:181], v22 offset:10240
    ds_read_b64_tr_b16 a[182:183], v22 offset:10496
    ds_read_b64_tr_b16 a[240:241], v22 offset:8224
    ds_read_b64_tr_b16 a[242:243], v22 offset:8480
    ds_read_b64_tr_b16 a[244:245], v22 offset:10272
    ds_read_b64_tr_b16 a[246:247], v22 offset:10528
    s_waitcnt lgkmcnt(0)
    s_waitcnt vmcnt(1)
    s_add_u32 m0, s60, 14336
    s_mov_b32 s67, 3932160
    buffer_load_dwordx4 v20, s[44:47], s67 offen lds
    s_waitcnt vmcnt(1)
    s_add_u32 m0, s60, 15360
    s_mov_b32 s67, 4063232
    buffer_load_dwordx4 v20, s[44:47], s67 offen lds
    s_waitcnt vmcnt(0)
    ds_read_b64_tr_b16 a[184:185], v22 offset:12288
    ds_read_b64_tr_b16 a[186:187], v22 offset:12544
    ds_read_b64_tr_b16 a[188:189], v22 offset:14336
    ds_read_b64_tr_b16 a[190:191], v22 offset:14592
    ds_read_b64_tr_b16 a[248:249], v22 offset:12320
    ds_read_b64_tr_b16 a[250:251], v22 offset:12576
    ds_read_b64_tr_b16 a[252:253], v22 offset:14368
    ds_read_b64_tr_b16 a[254:255], v22 offset:14624
    s_waitcnt lgkmcnt(0)
    s_branch PA_W2
PA_W1:
    s_add_u32 m0, s60, 0
    s_mov_b32 s67, 0
    buffer_load_dwordx4 v20, s[40:43], s67 offen lds
    s_add_u32 m0, s60, 1024
    s_mov_b32 s67, 131072
    buffer_load_dwordx4 v20, s[40:43], s67 offen lds
    s_add_u32 m0, s60, 2048
    s_mov_b32 s67, 262144
    buffer_load_dwordx4 v20, s[40:43], s67 offen lds
    s_waitcnt vmcnt(2)
    s_add_u32 m0, s60, 3072
    s_mov_b32 s67, 393216
    buffer_load_dwordx4 v20, s[40:43], s67 offen lds
    s_waitcnt vmcnt(2)
    s_add_u32 m0, s60, 4096
    s_mov_b32 s67, 524288
    buffer_load_dwordx4 v20, s[40:43], s67 offen lds
    s_waitcnt vmcnt(2)
    s_add_u32 m0, s60, 5120
    s_mov_b32 s67, 655360
    buffer_load_dwordx4 v20, s[40:43], s67 offen lds
    s_waitcnt vmcnt(2)
    s_add_u32 m0, s60, 6144
    s_mov_b32 s67, 786432
    buffer_load_dwordx4 v20, s[40:43], s67 offen lds
    ds_read_b64_tr_b16 a[0:1], v22 offset:0
    ds_read_b64_tr_b16 a[2:3], v22 offset:256
    ds_read_b64_tr_b16 a[4:5], v22 offset:2048
    ds_read_b64_tr_b16 a[6:7], v22 offset:2304
    ds_read_b64_tr_b16 a[64:65], v22 offset:32
    ds_read_b64_tr_b16 a[66:67], v22 offset:288
    ds_read_b64_tr_b16 a[68:69], v22 offset:2080
    ds_read_b64_tr_b16 a[70:71], v22 offset:2336
    s_waitcnt lgkmcnt(0)
    s_waitcnt vmcnt(2)
    s_add_u32 m0, s60, 7168
    s_mov_b32 s67, 917504
    buffer_load_dwordx4 v20, s[40:43], s67 offen lds
    s_waitcnt vmcnt(2)
    s_add_u32 m0, s60, 8192
    s_mov_b32 s67, 1048576
    buffer_load_dwordx4 v20, s[40:43], s67 offen lds
    s_waitcnt vmcnt(2)
    s_add_u32 m0, s60, 9216
    s_mov_b32 s67, 1179648
    buffer_load_dwordx4 v20, s[40:43], s67 offen lds
    s_waitcnt vmcnt(2)
    s_add_u32 m0, s60, 10240
    s_mov_b32 s67, 1310720
    buffer_load_dwordx4 v20, s[40:43], s67 offen lds
    ds_read_b64_tr_b16 a[8:9], v22 offset:4096
    ds_read_b64_tr_b16 a[10:11], v22 offset:4352
    ds_read_b64_tr_b16 a[12:13], v22 offset:6144
    ds_read_b64_tr_b16 a[14:15], v22 offset:6400
    ds_read_b64_tr_b16 a[72:73], v22 offset:4128
    ds_read_b64_tr_b16 a[74:75], v22 offset:4384
    ds_read_b64_tr_b16 a[76:77], v22 offset:6176
    ds_read_b64_tr_b16 a[78:79], v22 offset:6432
    s_waitcnt lgkmcnt(0)
    s_waitcnt vmcnt(2)
    s_add_u32 m0, s60, 11264
    s_mov_b32 s67, 1441792
    buffer_load_dwordx4 v20, s[40:43], s67 offen lds
    s_waitcnt vmcnt(2)
    s_add_u32 m0, s60, 12288
    s_mov_b32 s67, 1572864
    buffer_load_dwordx4 v20, s[40:43], s67 offen lds
    s_waitcnt vmcnt(2)
    s_add_u32 m0, s60, 13312
    s_mov_b32 s67, 1703936
    buffer_load_dwordx4 v20, s[40:43], s67 offen lds
    s_waitcnt vmcnt(2)
    s_add_u32 m0, s60, 14336
    s_mov_b32 s67, 1835008
    buffer_load_dwordx4 v20, s[40:43], s67 offen lds
    ds_read_b64_tr_b16 a[16:17], v22 offset:8192
    ds_read_b64_tr_b16 a[18:19], v22 offset:8448
    ds_read_b64_tr_b16 a[20:21], v22 offset:10240
    ds_read_b64_tr_b16 a[22:23], v22 offset:10496
    ds_read_b64_tr_b16 a[80:81], v22 offset:8224
    ds_read_b64_tr_b16 a[82:83], v22 offset:8480
    ds_read_b64_tr_b16 a[84:85], v22 offset:10272
    ds_read_b64_tr_b16 a[86:87], v22 offset:10528
    s_waitcnt lgkmcnt(0)
    s_waitcnt vmcnt(2)
    s_add_u32 m0, s60, 15360
    s_mov_b32 s67, 1966080
    buffer_load_dwordx4 v20, s[40:43], s67 offen lds
    s_waitcnt vmcnt(2)
    s_add_u32 m0, s60, 16384
    s_mov_b32 s67, 2097152
    buffer_load_dwordx4 v20, s[40:43], s67 offen lds
    s_waitcnt vmcnt(2)
    s_add_u32 m0, s60, 17408
    s_mov_b32 s67, 2228224
    buffer_load_dwordx4 v20, s[40:43], s67 offen lds
    s_waitcnt vmcnt(2)
    s_add_u32 m0, s60, 18432
    s_mov_b32 s67, 2359296
    buffer_load_dwordx4 v20, s[40:43], s67 offen lds
    ds_read_b64_tr_b16 a[24:25], v22 offset:12288
    ds_read_b64_tr_b16 a[26:27], v22 offset:12544
    ds_read_b64_tr_b16 a[28:29], v22 offset:14336
    ds_read_b64_tr_b16 a[30:31], v22 offset:14592
    ds_read_b64_tr_b16 a[88:89], v22 offset:12320
    ds_read_b64_tr_b16 a[90:91], v22 offset:12576
    ds_read_b64_tr_b16 a[92:93], v22 offset:14368
    ds_read_b64_tr_b16 a[94:95], v22 offset:14624
    s_waitcnt lgkmcnt(0)
    s_waitcnt vmcnt(2)
    s_add_u32 m0, s60, 19456
    s_mov_b32 s67, 2490368
    buffer_load_dwordx4 v20, s[40:43], s67 offen lds
    s_waitcnt vmcnt(2)
    s_add_u32 m0, s60, 20480
    s_mov_b32 s67, 2621440
    buffer_load_dwordx4 v20, s[40:43], s67 offen lds
    s_waitcnt vmcnt(2)
    s_add_u32 m0, s60, 21504
    s_mov_b32 s67, 2752512
    buffer_load_dwordx4 v20, s[40:43], s67 offen lds
    s_waitcnt vmcnt(2)
    s_add_u32 m0, s60, 22528
    s_mov_b32 s67, 2883584
    buffer_load_dwordx4 v20, s[40:43], s67 offen lds
    ds_read_b64_tr_b16 a[32:33], v22 offset:16384
    ds_read_b64_tr_b16 a[34:35], v22 offset:16640
    ds_read_b64_tr_b16 a[36:37], v22 offset:18432
    ds_read_b64_tr_b16 a[38:39], v22 offset:18688
    ds_read_b64_tr_b16 a[96:97], v22 offset:16416
    ds_read_b64_tr_b16 a[98:99], v22 offset:16672
    ds_read_b64_tr_b16 a[100:101], v22 offset:18464
    ds_read_b64_tr_b16 a[102:103], v22 offset:18720
    s_waitcnt lgkmcnt(0)
    s_waitcnt vmcnt(2)
    s_add_u32 m0, s60, 23552
    s_mov_b32 s67, 3014656
    buffer_load_dwordx4 v20, s[40:43], s67 offen lds
    s_waitcnt vmcnt(2)
    s_add_u32 m0, s60, 0
    s_mov_b32 s67, 3145728
    buffer_load_dwordx4 v20, s[40:43], s67 offen lds
    s_waitcnt vmcnt(2)
    s_add_u32 m0, s60, 1024
    s_mov_b32 s67, 3276800
    buffer_load_dwordx4 v20, s[40:43], s67 offen lds
    s_waitcnt vmcnt(2)
    s_add_u32 m0, s60, 2048
    s_mov_b32 s67, 3407872
    buffer_load_dwordx4 v20, s[40:43], s67 offen lds
    ds_read_b64_tr_b16 a[40:41], v22 offset:20480
    ds_read_b64_tr_b16 a[42:43], v22 offset:20736
    ds_read_b64_tr_b16 a[44:45], v22 offset:22528
    ds_read_b64_tr_b16 a[46:47], v22 offset:22784
    ds_read_b64_tr_b16 a[104:105], v22 offset:20512
    ds_read_b64_tr_b16 a[106:107], v22 offset:20768
    ds_read_b64_tr_b16 a[108:109], v22 offset:22560
    ds_read_b64_tr_b16 a[110:111], v22 offset:22816
    s_waitcnt lgkmcnt(0)
    s_waitcnt vmcnt(2)
    s_add_u32 m0, s60, 3072
    s_mov_b32 s67, 3538944
    buffer_load_dwordx4 v20, s[40:43], s67 offen lds
    s_waitcnt vmcnt(2)
    s_add_u32 m0, s60, 4096
    s_mov_b32 s67, 3670016
    buffer_load_dwordx4 v20, s[40:43], s67 offen lds
    s_waitcnt vmcnt(2)
    s_add_u32 m0, s60, 5120
    s_mov_b32 s67, 3801088
    buffer_load_dwordx4 v20, s[40:43], s67 offen lds
    s_waitcnt vmcnt(2)
    s_add_u32 m0, s60, 6144
    s_mov_b32 s67, 3932160
    buffer_load_dwordx4 v20, s[40:43], s67 offen lds
    ds_read_b64_tr_b16 a[48:49], v22 offset:0
    ds_read_b64_tr_b16 a[50:51], v22 offset:256
    ds_read_b64_tr_b16 a[52:53], v22 offset:2048
    ds_read_b64_tr_b16 a[54:55], v22 offset:2304
    ds_read_b64_tr_b16 a[112:113], v22 offset:32
    ds_read_b64_tr_b16 a[114:115], v22 offset:288
    ds_read_b64_tr_b16 a[116:117], v22 offset:2080
    ds_read_b64_tr_b16 a[118:119], v22 offset:2336
    s_waitcnt lgkmcnt(0)
    s_waitcnt vmcnt(2)
    s_add_u32 m0, s60, 7168
    s_mov_b32 s67, 4063232
    buffer_load_dwordx4 v20, s[40:43], s67 offen lds
    s_waitcnt vmcnt(2)
    s_add_u32 m0, s60, 8192
    s_mov_b32 s67, 0
    buffer_load_dwordx4 v20, s[44:47], s67 offen lds
    s_waitcnt vmcnt(2)
    s_add_u32 m0, s60, 9216
    s_mov_b32 s67, 131072
    buffer_load_dwordx4 v20, s[44:47], s67 offen lds
    s_waitcnt vmcnt(2)
    s_add_u32 m0, s60, 10240
    s_mov_b32 s67, 262144
    buffer_load_dwordx4 v20, s[44:47], s67 offen lds
    ds_read_b64_tr_b16 a[56:57], v22 offset:4096
    ds_read_b64_tr_b16 a[58:59], v22 offset:4352
    ds_read_b64_tr_b16 a[60:61], v22 offset:6144
    ds_read_b64_tr_b16 a[62:63], v22 offset:6400
    ds_read_b64_tr_b16 a[120:121], v22 offset:4128
    ds_read_b64_tr_b16 a[122:123], v22 offset:4384
    ds_read_b64_tr_b16 a[124:125], v22 offset:6176
    ds_read_b64_tr_b16 a[126:127], v22 offset:6432
    s_waitcnt lgkmcnt(0)
    s_waitcnt vmcnt(2)
    s_add_u32 m0, s60, 11264
    s_mov_b32 s67, 393216
    buffer_load_dwordx4 v20, s[44:47], s67 offen lds
    s_waitcnt vmcnt(2)
    s_add_u32 m0, s60, 12288
    s_mov_b32 s67, 524288
    buffer_load_dwordx4 v20, s[44:47], s67 offen lds
    s_waitcnt vmcnt(2)
    s_add_u32 m0, s60, 13312
    s_mov_b32 s67, 655360
    buffer_load_dwordx4 v20, s[44:47], s67 offen lds
    s_waitcnt vmcnt(2)
    s_add_u32 m0, s60, 14336
    s_mov_b32 s67, 786432
    buffer_load_dwordx4 v20, s[44:47], s67 offen lds
    ds_read_b64_tr_b16 a[128:129], v22 offset:8192
    ds_read_b64_tr_b16 a[130:131], v22 offset:8448
    ds_read_b64_tr_b16 a[132:133], v22 offset:10240
    ds_read_b64_tr_b16 a[134:135], v22 offset:10496
    ds_read_b64_tr_b16 a[192:193], v22 offset:8224
    ds_read_b64_tr_b16 a[194:195], v22 offset:8480
    ds_read_b64_tr_b16 a[196:197], v22 offset:10272
    ds_read_b64_tr_b16 a[198:199], v22 offset:10528
    s_waitcnt lgkmcnt(0)
    s_waitcnt vmcnt(2)
    s_add_u32 m0, s60, 15360
    s_mov_b32 s67, 917504
    buffer_load_dwordx4 v20, s[44:47], s67 offen lds
    s_waitcnt vmcnt(2)
    s_add_u32 m0, s60, 16384
    s_mov_b32 s67, 1048576
    buffer_load_dwordx4 v20, s[44:47], s67 offen lds
    s_waitcnt vmcnt(2)
    s_add_u32 m0, s60, 17408
    s_mov_b32 s67, 1179648
    buffer_load_dwordx4 v20, s[44:47], s67 offen lds
    s_waitcnt vmcnt(2)
    s_add_u32 m0, s60, 18432
    s_mov_b32 s67, 1310720
    buffer_load_dwordx4 v20, s[44:47], s67 offen lds
    ds_read_b64_tr_b16 a[136:137], v22 offset:12288
    ds_read_b64_tr_b16 a[138:139], v22 offset:12544
    ds_read_b64_tr_b16 a[140:141], v22 offset:14336
    ds_read_b64_tr_b16 a[142:143], v22 offset:14592
    ds_read_b64_tr_b16 a[200:201], v22 offset:12320
    ds_read_b64_tr_b16 a[202:203], v22 offset:12576
    ds_read_b64_tr_b16 a[204:205], v22 offset:14368
    ds_read_b64_tr_b16 a[206:207], v22 offset:14624
    s_waitcnt lgkmcnt(0)
    s_waitcnt vmcnt(2)
    s_add_u32 m0, s60, 19456
    s_mov_b32 s67, 1441792
    buffer_load_dwordx4 v20, s[44:47], s67 offen lds
    s_waitcnt vmcnt(2)
    s_add_u32 m0, s60, 20480
    s_mov_b32 s67, 1572864
    buffer_load_dwordx4 v20, s[44:47], s67 offen lds
    s_waitcnt vmcnt(2)
    s_add_u32 m0, s60, 21504
    s_mov_b32 s67, 1703936
    buffer_load_dwordx4 v20, s[44:47], s67 offen lds
    s_waitcnt vmcnt(2)
    s_add_u32 m0, s60, 22528
    s_mov_b32 s67, 1835008
    buffer_load_dwordx4 v20, s[44:47], s67 offen lds
    ds_read_b64_tr_b16 a[144:145], v22 offset:16384
    ds_read_b64_tr_b16 a[146:147], v22 offset:16640
    ds_read_b64_tr_b16 a[148:149], v22 offset:18432
    ds_read_b64_tr_b16 a[150:151], v22 offset:18688
    ds_read_b64_tr_b16 a[208:209], v22 offset:16416
    ds_read_b64_tr_b16 a[210:211], v22 offset:16672
    ds_read_b64_tr_b16 a[212:213], v22 offset:18464
    ds_read_b64_tr_b16 a[214:215], v22 offset:18720
    s_waitcnt lgkmcnt(0)
    s_waitcnt vmcnt(2)
    s_add_u32 m0, s60, 23552
    s_mov_b32 s67, 1966080
    buffer_load_dwordx4 v20, s[44:47], s67 offen lds
    s_waitcnt vmcnt(2)
    s_add_u32 m0, s60, 0
    s_mov_b32 s67, 2097152
    buffer_load_dwordx4 v20, s[44:47], s67 offen lds
    s_waitcnt vmcnt(2)
    s_add_u32 m0, s60, 1024
    s_mov_b32 s67, 2228224
    buffer_load_dwordx4 v20, s[44:47], s67 offen lds
    s_waitcnt vmcnt(2)
    s_add_u32 m0, s60, 2048
    s_mov_b32 s67, 2359296
    buffer_load_dwordx4 v20, s[44:47], s67 offen lds
    ds_read_b64_tr_b16 a[152:153], v22 offset:20480
    ds_read_b64_tr_b16 a[154:155], v22 offset:20736
    ds_read_b64_tr_b16 a[156:157], v22 offset:22528
    ds_read_b64_tr_b16 a[158:159], v22 offset:22784
    ds_read_b64_tr_b16 a[216:217], v22 offset:20512
    ds_read_b64_tr_b16 a[218:219], v22 offset:20768
    ds_read_b64_tr_b16 a[220:221], v22 offset:22560
    ds_read_b64_tr_b16 a[222:223], v22 offset:22816
    s_waitcnt lgkmcnt(0)
    s_waitcnt vmcnt(2)
    s_add_u32 m0, s60, 3072
    s_mov_b32 s67, 2490368
    buffer_load_dwordx4 v20, s[44:47], s67 offen lds
    s_waitcnt vmcnt(2)
    s_add_u32 m0, s60, 4096
    s_mov_b32 s67, 2621440
    buffer_load_dwordx4 v20, s[44:47], s67 offen lds
    s_waitcnt vmcnt(2)
    s_add_u32 m0, s60, 5120
    s_mov_b32 s67, 2752512
    buffer_load_dwordx4 v20, s[44:47], s67 offen lds
    s_waitcnt vmcnt(2)
    s_add_u32 m0, s60, 6144
    s_mov_b32 s67, 2883584
    buffer_load_dwordx4 v20, s[44:47], s67 offen lds
    ds_read_b64_tr_b16 a[160:161], v22 offset:0
    ds_read_b64_tr_b16 a[162:163], v22 offset:256
    ds_read_b64_tr_b16 a[164:165], v22 offset:2048
    ds_read_b64_tr_b16 a[166:167], v22 offset:2304
    ds_read_b64_tr_b16 a[224:225], v22 offset:32
    ds_read_b64_tr_b16 a[226:227], v22 offset:288
    ds_read_b64_tr_b16 a[228:229], v22 offset:2080
    ds_read_b64_tr_b16 a[230:231], v22 offset:2336
    s_waitcnt lgkmcnt(0)
    s_waitcnt vmcnt(2)
    s_add_u32 m0, s60, 7168
    s_mov_b32 s67, 3014656
    buffer_load_dwordx4 v20, s[44:47], s67 offen lds
    s_waitcnt vmcnt(2)
    s_add_u32 m0, s60, 8192
    s_mov_b32 s67, 3145728
    buffer_load_dwordx4 v20, s[44:47], s67 offen lds
    s_waitcnt vmcnt(2)
    s_add_u32 m0, s60, 9216
    s_mov_b32 s67, 3276800
    buffer_load_dwordx4 v20, s[44:47], s67 offen lds
    s_waitcnt vmcnt(2)
    s_add_u32 m0, s60, 10240
    s_mov_b32 s67, 3407872
    buffer_load_dwordx4 v20, s[44:47], s67 offen lds
    ds_read_b64_tr_b16 a[168:169], v22 offset:4096
    ds_read_b64_tr_b16 a[170:171], v22 offset:4352
    ds_read_b64_tr_b16 a[172:173], v22 offset:6144
    ds_read_b64_tr_b16 a[174:175], v22 offset:6400
    ds_read_b64_tr_b16 a[232:233], v22 offset:4128
    ds_read_b64_tr_b16 a[234:235], v22 offset:4384
    ds_read_b64_tr_b16 a[236:237], v22 offset:6176
    ds_read_b64_tr_b16 a[238:239], v22 offset:6432
    s_waitcnt lgkmcnt(0)
    s_waitcnt vmcnt(2)
    s_add_u32 m0, s60, 11264
    s_mov_b32 s67, 3538944
    buffer_load_dwordx4 v20, s[44:47], s67 offen lds
    s_waitcnt vmcnt(2)
    s_add_u32 m0, s60, 12288
    s_mov_b32 s67, 3670016
    buffer_load_dwordx4 v20, s[44:47], s67 offen lds
    s_waitcnt vmcnt(2)
    s_add_u32 m0, s60, 13312
    s_mov_b32 s67, 3801088
    buffer_load_dwordx4 v20, s[44:47], s67 offen lds
    s_waitcnt vmcnt(2)
    s_add_u32 m0, s60, 14336
    s_mov_b32 s67, 3932160
    buffer_load_dwordx4 v20, s[44:47], s67 offen lds
    ds_read_b64_tr_b16 a[176:177], v22 offset:8192
    ds_read_b64_tr_b16 a[178:179], v22 offset:8448
    ds_read_b64_tr_b16 a[180:181], v22 offset:10240
    ds_read_b64_tr_b16 a[182:183], v22 offset:10496
    ds_read_b64_tr_b16 a[240:241], v22 offset:8224
    ds_read_b64_tr_b16 a[242:243], v22 offset:8480
    ds_read_b64_tr_b16 a[244:245], v22 offset:10272
    ds_read_b64_tr_b16 a[246:247], v22 offset:10528
    s_waitcnt lgkmcnt(0)
    s_waitcnt vmcnt(2)
    s_add_u32 m0, s60, 15360
    s_mov_b32 s67, 4063232
    buffer_load_dwordx4 v20, s[44:47], s67 offen lds
    s_waitcnt vmcnt(0)
    ds_read_b64_tr_b16 a[184:185], v22 offset:12288
    ds_read_b64_tr_b16 a[186:187], v22 offset:12544
    ds_read_b64_tr_b16 a[188:189], v22 offset:14336
    ds_read_b64_tr_b16 a[190:191], v22 offset:14592
    ds_read_b64_tr_b16 a[248:249], v22 offset:12320
    ds_read_b64_tr_b16 a[250:251], v22 offset:12576
    ds_read_b64_tr_b16 a[252:253], v22 offset:14368
    ds_read_b64_tr_b16 a[254:255], v22 offset:14624
    s_waitcnt lgkmcnt(0)
PA_W2:
    v_mbcnt_lo_u32_b32 v25, -1, 0
    v_mbcnt_hi_u32_b32 v25, -1, v25
    v_lshlrev_b32 v25, 2, v25
WI_67:
    global_load_dword v24, v25, s[32:33] sc1
    s_add_u32 s65, s65, 1
    s_waitcnt vmcnt(0)
    v_readlane_b32 s67, v24, 18
    s_cmp_ge_u32 s67, 60
    s_cbranch_scc1 WID_68
    s_sleep 16
    s_cmp_lt_u32 s65, 262144
    s_cbranch_scc1 WI_67
WID_68:
    s_and_b32 s67, s50, 3
    s_lshl_b32 s67, s67, 4
    s_lshr_b32 s68, s50, 2
    s_add_u32 s67, s67, s68
    s_nop 3
    v_readlane_b32 s82, v24, s67
    s_mov_b32 s57, 0x7ffffff0
PA_LOOP:
    s_waitcnt vmcnt(4)
    s_barrier
    s_lshl_b32 s67, s61, 15
    s_add_u32 s56, s56, s67
    s_xor_b32 s55, s55, 0x8000
    ds_read_b128 v[32:35], v5 offset:0
    ds_read_b128 v[36:39], v5 offset:16384
    ds_read_b128 v[40:43], v5 offset:1024
    ds_read_b128 v[44:47], v5 offset:17408
    ds_read_b128 v[48:51], v5 offset:2048
    ds_read_b128 v[52:55], v5 offset:18432
    s_waitcnt lgkmcnt(5)
    v_mfma_f32_16x16x32_bf16 v[64:67], a[0:3], v[32:35], 0
    ds_read_b128 v[56:59], v5 offset:3072
    v_mfma_f32_16x16x32_bf16 v[72:75], a[64:67], v[32:35], 0
    v_mfma_f32_16x16x32_bf16 v[80:83], v[32:35], a[128:131], 0
    v_mfma_f32_16x16x32_bf16 v[88:91], v[32:35], a[192:195], 0
    s_waitcnt lgkmcnt(5)
    v_mfma_f32_16x16x32_bf16 v[68:71], a[0:3], v[36:39], 0
    ds_read_b128 v[60:63], v5 offset:19456
    v_mfma_f32_16x16x32_bf16 v[76:79], a[64:67], v[36:39], 0
    v_mfma_f32_16x16x32_bf16 v[84:87], v[36:39], a[128:131], 0
    v_mfma_f32_16x16x32_bf16 v[92:95], v[36:39], a[192:195], 0
    s_add_u32 m0, s55, 0
    s_add_u32 s67, s56, 0
    buffer_load_dwordx4 v4, s[84:87], s67 offen lds
    s_waitcnt lgkmcnt(5)
    v_mfma_f32_16x16x32_bf16 v[64:67], a[4:7], v[40:43], v[64:67]
    ds_read_b128 v[32:35], v5 offset:4096
    v_mfma_f32_16x16x32_bf16 v[72:75], a[68:71], v[40:43], v[72:75]
    v_mfma_f32_16x16x32_bf16 v[80:83], v[40:43], a[132:135], v[80:83]
    v_mfma_f32_16x16x32_bf16 v[88:91], v[40:43], a[196:199], v[88:91]
    s_waitcnt lgkmcnt(5)
    v_mfma_f32_16x16x32_bf16 v[68:71], a[4:7], v[44:47], v[68:71]
    ds_read_b128 v[36:39], v5 offset:20480
    v_mfma_f32_16x16x32_bf16 v[76:79], a[68:71], v[44:47], v[76:79]
    v_mfma_f32_16x16x32_bf16 v[84:87], v[44:47], a[132:135], v[84:87]
    v_mfma_f32_16x16x32_bf16 v[92:95], v[44:47], a[196:199], v[92:95]
    s_waitcnt lgkmcnt(5)
    v_mfma_f32_16x16x32_bf16 v[64:67], a[8:11], v[48:51], v[64:67]
    ds_read_b128 v[40:43], v5 offset:5120
    v_mfma_f32_16x16x32_bf16 v[72:75], a[72:75], v[48:51], v[72:75]
    v_mfma_f32_16x16x32_bf16 v[80:83], v[48:51], a[136:139], v[80:83]
    v_mfma_f32_16x16x32_bf16 v[88:91], v[48:51], a[200:203], v[88:91]
    s_add_u32 m0, s55, 1024
    s_add_u32 s67, s56, 64
    buffer_load_dwordx4 v4, s[84:87], s67 offen lds
    s_waitcnt lgkmcnt(5)
    v_mfma_f32_16x16x32_bf16 v[68:71], a[8:11], v[52:55], v[68:71]
    ds_read_b128 v[44:47], v5 offset:21504
    v_mfma_f32_16x16x32_bf16 v[76:79], a[72:75], v[52:55], v[76:79]
    v_mfma_f32_16x16x32_bf16 v[84:87], v[52:55], a[136:139], v[84:87]
    v_mfma_f32_16x16x32_bf16 v[92:95], v[52:55], a[200:203], v[92:95]
    s_waitcnt lgkmcnt(5)
    v_mfma_f32_16x16x32_bf16 v[64:67], a[12:15], v[56:59], v[64:67]
    ds_read_b128 v[48:51], v5 offset:6144
    v_mfma_f32_16x16x32_bf16 v[72:75], a[76:79], v[56:59], v[72:75]
    v_mfma_f32_16x16x32_bf16 v[80:83], v[56:59], a[140:143], v[80:83]
    v_mfma_f32_16x16x32_bf16 v[88:91], v[56:59], a[204:207], v[88:91]
    s_waitcnt lgkmcnt(5)
    v_mfma_f32_16x16x32_bf16 v[68:71], a[12:15], v[60:63], v[68:71]
    ds_read_b128 v[52:55], v5 offset:22528
    v_mfma_f32_16x16x32_bf16 v[76:79], a[76:79], v[60:63], v[76:79]
    v_mfma_f32_16x16x32_bf16 v[84:87], v[60:63], a[140:143], v[84:87]
    v_mfma_f32_16x16x32_bf16 v[92:95], v[60:63], a[204:207], v[92:95]
    s_add_u32 m0, s55, 2048
    s_add_u32 s67, s56, 128
    buffer_load_dwordx4 v4, s[84:87], s67 offen lds
    s_waitcnt lgkmcnt(5)
    v_mfma_f32_16x16x32_bf16 v[64:67], a[16:19], v[32:35], v[64:67]
    ds_read_b128 v[56:59], v5 offset:7168
    v_mfma_f32_16x16x32_bf16 v[72:75], a[80:83], v[32:35], v[72:75]
    v_mfma_f32_16x16x32_bf16 v[80:83], v[32:35], a[144:147], v[80:83]
    v_mfma_f32_16x16x32_bf16 v[88:91], v[32:35], a[208:211], v[88:91]
    s_waitcnt lgkmcnt(5)
    v_mfma_f32_16x16x32_bf16 v[68:71], a[16:19], v[36:39], v[68:71]
    ds_read_b128 v[60:63], v5 offset:23552
    v_mfma_f32_16x16x32_bf16 v[76:79], a[80:83], v[36:39], v[76:79]
    v_mfma_f32_16x16x32_bf16 v[84:87], v[36:39], a[144:147], v[84:87]
    v_mfma_f32_16x16x32_bf16 v[92:95], v[36:39], a[208:211], v[92:95]
    s_waitcnt lgkmcnt(5)
    v_mfma_f32_16x16x32_bf16 v[64:67], a[20:23], v[40:43], v[64:67]
    ds_read_b128 v[32:35], v5 offset:8192
    v_mfma_f32_16x16x32_bf16 v[72:75], a[84:87], v[40:43], v[72:75]
    v_mfma_f32_16x16x32_bf16 v[80:83], v[40:43], a[148:151], v[80:83]
    v_mfma_f32_16x16x32_bf16 v[88:91], v[40:43], a[212:215], v[88:91]
    s_add_u32 m0, s55, 3072
    s_add_u32 s67, s56, 192
    buffer_load_dwordx4 v4, s[84:87], s67 offen lds
    s_waitcnt lgkmcnt(5)
    v_mfma_f32_16x16x32_bf16 v[68:71], a[20:23], v[44:47], v[68:71]
    ds_read_b128 v[36:39], v5 offset:24576
    v_mfma_f32_16x16x32_bf16 v[76:79], a[84:87], v[44:47], v[76:79]
    v_mfma_f32_16x16x32_bf16 v[84:87], v[44:47], a[148:151], v[84:87]
    v_mfma_f32_16x16x32_bf16 v[92:95], v[44:47], a[212:215], v[92:95]
    s_waitcnt lgkmcnt(5)
    v_mfma_f32_16x16x32_bf16 v[64:67], a[24:27], v[48:51], v[64:67]
    ds_read_b128 v[40:43], v5 offset:9216
    v_mfma_f32_16x16x32_bf16 v[72:75], a[88:91], v[48:51], v[72:75]
    v_mfma_f32_16x16x32_bf16 v[80:83], v[48:51], a[152:155], v[80:83]
    v_mfma_f32_16x16x32_bf16 v[88:91], v[48:51], a[216:219], v[88:91]
    s_waitcnt lgkmcnt(5)
    v_mfma_f32_16x16x32_bf16 v[68:71], a[24:27], v[52:55], v[68:71]
    ds_read_b128 v[44:47], v5 offset:25600
    v_mfma_f32_16x16x32_bf16 v[76:79], a[88:91], v[52:55], v[76:79]
    v_mfma_f32_16x16x32_bf16 v[84:87], v[52:55], a[152:155], v[84:87]
    v_mfma_f32_16x16x32_bf16 v[92:95], v[52:55], a[216:219], v[92:95]
    s_add_u32 m0, s55, 4096
    s_add_u32 s67, s56, 256
    buffer_load_dwordx4 v4, s[84:87], s67 offen lds
    s_waitcnt lgkmcnt(5)
    v_mfma_f32_16x16x32_bf16 v[64:67], a[28:31], v[56:59], v[64:67]
    ds_read_b128 v[48:51], v5 offset:10240
    v_mfma_f32_16x16x32_bf16 v[72:75], a[92:95], v[56:59], v[72:75]
    v_mfma_f32_16x16x32_bf16 v[80:83], v[56:59], a[156:159], v[80:83]
    v_mfma_f32_16x16x32_bf16 v[88:91], v[56:59], a[220:223], v[88:91]
    s_waitcnt vmcnt(5)
    s_barrier
    v_mov_b32 v6, 1
    v_mov_b32 v7, s57
    s_mov_b64 exec, s[76:77]
    buffer_store_dword v6, v7, s[36:39], 0 offen sc1
    s_mov_b64 exec, -1
    s_waitcnt lgkmcnt(5)
    v_mfma_f32_16x16x32_bf16 v[68:71], a[28:31], v[60:63], v[68:71]
    ds_read_b128 v[52:55], v5 offset:26624
    v_mfma_f32_16x16x32_bf16 v[76:79], a[92:95], v[60:63], v[76:79]
    v_mfma_f32_16x16x32_bf16 v[84:87], v[60:63], a[156:159], v[84:87]
    v_mfma_f32_16x16x32_bf16 v[92:95], v[60:63], a[220:223], v[92:95]
    s_waitcnt lgkmcnt(5)
    v_mfma_f32_16x16x32_bf16 v[64:67], a[32:35], v[32:35], v[64:67]
    ds_read_b128 v[56:59], v5 offset:11264
    v_mfma_f32_16x16x32_bf16 v[72:75], a[96:99], v[32:35], v[72:75]
    v_mfma_f32_16x16x32_bf16 v[80:83], v[32:35], a[160:163], v[80:83]
    v_mfma_f32_16x16x32_bf16 v[88:91], v[32:35], a[224:227], v[88:91]
    s_add_u32 m0, s55, 5120
    s_add_u32 s67, s56, 320
    buffer_load_dwordx4 v4, s[84:87], s67 offen lds
    s_waitcnt lgkmcnt(5)
    v_mfma_f32_16x16x32_bf16 v[68:71], a[32:35], v[36:39], v[68:71]
    ds_read_b128 v[60:63], v5 offset:27648
    v_mfma_f32_16x16x32_bf16 v[76:79], a[96:99], v[36:39], v[76:79]
    v_mfma_f32_16x16x32_bf16 v[84:87], v[36:39], a[160:163], v[84:87]
    v_mfma_f32_16x16x32_bf16 v[92:95], v[36:39], a[224:227], v[92:95]
    s_waitcnt lgkmcnt(5)
    v_mfma_f32_16x16x32_bf16 v[64:67], a[36:39], v[40:43], v[64:67]
    ds_read_b128 v[32:35], v5 offset:12288
    v_mfma_f32_16x16x32_bf16 v[72:75], a[100:103], v[40:43], v[72:75]
    v_mfma_f32_16x16x32_bf16 v[80:83], v[40:43], a[164:167], v[80:83]
    v_mfma_f32_16x16x32_bf16 v[88:91], v[40:43], a[228:231], v[88:91]
    s_waitcnt lgkmcnt(5)
    v_mfma_f32_16x16x32_bf16 v[68:71], a[36:39], v[44:47], v[68:71]
    ds_read_b128 v[36:39], v5 offset:28672
    v_mfma_f32_16x16x32_bf16 v[76:79], a[100:103], v[44:47], v[76:79]
    v_mfma_f32_16x16x32_bf16 v[84:87], v[44:47], a[164:167], v[84:87]
    v_mfma_f32_16x16x32_bf16 v[92:95], v[44:47], a[228:231], v[92:95]
    s_add_u32 m0, s55, 6144
    s_add_u32 s67, s56, 384
    buffer_load_dwordx4 v4, s[84:87], s67 offen lds
    s_waitcnt lgkmcnt(5)
    v_mfma_f32_16x16x32_bf16 v[64:67], a[40:43], v[48:51], v[64:67]
    ds_read_b128 v[40:43], v5 offset:13312
    v_mfma_f32_16x16x32_bf16 v[72:75], a[104:107], v[48:51], v[72:75]
    v_mfma_f32_16x16x32_bf16 v[80:83], v[48:51], a[168:171], v[80:83]
    v_mfma_f32_16x16x32_bf16 v[88:91], v[48:51], a[232:235], v[88:91]
    s_waitcnt lgkmcnt(5)
    v_mfma_f32_16x16x32_bf16 v[68:71], a[40:43], v[52:55], v[68:71]
    ds_read_b128 v[44:47], v5 offset:29696
    v_mfma_f32_16x16x32_bf16 v[76:79], a[104:107], v[52:55], v[76:79]
    v_mfma_f32_16x16x32_bf16 v[84:87], v[52:55], a[168:171], v[84:87]
    v_mfma_f32_16x16x32_bf16 v[92:95], v[52:55], a[232:235], v[92:95]
    s_waitcnt lgkmcnt(5)
    v_mfma_f32_16x16x32_bf16 v[64:67], a[44:47], v[56:59], v[64:67]
    ds_read_b128 v[48:51], v5 offset:14336
    v_mfma_f32_16x16x32_bf16 v[72:75], a[108:111], v[56:59], v[72:75]
    v_mfma_f32_16x16x32_bf16 v[80:83], v[56:59], a[172:175], v[80:83]
    v_mfma_f32_16x16x32_bf16 v[88:91], v[56:59], a[236:239], v[88:91]
    s_add_u32 m0, s55, 7168
    s_add_u32 s67, s56, 448
    buffer_load_dwordx4 v4, s[84:87], s67 offen lds
    s_waitcnt lgkmcnt(5)
    v_mfma_f32_16x16x32_bf16 v[68:71], a[44:47], v[60:63], v[68:71]
    ds_read_b128 v[52:55], v5 offset:30720
    v_mfma_f32_16x16x32_bf16 v[76:79], a[108:111], v[60:63], v[76:79]
    v_mfma_f32_16x16x32_bf16 v[84:87], v[60:63], a[172:175], v[84:87]
    v_mfma_f32_16x16x32_bf16 v[92:95], v[60:63], a[236:239], v[92:95]
    s_waitcnt lgkmcnt(5)
    v_mfma_f32_16x16x32_bf16 v[64:67], a[48:51], v[32:35], v[64:67]
    ds_read_b128 v[56:59], v5 offset:15360
    v_mfma_f32_16x16x32_bf16 v[72:75], a[112:115], v[32:35], v[72:75]
    v_mfma_f32_16x16x32_bf16 v[80:83], v[32:35], a[176:179], v[80:83]
    v_mfma_f32_16x16x32_bf16 v[88:91], v[32:35], a[240:243], v[88:91]
    s_waitcnt lgkmcnt(5)
    v_mfma_f32_16x16x32_bf16 v[68:71], a[48:51], v[36:39], v[68:71]
    ds_read_b128 v[60:63], v5 offset:31744
    v_mfma_f32_16x16x32_bf16 v[76:79], a[112:115], v[36:39], v[76:79]
    v_mfma_f32_16x16x32_bf16 v[84:87], v[36:39], a[176:179], v[84:87]
    v_mfma_f32_16x16x32_bf16 v[92:95], v[36:39], a[240:243], v[92:95]
    s_waitcnt lgkmcnt(5)
    v_mfma_f32_16x16x32_bf16 v[64:67], a[52:55], v[40:43], v[64:67]
    v_mfma_f32_16x16x32_bf16 v[72:75], a[116:119], v[40:43], v[72:75]
    v_mfma_f32_16x16x32_bf16 v[80:83], v[40:43], a[180:183], v[80:83]
    v_mfma_f32_16x16x32_bf16 v[88:91], v[40:43], a[244:247], v[88:91]
    s_waitcnt lgkmcnt(4)
    v_mfma_f32_16x16x32_bf16 v[68:71], a[52:55], v[44:47], v[68:71]
    v_mfma_f32_16x16x32_bf16 v[76:79], a[116:119], v[44:47], v[76:79]
    v_mfma_f32_16x16x32_bf16 v[84:87], v[44:47], a[180:183], v[84:87]
    v_mfma_f32_16x16x32_bf16 v[92:95], v[44:47], a[244:247], v[92:95]
    s_waitcnt lgkmcnt(3)
    v_mfma_f32_16x16x32_bf16 v[64:67], a[56:59], v[48:51], v[64:67]
    v_mfma_f32_16x16x32_bf16 v[72:75], a[120:123], v[48:51], v[72:75]
    v_mfma_f32_16x16x32_bf16 v[80:83], v[48:51], a[184:187], v[80:83]
    v_mfma_f32_16x16x32_bf16 v[88:91], v[48:51], a[248:251], v[88:91]
    s_waitcnt lgkmcnt(2)
    v_mfma_f32_16x16x32_bf16 v[68:71], a[56:59], v[52:55], v[68:71]
    v_mfma_f32_16x16x32_bf16 v[76:79], a[120:123], v[52:55], v[76:79]
    v_mfma_f32_16x16x32_bf16 v[84:87], v[52:55], a[184:187], v[84:87]
    v_mfma_f32_16x16x32_bf16 v[92:95], v[52:55], a[248:251], v[92:95]
    s_waitcnt lgkmcnt(1)
    v_mfma_f32_16x16x32_bf16 v[64:67], a[60:63], v[56:59], v[64:67]
    v_mfma_f32_16x16x32_bf16 v[72:75], a[124:127], v[56:59], v[72:75]
    v_mfma_f32_16x16x32_bf16 v[80:83], v[56:59], a[188:191], v[80:83]
    v_mfma_f32_16x16x32_bf16 v[88:91], v[56:59], a[252:255], v[88:91]
    s_waitcnt lgkmcnt(0)
    v_mfma_f32_16x16x32_bf16 v[68:71], a[60:63], v[60:63], v[68:71]
    v_mfma_f32_16x16x32_bf16 v[76:79], a[124:127], v[60:63], v[76:79]
    v_mfma_f32_16x16x32_bf16 v[84:87], v[60:63], a[188:191], v[84:87]
    v_mfma_f32_16x16x32_bf16 v[92:95], v[60:63], a[252:255], v[92:95]
    v_xor_b32 v5, 0x8000, v5
    s_lshl_b32 s58, s53, 19
    s_lshl_b32 s67, s51, 14
    s_add_u32 s58, s58, s67
    s_add_u32 s58, s58, 16777216
    s_lshl_b32 s67, s48, 10
    s_add_u32 s68, s58, s67
    s_nop 0
    s_lshl_b32 s57, s51, 6
    s_add_u32 s57, s57, s53
    s_lshl_b32 s57, s57, 2
    v_cvt_pk_bf16_f32 v96, v64, v65
    v_cvt_pk_bf16_f32 v97, v66, v67
    v_cvt_pk_bf16_f32 v98, v72, v73
    v_cvt_pk_bf16_f32 v99, v74, v75
    buffer_store_dwordx4 v[96:99], v3, s[36:39], s68 offen sc1
    s_add_u32 s68, s68, 4096
    v_cvt_pk_bf16_f32 v100, v68, v69
    v_cvt_pk_bf16_f32 v101, v70, v71
    v_cvt_pk_bf16_f32 v102, v76, v77
    v_cvt_pk_bf16_f32 v103, v78, v79
    buffer_store_dwordx4 v[100:103], v3, s[36:39], s68 offen sc1
    s_add_u32 s68, s68, 4096
    s_add_u32 s68, s68, s67
    v_cvt_pk_bf16_f32 v104, v80, v81
    v_cvt_pk_bf16_f32 v105, v82, v83
    v_cvt_pk_bf16_f32 v106, v84, v85
    v_cvt_pk_bf16_f32 v107, v86, v87
    buffer_store_dwordx4 v[104:107], v3, s[36:39], s68 offen offset:0 sc1
    v_cvt_pk_bf16_f32 v108, v88, v89
    v_cvt_pk_bf16_f32 v109, v90, v91
    v_cvt_pk_bf16_f32 v110, v92, v93
    v_cvt_pk_bf16_f32 v111, v94, v95
    buffer_store_dwordx4 v[108:111], v3, s[36:39], s68 offen offset:1024 sc1
    s_add_u32 s53, s53, s61
    s_cmp_lt_u32 s53, s66
    s_cbranch_scc1 PA_LOOP
    s_waitcnt vmcnt(0)
    s_barrier
    v_mov_b32 v6, 1
    v_mov_b32 v7, s57
    s_mov_b64 exec, s[76:77]
    buffer_store_dword v6, v7, s[36:39], 0 offen sc1
    s_mov_b64 exec, -1
    s_mov_b32 s40, s20
    s_mov_b32 s41, s21
    s_mov_b32 s42, 4194304
    s_mov_b32 s43, 0x20000
    s_mov_b32 s44, s26
    s_mov_b32 s45, s27
    s_mov_b32 s46, 4194304
    s_mov_b32 s47, 0x20000
    v_and_b32 v18, 3, v0
    v_lshrrev_b32 v19, 2, v0
    s_lshl_b32 s67, s51, 8
    s_lshl_b32 s68, s48, 6
    s_add_u32 s67, s67, s68
    v_lshlrev_b32 v20, 13, v19
    v_lshl_add_u32 v20, v18, 4, v20
    v_add_u32 v20, s67, v20
    s_lshl_b32 s67, s48, 20
    s_lshl_b32 s68, s51, 5
    s_add_u32 s67, s67, s68
    v_lshrrev_b32 v21, 1, v0
    v_lshlrev_b32 v21, 10, v21
    v_and_b32 v24, 1, v0
    v_lshl_add_u32 v21, v24, 4, v21
    v_add_u32 v21, s67, v21
    s_mul_i32 s60, s48, 24576
    s_add_u32 s60, s60, 65536
    v_lshrrev_b32 v24, 2, v1
    v_lshl_add_u32 v22, v2, 3, v24
    v_lshlrev_b32 v22, 6, v22
    v_lshl_add_u32 v22, v18, 3, v22
    v_add_u32 v22, s60, v22
    v_lshl_add_u32 v23, v2, 2, v24
    v_lshlrev_b32 v23, 5, v23
    v_lshl_add_u32 v23, v18, 3, v23
    v_add_u32 v23, s60, v23
    s_mov_b32 s53, s52
    s_lshl_b32 s56, s53, 15
    s_lshl_b32 s55, s48, 13
    v_mov_b32 v5, v3
    s_add_u32 m0, s55, 0
    s_add_u32 s67, s56, 0
    buffer_load_dwordx4 v4, s[84:87], s67 offen lds
    s_add_u32 m0, s55, 1024
    s_add_u32 s67, s56, 64
    buffer_load_dwordx4 v4, s[84:87], s67 offen lds
    s_add_u32 m0, s55, 2048
    s_add_u32 s67, s56, 128
    buffer_load_dwordx4 v4, s[84:87], s67 offen lds
    s_add_u32 m0, s55, 3072
    s_add_u32 s67, s56, 192
    buffer_load_dwordx4 v4, s[84:87], s67 offen lds
    s_add_u32 m0, s55, 4096
    s_add_u32 s67, s56, 256
    buffer_load_dwordx4 v4, s[84:87], s67 offen lds
    s_add_u32 m0, s55, 5120
    s_add_u32 s67, s56, 320
    buffer_load_dwordx4 v4, s[84:87], s67 offen lds
    s_add_u32 m0, s55, 6144
    s_add_u32 s67, s56, 384
    buffer_load_dwordx4 v4, s[84:87], s67 offen lds
    s_add_u32 m0, s55, 7168
    s_add_u32 s67, s56, 448
    buffer_load_dwordx4 v4, s[84:87], s67 offen lds
    s_add_u32 m0, s60, 0
    s_mov_b32 s67, 0
    buffer_load_dwordx4 v20, s[40:43], s67 offen lds
    s_add_u32 m0, s60, 1024
    s_mov_b32 s67, 131072
    buffer_load_dwordx4 v20, s[40:43], s67 offen lds
    s_waitcnt vmcnt(1)
    s_add_u32 m0, s60, 2048
    s_mov_b32 s67, 262144
    buffer_load_dwordx4 v20, s[40:43], s67 offen lds
    s_waitcnt vmcnt(1)
    s_add_u32 m0, s60, 3072
    s_mov_b32 s67, 393216
    buffer_load_dwordx4 v20, s[40:43], s67 offen lds
    s_waitcnt vmcnt(1)
    s_add_u32 m0, s60, 4096
    s_mov_b32 s67, 524288
    buffer_load_dwordx4 v20, s[40:43], s67 offen lds
    s_waitcnt vmcnt(1)
    s_add_u32 m0, s60, 5120
    s_mov_b32 s67, 655360
    buffer_load_dwordx4 v20, s[40:43], s67 offen lds
    ds_read_b64_tr_b16 a[0:1], v22 offset:0
    ds_read_b64_tr_b16 a[2:3], v22 offset:256
    ds_read_b64_tr_b16 a[4:5], v22 offset:2048
    ds_read_b64_tr_b16 a[6:7], v22 offset:2304
    ds_read_b64_tr_b16 a[64:65], v22 offset:32
    ds_read_b64_tr_b16 a[66:67], v22 offset:288
    ds_read_b64_tr_b16 a[68:69], v22 offset:2080
    ds_read_b64_tr_b16 a[70:71], v22 offset:2336
    s_waitcnt lgkmcnt(0)
    s_waitcnt vmcnt(1)
    s_add_u32 m0, s60, 6144
    s_mov_b32 s67, 786432
    buffer_load_dwordx4 v20, s[40:43], s67 offen lds
    s_waitcnt vmcnt(1)
    s_add_u32 m0, s60, 7168
    s_mov_b32 s67, 917504
    buffer_load_dwordx4 v20, s[40:43], s67 offen lds
    s_waitcnt vmcnt(1)
    s_add_u32 m0, s60, 8192
    s_mov_b32 s67, 1048576
    buffer_load_dwordx4 v20, s[40:43], s67 offen lds
    s_waitcnt vmcnt(1)
    s_add_u32 m0, s60, 9216
    s_mov_b32 s67, 1179648
    buffer_load_dwordx4 v20, s[40:43], s67 offen lds
    ds_read_b64_tr_b16 a[8:9], v22 offset:4096
    ds_read_b64_tr_b16 a[10:11], v22 offset:4352
    ds_read_b64_tr_b16 a[12:13], v22 offset:6144
    ds_read_b64_tr_b16 a[14:15], v22 offset:6400
    ds_read_b64_tr_b16 a[72:73], v22 offset:4128
    ds_read_b64_tr_b16 a[74:75], v22 offset:4384
    ds_read_b64_tr_b16 a[76:77], v22 offset:6176
    ds_read_b64_tr_b16 a[78:79], v22 offset:6432
    s_waitcnt lgkmcnt(0)
    s_waitcnt vmcnt(1)
    s_add_u32 m0, s60, 10240
    s_mov_b32 s67, 1310720
    buffer_load_dwordx4 v20, s[40:43], s67 offen lds
    s_waitcnt vmcnt(1)
    s_add_u32 m0, s60, 11264
    s_mov_b32 s67, 1441792
    buffer_load_dwordx4 v20, s[40:43], s67 offen lds
    s_waitcnt vmcnt(1)
    s_add_u32 m0, s60, 12288
    s_mov_b32 s67, 1572864
    buffer_load_dwordx4 v20, s[40:43], s67 offen lds
    s_waitcnt vmcnt(1)
    s_add_u32 m0, s60, 13312
    s_mov_b32 s67, 1703936
    buffer_load_dwordx4 v20, s[40:43], s67 offen lds
    ds_read_b64_tr_b16 a[16:17], v22 offset:8192
    ds_read_b64_tr_b16 a[18:19], v22 offset:8448
    ds_read_b64_tr_b16 a[20:21], v22 offset:10240
    ds_read_b64_tr_b16 a[22:23], v22 offset:10496
    ds_read_b64_tr_b16 a[80:81], v22 offset:8224
    ds_read_b64_tr_b16 a[82:83], v22 offset:8480
    ds_read_b64_tr_b16 a[84:85], v22 offset:10272
    ds_read_b64_tr_b16 a[86:87], v22 offset:10528
    s_waitcnt lgkmcnt(0)
    s_waitcnt vmcnt(1)
    s_add_u32 m0, s60, 14336
    s_mov_b32 s67, 1835008
    buffer_load_dwordx4 v20, s[40:43], s67 offen lds
    s_waitcnt vmcnt(1)
    s_add_u32 m0, s60, 15360
    s_mov_b32 s67, 1966080
    buffer_load_dwordx4 v20, s[40:43], s67 offen lds
    s_waitcnt vmcnt(1)
    s_add_u32 m0, s60, 16384
    s_mov_b32 s67, 2097152
    buffer_load_dwordx4 v20, s[40:43], s67 offen lds
    s_waitcnt vmcnt(1)
    s_add_u32 m0, s60, 17408
    s_mov_b32 s67, 2228224
    buffer_load_dwordx4 v20, s[40:43], s67 offen lds
    ds_read_b64_tr_b16 a[24:25], v22 offset:12288
    ds_read_b64_tr_b16 a[26:27], v22 offset:12544
    ds_read_b64_tr_b16 a[28:29], v22 offset:14336
    ds_read_b64_tr_b16 a[30:31], v22 offset:14592
    ds_read_b64_tr_b16 a[88:89], v22 offset:12320
    ds_read_b64_tr_b16 a[90:91], v22 offset:12576
    ds_read_b64_tr_b16 a[92:93], v22 offset:14368
    ds_read_b64_tr_b16 a[94:95], v22 offset:14624
    s_waitcnt lgkmcnt(0)
    s_waitcnt vmcnt(1)
    s_add_u32 m0, s60, 18432
    s_mov_b32 s67, 2359296
    buffer_load_dwordx4 v20, s[40:43], s67 offen lds
    s_waitcnt vmcnt(1)
    s_add_u32 m0, s60, 19456
    s_mov_b32 s67, 2490368
    buffer_load_dwordx4 v20, s[40:43], s67 offen lds
    s_waitcnt vmcnt(1)
    s_add_u32 m0, s60, 20480
    s_mov_b32 s67, 2621440
    buffer_load_dwordx4 v20, s[40:43], s67 offen lds
    s_waitcnt vmcnt(1)
    s_add_u32 m0, s60, 21504
    s_mov_b32 s67, 2752512
    buffer_load_dwordx4 v20, s[40:43], s67 offen lds
    ds_read_b64_tr_b16 a[32:33], v22 offset:16384
    ds_read_b64_tr_b16 a[34:35], v22 offset:16640
    ds_read_b64_tr_b16 a[36:37], v22 offset:18432
    ds_read_b64_tr_b16 a[38:39], v22 offset:18688
    ds_read_b64_tr_b16 a[96:97], v22 offset:16416
    ds_read_b64_tr_b16 a[98:99], v22 offset:16672
    ds_read_b64_tr_b16 a[100:101], v22 offset:18464
    ds_read_b64_tr_b16 a[102:103], v22 offset:18720
    s_waitcnt lgkmcnt(0)
    s_waitcnt vmcnt(1)
    s_add_u32 m0, s60, 22528
    s_mov_b32 s67, 2883584
    buffer_load_dwordx4 v20, s[40:43], s67 offen lds
    s_waitcnt vmcnt(1)
    s_add_u32 m0, s60, 23552
    s_mov_b32 s67, 3014656
    buffer_load_dwordx4 v20, s[40:43], s67 offen lds
    s_waitcnt vmcnt(1)
    s_add_u32 m0, s60, 0
    s_mov_b32 s67, 3145728
    buffer_load_dwordx4 v20, s[40:43], s67 offen lds
    s_waitcnt vmcnt(1)
    s_add_u32 m0, s60, 1024
    s_mov_b32 s67, 3276800
    buffer_load_dwordx4 v20, s[40:43], s67 offen lds
    ds_read_b64_tr_b16 a[40:41], v22 offset:20480
    ds_read_b64_tr_b16 a[42:43], v22 offset:20736
    ds_read_b64_tr_b16 a[44:45], v22 offset:22528
    ds_read_b64_tr_b16 a[46:47], v22 offset:22784
    ds_read_b64_tr_b16 a[104:105], v22 offset:20512
    ds_read_b64_tr_b16 a[106:107], v22 offset:20768
    ds_read_b64_tr_b16 a[108:109], v22 offset:22560
    ds_read_b64_tr_b16 a[110:111], v22 offset:22816
    s_waitcnt lgkmcnt(0)
    s_waitcnt vmcnt(1)
    s_add_u32 m0, s60, 2048
    s_mov_b32 s67, 3407872
    buffer_load_dwordx4 v20, s[40:43], s67 offen lds
    s_waitcnt vmcnt(1)
    s_add_u32 m0, s60, 3072
    s_mov_b32 s67, 3538944
    buffer_load_dwordx4 v20, s[40:43], s67 offen lds
    s_waitcnt vmcnt(1)
    s_add_u32 m0, s60, 4096
    s_mov_b32 s67, 3670016
    buffer_load_dwordx4 v20, s[40:43], s67 offen lds
    s_waitcnt vmcnt(1)
    s_add_u32 m0, s60, 5120
    s_mov_b32 s67, 3801088
    buffer_load_dwordx4 v20, s[40:43], s67 offen lds
    ds_read_b64_tr_b16 a[48:49], v22 offset:0
    ds_read_b64_tr_b16 a[50:51], v22 offset:256
    ds_read_b64_tr_b16 a[52:53], v22 offset:2048
    ds_read_b64_tr_b16 a[54:55], v22 offset:2304
    ds_read_b64_tr_b16 a[112:113], v22 offset:32
    ds_read_b64_tr_b16 a[114:115], v22 offset:288
    ds_read_b64_tr_b16 a[116:117], v22 offset:2080
    ds_read_b64_tr_b16 a[118:119], v22 offset:2336
    s_waitcnt lgkmcnt(0)
    s_waitcnt vmcnt(1)
    s_add_u32 m0, s60, 6144
    s_mov_b32 s67, 3932160
    buffer_load_dwordx4 v20, s[40:43], s67 offen lds
    s_waitcnt vmcnt(1)
    s_add_u32 m0, s60, 7168
    s_mov_b32 s67, 4063232
    buffer_load_dwordx4 v20, s[40:43], s67 offen lds
    s_waitcnt vmcnt(1)
    s_add_u32 m0, s60, 8192
    s_mov_b32 s67, 0
    buffer_load_dwordx4 v21, s[44:47], s67 offen lds
    s_waitcnt vmcnt(1)
    s_add_u32 m0, s60, 9216
    s_mov_b32 s67, 32768
    buffer_load_dwordx4 v21, s[44:47], s67 offen lds
    ds_read_b64_tr_b16 a[56:57], v22 offset:4096
    ds_read_b64_tr_b16 a[58:59], v22 offset:4352
    ds_read_b64_tr_b16 a[60:61], v22 offset:6144
    ds_read_b64_tr_b16 a[62:63], v22 offset:6400
    ds_read_b64_tr_b16 a[120:121], v22 offset:4128
    ds_read_b64_tr_b16 a[122:123], v22 offset:4384
    ds_read_b64_tr_b16 a[124:125], v22 offset:6176
    ds_read_b64_tr_b16 a[126:127], v22 offset:6432
    s_waitcnt lgkmcnt(0)
    s_waitcnt vmcnt(1)
    s_add_u32 m0, s60, 10240
    s_mov_b32 s67, 65536
    buffer_load_dwordx4 v21, s[44:47], s67 offen lds
    s_waitcnt vmcnt(1)
    s_add_u32 m0, s60, 11264
    s_mov_b32 s67, 98304
    buffer_load_dwordx4 v21, s[44:47], s67 offen lds
    s_waitcnt vmcnt(1)
    s_add_u32 m0, s60, 12288
    s_mov_b32 s67, 131072
    buffer_load_dwordx4 v21, s[44:47], s67 offen lds
    s_waitcnt vmcnt(1)
    s_add_u32 m0, s60, 13312
    s_mov_b32 s67, 163840
    buffer_load_dwordx4 v21, s[44:47], s67 offen lds
    ds_read_b64_tr_b16 a[128:129], v23 offset:8192
    ds_read_b64_tr_b16 a[130:131], v23 offset:8704
    ds_read_b64_tr_b16 a[132:133], v23 offset:9216
    ds_read_b64_tr_b16 a[134:135], v23 offset:9728
    ds_read_b64_tr_b16 a[136:137], v23 offset:10240
    ds_read_b64_tr_b16 a[138:139], v23 offset:10752
    ds_read_b64_tr_b16 a[140:141], v23 offset:11264
    ds_read_b64_tr_b16 a[142:143], v23 offset:11776
    s_waitcnt lgkmcnt(0)
    s_waitcnt vmcnt(1)
    s_add_u32 m0, s60, 14336
    s_mov_b32 s67, 196608
    buffer_load_dwordx4 v21, s[44:47], s67 offen lds
    s_waitcnt vmcnt(1)
    s_add_u32 m0, s60, 15360
    s_mov_b32 s67, 229376
    buffer_load_dwordx4 v21, s[44:47], s67 offen lds
    s_waitcnt vmcnt(1)
    s_add_u32 m0, s60, 16384
    s_mov_b32 s67, 262144
    buffer_load_dwordx4 v21, s[44:47], s67 offen lds
    s_waitcnt vmcnt(1)
    s_add_u32 m0, s60, 17408
    s_mov_b32 s67, 294912
    buffer_load_dwordx4 v21, s[44:47], s67 offen lds
    ds_read_b64_tr_b16 a[144:145], v23 offset:12288
    ds_read_b64_tr_b16 a[146:147], v23 offset:12800
    ds_read_b64_tr_b16 a[148:149], v23 offset:13312
    ds_read_b64_tr_b16 a[150:151], v23 offset:13824
    ds_read_b64_tr_b16 a[152:153], v23 offset:14336
    ds_read_b64_tr_b16 a[154:155], v23 offset:14848
    ds_read_b64_tr_b16 a[156:157], v23 offset:15360
    ds_read_b64_tr_b16 a[158:159], v23 offset:15872
    s_waitcnt lgkmcnt(0)
    s_waitcnt vmcnt(1)
    s_add_u32 m0, s60, 18432
    s_mov_b32 s67, 327680
    buffer_load_dwordx4 v21, s[44:47], s67 offen lds
    s_waitcnt vmcnt(1)
    s_add_u32 m0, s60, 19456
    s_mov_b32 s67, 360448
    buffer_load_dwordx4 v21, s[44:47], s67 offen lds
    s_waitcnt vmcnt(1)
    s_add_u32 m0, s60, 20480
    s_mov_b32 s67, 393216
    buffer_load_dwordx4 v21, s[44:47], s67 offen lds
    s_waitcnt vmcnt(1)
    s_add_u32 m0, s60, 21504
    s_mov_b32 s67, 425984
    buffer_load_dwordx4 v21, s[44:47], s67 offen lds
    ds_read_b64_tr_b16 a[160:161], v23 offset:16384
    ds_read_b64_tr_b16 a[162:163], v23 offset:16896
    ds_read_b64_tr_b16 a[164:165], v23 offset:17408
    ds_read_b64_tr_b16 a[166:167], v23 offset:17920
    ds_read_b64_tr_b16 a[168:169], v23 offset:18432
    ds_read_b64_tr_b16 a[170:171], v23 offset:18944
    ds_read_b64_tr_b16 a[172:173], v23 offset:19456
    ds_read_b64_tr_b16 a[174:175], v23 offset:19968
    s_waitcnt lgkmcnt(0)
    s_waitcnt vmcnt(1)
    s_add_u32 m0, s60, 22528
    s_mov_b32 s67, 458752
    buffer_load_dwordx4 v21, s[44:47], s67 offen lds
    s_waitcnt vmcnt(1)
    s_add_u32 m0, s60, 23552
    s_mov_b32 s67, 491520
    buffer_load_dwordx4 v21, s[44:47], s67 offen lds
    s_waitcnt vmcnt(1)
    s_add_u32 m0, s60, 0
    s_mov_b32 s67, 524288
    buffer_load_dwordx4 v21, s[44:47], s67 offen lds
    s_waitcnt vmcnt(1)
    s_add_u32 m0, s60, 1024
    s_mov_b32 s67, 557056
    buffer_load_dwordx4 v21, s[44:47], s67 offen lds
    ds_read_b64_tr_b16 a[176:177], v23 offset:20480
    ds_read_b64_tr_b16 a[178:179], v23 offset:20992
    ds_read_b64_tr_b16 a[180:181], v23 offset:21504
    ds_read_b64_tr_b16 a[182:183], v23 offset:22016
    ds_read_b64_tr_b16 a[184:185], v23 offset:22528
    ds_read_b64_tr_b16 a[186:187], v23 offset:23040
    ds_read_b64_tr_b16 a[188:189], v23 offset:23552
    ds_read_b64_tr_b16 a[190:191], v23 offset:24064
    s_waitcnt lgkmcnt(0)
    s_waitcnt vmcnt(1)
    s_add_u32 m0, s60, 2048
    s_mov_b32 s67, 589824
    buffer_load_dwordx4 v21, s[44:47], s67 offen lds
    s_waitcnt vmcnt(1)
    s_add_u32 m0, s60, 3072
    s_mov_b32 s67, 622592
    buffer_load_dwordx4 v21, s[44:47], s67 offen lds
    s_waitcnt vmcnt(1)
    s_add_u32 m0, s60, 4096
    s_mov_b32 s67, 655360
    buffer_load_dwordx4 v21, s[44:47], s67 offen lds
    s_waitcnt vmcnt(1)
    s_add_u32 m0, s60, 5120
    s_mov_b32 s67, 688128
    buffer_load_dwordx4 v21, s[44:47], s67 offen lds
    ds_read_b64_tr_b16 a[192:193], v23 offset:0
    ds_read_b64_tr_b16 a[194:195], v23 offset:512
    ds_read_b64_tr_b16 a[196:197], v23 offset:1024
    ds_read_b64_tr_b16 a[198:199], v23 offset:1536
    ds_read_b64_tr_b16 a[200:201], v23 offset:2048
    ds_read_b64_tr_b16 a[202:203], v23 offset:2560
    ds_read_b64_tr_b16 a[204:205], v23 offset:3072
    ds_read_b64_tr_b16 a[206:207], v23 offset:3584
    s_waitcnt lgkmcnt(0)
    s_waitcnt vmcnt(1)
    s_add_u32 m0, s60, 6144
    s_mov_b32 s67, 720896
    buffer_load_dwordx4 v21, s[44:47], s67 offen lds
    s_waitcnt vmcnt(1)
    s_add_u32 m0, s60, 7168
    s_mov_b32 s67, 753664
    buffer_load_dwordx4 v21, s[44:47], s67 offen lds
    s_waitcnt vmcnt(1)
    s_add_u32 m0, s60, 8192
    s_mov_b32 s67, 786432
    buffer_load_dwordx4 v21, s[44:47], s67 offen lds
    s_waitcnt vmcnt(1)
    s_add_u32 m0, s60, 9216
    s_mov_b32 s67, 819200
    buffer_load_dwordx4 v21, s[44:47], s67 offen lds
    ds_read_b64_tr_b16 a[208:209], v23 offset:4096
    ds_read_b64_tr_b16 a[210:211], v23 offset:4608
    ds_read_b64_tr_b16 a[212:213], v23 offset:5120
    ds_read_b64_tr_b16 a[214:215], v23 offset:5632
    ds_read_b64_tr_b16 a[216:217], v23 offset:6144
    ds_read_b64_tr_b16 a[218:219], v23 offset:6656
    ds_read_b64_tr_b16 a[220:221], v23 offset:7168
    ds_read_b64_tr_b16 a[222:223], v23 offset:7680
    s_waitcnt lgkmcnt(0)
    s_waitcnt vmcnt(1)
    s_add_u32 m0, s60, 10240
    s_mov_b32 s67, 851968
    buffer_load_dwordx4 v21, s[44:47], s67 offen lds
    s_waitcnt vmcnt(1)
    s_add_u32 m0, s60, 11264
    s_mov_b32 s67, 884736
    buffer_load_dwordx4 v21, s[44:47], s67 offen lds
    s_waitcnt vmcnt(1)
    s_add_u32 m0, s60, 12288
    s_mov_b32 s67, 917504
    buffer_load_dwordx4 v21, s[44:47], s67 offen lds
    s_waitcnt vmcnt(1)
    s_add_u32 m0, s60, 13312
    s_mov_b32 s67, 950272
    buffer_load_dwordx4 v21, s[44:47], s67 offen lds
    ds_read_b64_tr_b16 a[224:225], v23 offset:8192
    ds_read_b64_tr_b16 a[226:227], v23 offset:8704
    ds_read_b64_tr_b16 a[228:229], v23 offset:9216
    ds_read_b64_tr_b16 a[230:231], v23 offset:9728
    ds_read_b64_tr_b16 a[232:233], v23 offset:10240
    ds_read_b64_tr_b16 a[234:235], v23 offset:10752
    ds_read_b64_tr_b16 a[236:237], v23 offset:11264
    ds_read_b64_tr_b16 a[238:239], v23 offset:11776
    s_waitcnt lgkmcnt(0)
    s_waitcnt vmcnt(1)
    s_add_u32 m0, s60, 14336
    s_mov_b32 s67, 983040
    buffer_load_dwordx4 v21, s[44:47], s67 offen lds
    s_waitcnt vmcnt(1)
    s_add_u32 m0, s60, 15360
    s_mov_b32 s67, 1015808
    buffer_load_dwordx4 v21, s[44:47], s67 offen lds
    s_waitcnt vmcnt(0)
    ds_read_b64_tr_b16 a[240:241], v23 offset:12288
    ds_read_b64_tr_b16 a[242:243], v23 offset:12800
    ds_read_b64_tr_b16 a[244:245], v23 offset:13312
    ds_read_b64_tr_b16 a[246:247], v23 offset:13824
    ds_read_b64_tr_b16 a[248:249], v23 offset:14336
    ds_read_b64_tr_b16 a[250:251], v23 offset:14848
    ds_read_b64_tr_b16 a[252:253], v23 offset:15360
    ds_read_b64_tr_b16 a[254:255], v23 offset:15872
    s_waitcnt lgkmcnt(0)
    s_mov_b32 s88, s30
    s_mov_b32 s89, s31
    s_mov_b32 s90, 2097152
    s_mov_b32 s91, 0x20000
    s_mov_b32 s40, s28
    s_mov_b32 s41, s29
    s_mov_b32 s42, 1024
    s_mov_b32 s43, 0x20000
    buffer_load_dwordx4 v[16:19], v3, s[40:43], 0 offen
    s_and_b32 s62, s48, 1
    s_lshr_b32 s63, s48, 1
    v_lshlrev_b32 v8, 2, v2
    v_sub_u32 v8, v1, v8
    s_lshl_b32 s67, s62, 4
    v_add_u32 v8, s67, v8
    v_subrev_u32 v9, 16, v8
    v_lshrrev_b32 v25, 2, v1
    v_lshl_add_u32 v25, v2, 2, v25
    v_and_b32 v24, 1, v0
    v_lshlrev_b32 v24, 3, v24
    v_lshl_add_u32 v10, v25, 4, v24
    v_add_u32 v10, 73728, v10
    s_lshl_b32 s67, s48, 9
    s_add_u32 s67, s67, 73728
    v_lshlrev_b32 v22, 4, v1
    v_lshl_add_u32 v22, v2, 2, v22
    v_add_u32 v22, s67, v22
    s_lshl_b32 s67, s48, 9
    v_lshl_add_u32 v23, v0, 3, s67
    v_and_b32 v24, 1, v2
    v_lshl_add_u32 v11, v24, 5, v1
    v_lshlrev_b32 v11, 3, v11
    s_lshl_b32 s67, s63, 10
    s_add_u32 s67, s67, 2048
    v_add_u32 v11, s67, v11
    v_lshrrev_b32 v24, 2, v0
    v_and_b32 v25, 3, v0
    v_lshlrev_b32 v12, 10, v24
    v_lshl_add_u32 v12, v25, 8, v12
    s_lshr_b32 s67, s51, 4
    s_lshl_b32 s67, s67, 14
    s_and_b32 s68, s51, 15
    s_lshl_b32 s68, s68, 4
    s_add_u32 s67, s67, s68
    v_add_u32 v12, s67, v12
    s_lshl_b32 s67, s48, 3
    v_lshrrev_b32 v24, 3, v0
    v_add_u32 v24, s67, v24
    v_and_b32 v25, 7, v0
    v_lshrrev_b32 v26, 4, v24
    v_and_b32 v27, 15, v24
    v_lshlrev_b32 v13, 10, v26
    v_lshl_add_u32 v13, v27, 4, v13
    v_lshrrev_b32 v26, 1, v25
    v_lshl_add_u32 v13, v26, 8, v13
    v_and_b32 v26, 1, v25
    v_lshl_add_u32 v13, v26, 3, v13
    v_add_u32 v13, 77824, v13
    s_lshl_b32 s67, s51, 16
    v_lshlrev_b32 v14, 13, v25
    v_lshl_add_u32 v14, v24, 1, v14
    v_add_u32 v14, s67, v14
    s_lshl_b32 s67, s51, 5
    v_lshlrev_b32 v15, 10, v24
    v_lshl_add_u32 v15, v25, 2, v15
    v_add_u32 v15, s67, v15
    v_and_b32 v20, 31, v0
    v_lshlrev_b32 v20, 7, v20
    v_lshlrev_b32 v21, 2, v24
    s_lshl_b32 s81, s51, 7
    s_add_u32 s81, s81, 16384
    s_mov_b32 s80, 0x3e0293ee
    v_lshlrev_b32 v24, 2, v0
    s_mov_b32 s58, 20480
    s_mov_b32 s59, 20736
    s_lshl_b32 s54, s51, 8
    v_mov_b32 v26, 0
    v_mov_b32 v31, 0
    s_mov_b32 s75, 0
    s_mov_b32 s74, -1
PB_LOOP:
    s_lshl_b32 s54, s51, 6
    s_add_u32 s54, s54, s53
    s_lshl_b32 s54, s54, 2
    s_cmp_eq_u32 s48, 0
    s_cbranch_scc0 KVWD_70
    v_cmp_gt_u32 vcc, 1, v31
    s_cbranch_vccz KVWD_70
KVW_69:
    buffer_load_dword v31, v26, s[36:39], s54 offen sc1
    s_add_u32 s65, s65, 1
    s_waitcnt vmcnt(0)
    v_cmp_gt_u32 vcc, 1, v31
    s_cbranch_vccz KVWD_70
    s_sleep 16
    s_cmp_lt_u32 s65, 262144
    s_cbranch_scc1 KVW_69
KVWD_70:
    s_waitcnt vmcnt(0)
    s_barrier
    s_add_u32 s54, s54, 28
    s_sub_u32 exec_lo, 0, s76
    s_mov_b32 exec_hi, exec_lo
    buffer_load_dword v30, off, s[36:39], s81 sc1
    buffer_load_dword v31, off, s[36:39], s54 sc1
    s_mov_b64 exec, -1
    s_lshl_b32 s58, s53, 19
    s_lshl_b32 s67, s51, 14
    s_add_u32 s58, s58, s67
    s_add_u32 s58, s58, 16777216
    s_add_u32 s59, s58, 4096
    s_lshl_b32 s67, s63, 12
    s_add_u32 s54, s58, s67
    s_add_u32 s54, s54, 8192
    ds_read_b128 v[224:227], v12
    ds_read_b128 v[80:83], v5 offset:0
    ds_read_b128 v[84:87], v5 offset:16384
    ds_read_b128 v[88:91], v5 offset:1024
    ds_read_b128 v[92:95], v5 offset:17408
    ds_read_b128 v[96:99], v5 offset:2048
    ds_read_b128 v[100:103], v5 offset:18432
    s_waitcnt lgkmcnt(5)
    v_mfma_f32_16x16x32_bf16 v[112:115], a[0:3], v[80:83], 0
    ds_read_b128 v[104:107], v5 offset:3072
    v_mfma_f32_16x16x32_bf16 v[120:123], a[64:67], v[80:83], 0
    s_waitcnt lgkmcnt(5)
    v_mfma_f32_16x16x32_bf16 v[116:119], a[0:3], v[84:87], 0
    ds_read_b128 v[108:111], v5 offset:19456
    v_mfma_f32_16x16x32_bf16 v[124:127], a[64:67], v[84:87], 0
    buffer_load_dwordx4 v[32:35], v3, s[36:39], s58 offen offset:0 sc1
    s_waitcnt lgkmcnt(5)
    v_mfma_f32_16x16x32_bf16 v[112:115], a[4:7], v[88:91], v[112:115]
    ds_read_b128 v[80:83], v5 offset:4096
    v_mfma_f32_16x16x32_bf16 v[120:123], a[68:71], v[88:91], v[120:123]
    s_waitcnt lgkmcnt(5)
    v_mfma_f32_16x16x32_bf16 v[116:119], a[4:7], v[92:95], v[116:119]
    ds_read_b128 v[84:87], v5 offset:20480
    v_mfma_f32_16x16x32_bf16 v[124:127], a[68:71], v[92:95], v[124:127]
    buffer_load_dwordx4 v[48:51], v3, s[36:39], s59 offen offset:0 sc1
    s_waitcnt lgkmcnt(5)
    v_mfma_f32_16x16x32_bf16 v[112:115], a[8:11], v[96:99], v[112:115]
    ds_read_b128 v[88:91], v5 offset:5120
    v_mfma_f32_16x16x32_bf16 v[120:123], a[72:75], v[96:99], v[120:123]
    s_waitcnt lgkmcnt(5)
    v_mfma_f32_16x16x32_bf16 v[116:119], a[8:11], v[100:103], v[116:119]
    ds_read_b128 v[92:95], v5 offset:21504
    v_mfma_f32_16x16x32_bf16 v[124:127], a[72:75], v[100:103], v[124:127]
    buffer_load_dwordx4 v[64:67], v3, s[36:39], s54 offen offset:0 sc1
    s_waitcnt lgkmcnt(5)
    v_mfma_f32_16x16x32_bf16 v[112:115], a[12:15], v[104:107], v[112:115]
    ds_read_b128 v[96:99], v5 offset:6144
    v_mfma_f32_16x16x32_bf16 v[120:123], a[76:79], v[104:107], v[120:123]
    s_waitcnt lgkmcnt(5)
    v_mfma_f32_16x16x32_bf16 v[116:119], a[12:15], v[108:111], v[116:119]
    ds_read_b128 v[100:103], v5 offset:22528
    v_mfma_f32_16x16x32_bf16 v[124:127], a[76:79], v[108:111], v[124:127]
    buffer_load_dwordx4 v[36:39], v3, s[36:39], s58 offen offset:1024 sc1
    s_waitcnt lgkmcnt(5)
    v_mfma_f32_16x16x32_bf16 v[112:115], a[16:19], v[80:83], v[112:115]
    ds_read_b128 v[104:107], v5 offset:7168
    v_mfma_f32_16x16x32_bf16 v[120:123], a[80:83], v[80:83], v[120:123]
    s_waitcnt lgkmcnt(5)
    v_mfma_f32_16x16x32_bf16 v[116:119], a[16:19], v[84:87], v[116:119]
    ds_read_b128 v[108:111], v5 offset:23552
    v_mfma_f32_16x16x32_bf16 v[124:127], a[80:83], v[84:87], v[124:127]
    buffer_load_dwordx4 v[52:55], v3, s[36:39], s59 offen offset:1024 sc1
    s_waitcnt lgkmcnt(5)
    v_mfma_f32_16x16x32_bf16 v[112:115], a[20:23], v[88:91], v[112:115]
    ds_read_b128 v[80:83], v5 offset:8192
    v_mfma_f32_16x16x32_bf16 v[120:123], a[84:87], v[88:91], v[120:123]
    s_waitcnt lgkmcnt(5)
    v_mfma_f32_16x16x32_bf16 v[116:119], a[20:23], v[92:95], v[116:119]
    ds_read_b128 v[84:87], v5 offset:24576
    v_mfma_f32_16x16x32_bf16 v[124:127], a[84:87], v[92:95], v[124:127]
    buffer_load_dwordx4 v[68:71], v3, s[36:39], s54 offen offset:1024 sc1
    s_waitcnt lgkmcnt(5)
    v_mfma_f32_16x16x32_bf16 v[112:115], a[24:27], v[96:99], v[112:115]
    ds_read_b128 v[88:91], v5 offset:9216
    v_mfma_f32_16x16x32_bf16 v[120:123], a[88:91], v[96:99], v[120:123]
    s_waitcnt lgkmcnt(5)
    v_mfma_f32_16x16x32_bf16 v[116:119], a[24:27], v[100:103], v[116:119]
    ds_read_b128 v[92:95], v5 offset:25600
    v_mfma_f32_16x16x32_bf16 v[124:127], a[88:91], v[100:103], v[124:127]
    buffer_load_dwordx4 v[40:43], v3, s[36:39], s58 offen offset:2048 sc1
    s_waitcnt lgkmcnt(5)
    v_mfma_f32_16x16x32_bf16 v[112:115], a[28:31], v[104:107], v[112:115]
    ds_read_b128 v[96:99], v5 offset:10240
    v_mfma_f32_16x16x32_bf16 v[120:123], a[92:95], v[104:107], v[120:123]
    s_waitcnt lgkmcnt(5)
    v_mfma_f32_16x16x32_bf16 v[116:119], a[28:31], v[108:111], v[116:119]
    ds_read_b128 v[100:103], v5 offset:26624
    v_mfma_f32_16x16x32_bf16 v[124:127], a[92:95], v[108:111], v[124:127]
    buffer_load_dwordx4 v[56:59], v3, s[36:39], s59 offen offset:2048 sc1
    s_waitcnt lgkmcnt(5)
    v_mfma_f32_16x16x32_bf16 v[112:115], a[32:35], v[80:83], v[112:115]
    ds_read_b128 v[104:107], v5 offset:11264
    v_mfma_f32_16x16x32_bf16 v[120:123], a[96:99], v[80:83], v[120:123]
    s_waitcnt lgkmcnt(5)
    v_mfma_f32_16x16x32_bf16 v[116:119], a[32:35], v[84:87], v[116:119]
    ds_read_b128 v[108:111], v5 offset:27648
    v_mfma_f32_16x16x32_bf16 v[124:127], a[96:99], v[84:87], v[124:127]
    buffer_load_dwordx4 v[72:75], v3, s[36:39], s54 offen offset:2048 sc1
    s_waitcnt lgkmcnt(5)
    v_mfma_f32_16x16x32_bf16 v[112:115], a[36:39], v[88:91], v[112:115]
    ds_read_b128 v[80:83], v5 offset:12288
    v_mfma_f32_16x16x32_bf16 v[120:123], a[100:103], v[88:91], v[120:123]
    s_waitcnt lgkmcnt(5)
    v_mfma_f32_16x16x32_bf16 v[116:119], a[36:39], v[92:95], v[116:119]
    ds_read_b128 v[84:87], v5 offset:28672
    v_mfma_f32_16x16x32_bf16 v[124:127], a[100:103], v[92:95], v[124:127]
    buffer_load_dwordx4 v[44:47], v3, s[36:39], s58 offen offset:3072 sc1
    s_waitcnt lgkmcnt(5)
    v_mfma_f32_16x16x32_bf16 v[112:115], a[40:43], v[96:99], v[112:115]
    ds_read_b128 v[88:91], v5 offset:13312
    v_mfma_f32_16x16x32_bf16 v[120:123], a[104:107], v[96:99], v[120:123]
    s_waitcnt lgkmcnt(5)
    v_mfma_f32_16x16x32_bf16 v[116:119], a[40:43], v[100:103], v[116:119]
    ds_read_b128 v[92:95], v5 offset:29696
    v_mfma_f32_16x16x32_bf16 v[124:127], a[104:107], v[100:103], v[124:127]
    buffer_load_dwordx4 v[60:63], v3, s[36:39], s59 offen offset:3072 sc1
    s_waitcnt lgkmcnt(5)
    v_mfma_f32_16x16x32_bf16 v[112:115], a[44:47], v[104:107], v[112:115]
    ds_read_b128 v[96:99], v5 offset:14336
    v_mfma_f32_16x16x32_bf16 v[120:123], a[108:111], v[104:107], v[120:123]
    s_waitcnt lgkmcnt(5)
    v_mfma_f32_16x16x32_bf16 v[116:119], a[44:47], v[108:111], v[116:119]
    ds_read_b128 v[100:103], v5 offset:30720
    v_mfma_f32_16x16x32_bf16 v[124:127], a[108:111], v[108:111], v[124:127]
    buffer_load_dwordx4 v[76:79], v3, s[36:39], s54 offen offset:3072 sc1
    s_waitcnt lgkmcnt(5)
    v_mfma_f32_16x16x32_bf16 v[112:115], a[48:51], v[80:83], v[112:115]
    ds_read_b128 v[104:107], v5 offset:15360
    v_mfma_f32_16x16x32_bf16 v[120:123], a[112:115], v[80:83], v[120:123]
    s_waitcnt lgkmcnt(5)
    v_mfma_f32_16x16x32_bf16 v[116:119], a[48:51], v[84:87], v[116:119]
    ds_read_b128 v[108:111], v5 offset:31744
    v_mfma_f32_16x16x32_bf16 v[124:127], a[112:115], v[84:87], v[124:127]
    s_waitcnt lgkmcnt(5)
    v_mfma_f32_16x16x32_bf16 v[112:115], a[52:55], v[88:91], v[112:115]
    v_mfma_f32_16x16x32_bf16 v[120:123], a[116:119], v[88:91], v[120:123]
    s_waitcnt lgkmcnt(4)
    v_mfma_f32_16x16x32_bf16 v[116:119], a[52:55], v[92:95], v[116:119]
    v_mfma_f32_16x16x32_bf16 v[124:127], a[116:119], v[92:95], v[124:127]
    s_waitcnt lgkmcnt(3)
    v_mfma_f32_16x16x32_bf16 v[112:115], a[56:59], v[96:99], v[112:115]
    v_mfma_f32_16x16x32_bf16 v[120:123], a[120:123], v[96:99], v[120:123]
    s_waitcnt lgkmcnt(2)
    v_mfma_f32_16x16x32_bf16 v[116:119], a[56:59], v[100:103], v[116:119]
    v_mfma_f32_16x16x32_bf16 v[124:127], a[120:123], v[100:103], v[124:127]
    s_waitcnt lgkmcnt(1)
    v_mfma_f32_16x16x32_bf16 v[112:115], a[60:63], v[104:107], v[112:115]
    v_mfma_f32_16x16x32_bf16 v[120:123], a[124:127], v[104:107], v[120:123]
    s_waitcnt lgkmcnt(0)
    v_mfma_f32_16x16x32_bf16 v[116:119], a[60:63], v[108:111], v[116:119]
    v_mfma_f32_16x16x32_bf16 v[124:127], a[124:127], v[108:111], v[124:127]
    s_lshl_b32 s67, s74, 12
    s_add_u32 s67, s67, 524288
    s_sub_u32 exec_lo, 0, s76
    s_mov_b32 exec_hi, exec_lo
    buffer_load_dword v25, v20, s[36:39], s67 offen sc1
    s_mov_b64 exec, -1
    v_lshlrev_b32 v228, 16, v224
    v_and_b32 v229, 0xffff0000, v224
    v_lshlrev_b32 v230, 16, v16
    v_and_b32 v231, 0xffff0000, v16
    v_mul_f32 v228, v228, v230
    v_mul_f32 v229, v229, v231
    v_cvt_pk_bf16_f32 v230, v228, v229
    v_lshlrev_b32 v228, 16, v230
    v_and_b32 v229, 0xffff0000, v230
    v_add_f32 v224, v228, v229
    v_lshlrev_b32 v228, 16, v225
    v_and_b32 v229, 0xffff0000, v225
    v_lshlrev_b32 v230, 16, v17
    v_and_b32 v231, 0xffff0000, v17
    v_mul_f32 v228, v228, v230
    v_mul_f32 v229, v229, v231
    v_cvt_pk_bf16_f32 v230, v228, v229
    v_lshlrev_b32 v228, 16, v230
    v_and_b32 v229, 0xffff0000, v230
    v_add_f32 v225, v228, v229
    v_lshlrev_b32 v228, 16, v226
    v_and_b32 v229, 0xffff0000, v226
    v_lshlrev_b32 v230, 16, v18
    v_and_b32 v231, 0xffff0000, v18
    v_mul_f32 v228, v228, v230
    v_mul_f32 v229, v229, v231
    v_cvt_pk_bf16_f32 v230, v228, v229
    v_lshlrev_b32 v228, 16, v230
    v_and_b32 v229, 0xffff0000, v230
    v_add_f32 v226, v228, v229
    v_lshlrev_b32 v228, 16, v227
    v_and_b32 v229, 0xffff0000, v227
    v_lshlrev_b32 v230, 16, v19
    v_and_b32 v231, 0xffff0000, v19
    v_mul_f32 v228, v228, v230
    v_mul_f32 v229, v229, v231
    v_cvt_pk_bf16_f32 v230, v228, v229
    v_lshlrev_b32 v228, 16, v230
    v_and_b32 v229, 0xffff0000, v230
    v_add_f32 v227, v228, v229
    v_add_f32 v224, v224, v225
    v_add_f32 v226, v226, v227
    v_add_f32 v224, v224, v226
    v_cvt_pk_bf16_f32 v232, v112, v113
    v_cvt_pk_bf16_f32 v233, v114, v115
    v_cvt_pk_bf16_f32 v234, v120, v121
    v_cvt_pk_bf16_f32 v235, v122, v123
    v_cvt_pk_bf16_f32 v236, v116, v117
    v_cvt_pk_bf16_f32 v237, v118, v119
    v_cvt_pk_bf16_f32 v238, v124, v125
    v_cvt_pk_bf16_f32 v239, v126, v127
    s_lshl_b32 s67, s48, 10
    s_add_u32 s67, s67, 65536
    v_add_u32 v6, s67, v3
    ds_write_b128 v6, v[232:235]
    ds_write_b128 v6, v[236:239] offset:4096
    s_nop 1
    v_add_f32_dpp v224, v224, v224 row_ror:1 row_mask:0xf bank_mask:0xf
    s_nop 1
    v_add_f32_dpp v224, v224, v224 row_ror:2 row_mask:0xf bank_mask:0xf
    s_nop 1
    v_add_f32_dpp v224, v224, v224 row_ror:4 row_mask:0xf bank_mask:0xf
    s_nop 1
    v_add_f32_dpp v224, v224, v224 row_ror:8 row_mask:0xf bank_mask:0xf
    v_mov_b32 v225, v224
    s_nop 1
    v_permlane16_swap_b32 v224, v225
    v_add_f32 v224, v224, v225
    v_mov_b32 v225, v224
    s_nop 1
    v_permlane32_swap_b32 v224, v225
    v_add_f32 v224, v224, v225
    v_cvt_pk_bf16_f32 v224, v224, v224
    v_lshlrev_b32 v224, 16, v224
    v_mul_f32 v224, 0xbfb8aa3b, v224
    v_exp_f32 v224, v224
    s_nop 0
    v_add_f32 v224, 1.0, v224
    v_rcp_f32 v224, v224
    s_nop 0
    v_cvt_pk_bf16_f32 v224, v224, v224
    v_lshlrev_b32 v224, 16, v224
    s_lshl_b32 s67, s53, 5
    s_add_u32 s67, s67, s51
    s_lshl_b32 s67, s67, 2
    s_add_u32 s67, s67, 88080384
    v_mov_b32 v7, 0
    s_mov_b64 exec, s[76:77]
    buffer_store_dword v224, v7, s[36:39], s67 offen sc1
    s_mov_b64 exec, -1
    s_waitcnt vmcnt(14)
    v_mov_b32 v6, 86016
    s_mov_b64 exec, s[76:77]
    ds_write_b32 v6, v30
    s_mov_b64 exec, -1
    s_waitcnt lgkmcnt(0)
    s_barrier
    ds_read_b32 v30, v6
    s_add_u32 s56, s56, 229376
    s_xor_b32 s55, s55, 0x8000
    s_lshl_b32 s67, s62, 12
    s_add_u32 s67, s67, 65536
    v_add_u32 v6, s67, v3
    ds_read_b128 v[232:235], v6 offset:0
    ds_read_b128 v[236:239], v6 offset:1024
    ds_read_b128 v[240:243], v6 offset:2048
    ds_read_b128 v[244:247], v6 offset:3072
    v_xor_b32 v5, 0x8000, v5
    v_xor_b32 v12, 0x8000, v12
    s_waitcnt vmcnt(1) lgkmcnt(0)
    v_mfma_f32_16x16x32_bf16 v[216:219], v[32:35], v[232:235], 0
    v_mfma_f32_16x16x32_bf16 v[220:223], v[48:51], v[232:235], 0
    v_mfma_f32_16x16x32_bf16 v[216:219], v[36:39], v[236:239], v[216:219]
    v_mfma_f32_16x16x32_bf16 v[220:223], v[52:55], v[236:239], v[220:223]
    v_mfma_f32_16x16x32_bf16 v[216:219], v[40:43], v[240:243], v[216:219]
    v_mfma_f32_16x16x32_bf16 v[220:223], v[56:59], v[240:243], v[220:223]
    v_mfma_f32_16x16x32_bf16 v[216:219], v[44:47], v[244:247], v[216:219]
    v_mfma_f32_16x16x32_bf16 v[220:223], v[60:63], v[244:247], v[220:223]
    s_add_u32 m0, s55, 0
    s_add_u32 s67, s56, 0
    buffer_load_dwordx4 v4, s[84:87], s67 offen lds
    s_add_u32 m0, s55, 1024
    s_add_u32 s67, s56, 64
    buffer_load_dwordx4 v4, s[84:87], s67 offen lds
    s_add_u32 m0, s55, 2048
    s_add_u32 s67, s56, 128
    buffer_load_dwordx4 v4, s[84:87], s67 offen lds
    s_add_u32 m0, s55, 3072
    s_add_u32 s67, s56, 192
    buffer_load_dwordx4 v4, s[84:87], s67 offen lds
    s_add_u32 m0, s55, 4096
    s_add_u32 s67, s56, 256
    buffer_load_dwordx4 v4, s[84:87], s67 offen lds
    s_add_u32 m0, s55, 5120
    s_add_u32 s67, s56, 320
    buffer_load_dwordx4 v4, s[84:87], s67 offen lds
    s_add_u32 m0, s55, 6144
    s_add_u32 s67, s56, 384
    buffer_load_dwordx4 v4, s[84:87], s67 offen lds
    s_add_u32 m0, s55, 7168
    s_add_u32 s67, s56, 448
    buffer_load_dwordx4 v4, s[84:87], s67 offen lds
    v_mov_b32 v224, 0xf149f2ca
    v_cmp_le_i32 vcc, 0, v8
    s_nop 1
    v_cndmask_b32 v216, v224, v216, vcc
    v_cmp_le_i32 vcc, 1, v8
    s_nop 1
    v_cndmask_b32 v217, v224, v217, vcc
    v_cmp_le_i32 vcc, 2, v8
    s_nop 1
    v_cndmask_b32 v218, v224, v218, vcc
    v_cmp_le_i32 vcc, 3, v8
    s_nop 1
    v_cndmask_b32 v219, v224, v219, vcc
    v_cmp_le_i32 vcc, 0, v9
    s_nop 1
    v_cndmask_b32 v220, v224, v220, vcc
    v_cmp_le_i32 vcc, 1, v9
    s_nop 1
    v_cndmask_b32 v221, v224, v221, vcc
    v_cmp_le_i32 vcc, 2, v9
    s_nop 1
    v_cndmask_b32 v222, v224, v222, vcc
    v_cmp_le_i32 vcc, 3, v9
    s_nop 1
    v_cndmask_b32 v223, v224, v223, vcc
    v_max3_f32 v27, v216, v217, v218
    v_max3_f32 v224, v220, v221, v222
    v_max3_f32 v27, v27, v219, v223
    v_max_f32 v27, v27, v224
    s_lshl_b32 s92, s53, 17
    s_lshl_b32 s67, s51, 12
    s_add_u32 s92, s92, s67
    s_add_u32 s92, s92, 50593792
    v_readfirstlane_b32 s93, v30
    s_cmp_gt_u32 s93, s53
    s_cbranch_scc0 PB_NOEARLY
    buffer_load_dwordx2 v[28:29], v23, s[36:39], s92 offen sc1
    buffer_load_dwordx2 v[248:249], v11, s[36:39], s92 offen offset:0 sc1
    buffer_load_dwordx2 v[250:251], v11, s[36:39], s92 offen offset:128 sc1
    buffer_load_dwordx2 v[252:253], v11, s[36:39], s92 offen offset:512 sc1
    buffer_load_dwordx2 v[254:255], v11, s[36:39], s92 offen offset:640 sc1
PB_NOEARLY:
    s_cmp_eq_u32 s74, -1
    s_cbranch_scc0 PB_PREV
    s_waitcnt vmcnt(0)
    s_branch PB_NOPREV
PB_PREV:
    s_cmp_eq_u32 s75, 1
    s_cbranch_scc1 CVD_71
    s_mov_b32 s75, 1
    s_mov_b32 s58, 20480
    s_mov_b32 s59, 20736
    s_cmp_eq_u32 s48, 0
    s_cbranch_scc0 CVWD_73
CVW_72:
    buffer_load_dword v226, v24, s[36:39], s58 offen sc1
    s_add_u32 s65, s65, 1
    s_waitcnt vmcnt(0)
    v_cmp_gt_u32 vcc, 1, v226
    s_cbranch_vccz CVWD_73
    s_sleep 32
    s_cmp_lt_u32 s65, 262144
    s_cbranch_scc1 CVW_72
CVWD_73:
    s_cmp_eq_u32 s48, 0
    s_cbranch_scc0 CVWD_75
CVW_74:
    buffer_load_dword v226, v24, s[36:39], s59 offen sc1
    s_add_u32 s65, s65, 1
    s_waitcnt vmcnt(0)
    v_cmp_gt_u32 vcc, 1, v226
    s_cbranch_vccz CVWD_75
    s_sleep 32
    s_cmp_lt_u32 s65, 262144
    s_cbranch_scc1 CVW_74
CVWD_75:
    s_barrier
CVD_71:
    s_lshl_b32 s67, s74, 6
    s_add_u32 s67, s67, 85983232
    s_add_u32 s57, s67, 4096
    buffer_load_ushort v228, v14, s[36:39], s67 offen sc1
    buffer_load_ushort v229, v14, s[36:39], s57 offen sc1
    s_lshl_b32 s54, s74, 15
    buffer_load_dword v230, v15, s[84:87], s54 offen
    s_lshl_b32 s59, s74, 12
    s_add_u32 s59, s59, 524288
    s_cmp_eq_u32 s48, 0
    s_cbranch_scc0 OWD_77
    v_cmp_gt_u32 vcc, 1, v25
    s_cbranch_vccz OWD_77
OW_76:
    buffer_load_dword v25, v20, s[36:39], s59 offen sc1
    s_add_u32 s65, s65, 1
    s_waitcnt vmcnt(0)
    v_cmp_gt_u32 vcc, 1, v25
    s_cbranch_vccz OWD_77
    s_sleep 2
    s_cmp_lt_u32 s65, 262144
    s_cbranch_scc1 OW_76
OWD_77:
    s_barrier
    s_lshl_b32 s67, s74, 7
    s_add_u32 s67, s67, 88080384
    buffer_load_dword v231, v21, s[36:39], s67 offen sc1
    s_mul_i32 s58, s74, 37
    s_lshr_b32 s58, s58, 9
    s_mul_i32 s58, s58, 14
    s_sub_u32 s58, s74, s58
    s_lshl_b32 s58, s58, 18
    s_lshl_b32 s67, s48, 16
    s_add_u32 s58, s58, s67
    s_add_u32 s58, s58, 68157440
    buffer_load_dwordx4 v[80:83], v3, s[36:39], s58 offen offset:0 sc1
    buffer_load_dwordx4 v[84:87], v3, s[36:39], s58 offen offset:1024 sc1
    buffer_load_dwordx4 v[88:91], v3, s[36:39], s58 offen offset:2048 sc1
    buffer_load_dwordx4 v[92:95], v3, s[36:39], s58 offen offset:3072 sc1
    s_add_u32 s58, s58, 4096
    buffer_load_dwordx4 v[96:99], v3, s[36:39], s58 offen offset:0 sc1
    buffer_load_dwordx4 v[100:103], v3, s[36:39], s58 offen offset:1024 sc1
    buffer_load_dwordx4 v[104:107], v3, s[36:39], s58 offen offset:2048 sc1
    buffer_load_dwordx4 v[108:111], v3, s[36:39], s58 offen offset:3072 sc1
    s_add_u32 s58, s58, 4096
    buffer_load_dwordx4 v[112:115], v3, s[36:39], s58 offen offset:0 sc1
    buffer_load_dwordx4 v[116:119], v3, s[36:39], s58 offen offset:1024 sc1
    buffer_load_dwordx4 v[120:123], v3, s[36:39], s58 offen offset:2048 sc1
    buffer_load_dwordx4 v[124:127], v3, s[36:39], s58 offen offset:3072 sc1
    s_add_u32 s58, s58, 4096
    buffer_load_dwordx4 v[128:131], v3, s[36:39], s58 offen offset:0 sc1
    buffer_load_dwordx4 v[132:135], v3, s[36:39], s58 offen offset:1024 sc1
    buffer_load_dwordx4 v[136:139], v3, s[36:39], s58 offen offset:2048 sc1
    buffer_load_dwordx4 v[140:143], v3, s[36:39], s58 offen offset:3072 sc1
    s_add_u32 s58, s58, 4096
    buffer_load_dwordx4 v[144:147], v3, s[36:39], s58 offen offset:0 sc1
    buffer_load_dwordx4 v[148:151], v3, s[36:39], s58 offen offset:1024 sc1
    buffer_load_dwordx4 v[152:155], v3, s[36:39], s58 offen offset:2048 sc1
    buffer_load_dwordx4 v[156:159], v3, s[36:39], s58 offen offset:3072 sc1
    s_add_u32 s58, s58, 4096
    buffer_load_dwordx4 v[160:163], v3, s[36:39], s58 offen offset:0 sc1
    buffer_load_dwordx4 v[164:167], v3, s[36:39], s58 offen offset:1024 sc1
    buffer_load_dwordx4 v[168:171], v3, s[36:39], s58 offen offset:2048 sc1
    buffer_load_dwordx4 v[172:175], v3, s[36:39], s58 offen offset:3072 sc1
    s_add_u32 s58, s58, 4096
    buffer_load_dwordx4 v[176:179], v3, s[36:39], s58 offen offset:0 sc1
    buffer_load_dwordx4 v[180:183], v3, s[36:39], s58 offen offset:1024 sc1
    buffer_load_dwordx4 v[184:187], v3, s[36:39], s58 offen offset:2048 sc1
    buffer_load_dwordx4 v[188:191], v3, s[36:39], s58 offen offset:3072 sc1
    s_add_u32 s58, s58, 4096
    buffer_load_dwordx4 v[192:195], v3, s[36:39], s58 offen offset:0 sc1
    buffer_load_dwordx4 v[196:199], v3, s[36:39], s58 offen offset:1024 sc1
    buffer_load_dwordx4 v[200:203], v3, s[36:39], s58 offen offset:2048 sc1
    buffer_load_dwordx4 v[204:207], v3, s[36:39], s58 offen offset:3072 sc1
    s_waitcnt vmcnt(31)
    v_mfma_f32_16x16x32_bf16 v[208:211], a[128:131], v[80:83], 0
    s_add_u32 s58, s58, 4096
    buffer_load_dwordx4 v[80:83], v3, s[36:39], s58 offen offset:0 sc1
    s_waitcnt vmcnt(31)
    v_mfma_f32_16x16x32_bf16 v[208:211], a[132:135], v[84:87], v[208:211]
    buffer_load_dwordx4 v[84:87], v3, s[36:39], s58 offen offset:1024 sc1
    s_waitcnt vmcnt(31)
    v_mfma_f32_16x16x32_bf16 v[208:211], a[136:139], v[88:91], v[208:211]
    buffer_load_dwordx4 v[88:91], v3, s[36:39], s58 offen offset:2048 sc1
    s_waitcnt vmcnt(31)
    v_mfma_f32_16x16x32_bf16 v[208:211], a[140:143], v[92:95], v[208:211]
    buffer_load_dwordx4 v[92:95], v3, s[36:39], s58 offen offset:3072 sc1
    s_waitcnt vmcnt(31)
    v_mfma_f32_16x16x32_bf16 v[212:215], a[128:131], v[96:99], 0
    s_add_u32 s58, s58, 4096
    buffer_load_dwordx4 v[96:99], v3, s[36:39], s58 offen offset:0 sc1
    s_waitcnt vmcnt(31)
    v_mfma_f32_16x16x32_bf16 v[212:215], a[132:135], v[100:103], v[212:215]
    buffer_load_dwordx4 v[100:103], v3, s[36:39], s58 offen offset:1024 sc1
    s_waitcnt vmcnt(31)
    v_mfma_f32_16x16x32_bf16 v[212:215], a[136:139], v[104:107], v[212:215]
    buffer_load_dwordx4 v[104:107], v3, s[36:39], s58 offen offset:2048 sc1
    s_waitcnt vmcnt(31)
    v_mfma_f32_16x16x32_bf16 v[212:215], a[140:143], v[108:111], v[212:215]
    buffer_load_dwordx4 v[108:111], v3, s[36:39], s58 offen offset:3072 sc1
    s_waitcnt vmcnt(31)
    v_mfma_f32_16x16x32_bf16 v[208:211], a[144:147], v[112:115], v[208:211]
    s_add_u32 s58, s58, 4096
    buffer_load_dwordx4 v[112:115], v3, s[36:39], s58 offen offset:0 sc1
    s_waitcnt vmcnt(31)
    v_mfma_f32_16x16x32_bf16 v[208:211], a[148:151], v[116:119], v[208:211]
    buffer_load_dwordx4 v[116:119], v3, s[36:39], s58 offen offset:1024 sc1
    s_waitcnt vmcnt(31)
    v_mfma_f32_16x16x32_bf16 v[208:211], a[152:155], v[120:123], v[208:211]
    buffer_load_dwordx4 v[120:123], v3, s[36:39], s58 offen offset:2048 sc1
    s_waitcnt vmcnt(31)
    v_mfma_f32_16x16x32_bf16 v[208:211], a[156:159], v[124:127], v[208:211]
    buffer_load_dwordx4 v[124:127], v3, s[36:39], s58 offen offset:3072 sc1
    s_waitcnt vmcnt(31)
    v_mfma_f32_16x16x32_bf16 v[212:215], a[144:147], v[128:131], v[212:215]
    s_add_u32 s58, s58, 4096
    buffer_load_dwordx4 v[128:131], v3, s[36:39], s58 offen offset:0 sc1
    s_waitcnt vmcnt(31)
    v_mfma_f32_16x16x32_bf16 v[212:215], a[148:151], v[132:135], v[212:215]
    buffer_load_dwordx4 v[132:135], v3, s[36:39], s58 offen offset:1024 sc1
    s_waitcnt vmcnt(31)
    v_mfma_f32_16x16x32_bf16 v[212:215], a[152:155], v[136:139], v[212:215]
    buffer_load_dwordx4 v[136:139], v3, s[36:39], s58 offen offset:2048 sc1
    s_waitcnt vmcnt(31)
    v_mfma_f32_16x16x32_bf16 v[212:215], a[156:159], v[140:143], v[212:215]
    buffer_load_dwordx4 v[140:143], v3, s[36:39], s58 offen offset:3072 sc1
    s_waitcnt vmcnt(31)
    v_mfma_f32_16x16x32_bf16 v[208:211], a[160:163], v[144:147], v[208:211]
    s_add_u32 s58, s58, 4096
    buffer_load_dwordx4 v[144:147], v3, s[36:39], s58 offen offset:0 sc1
    s_waitcnt vmcnt(31)
    v_mfma_f32_16x16x32_bf16 v[208:211], a[164:167], v[148:151], v[208:211]
    buffer_load_dwordx4 v[148:151], v3, s[36:39], s58 offen offset:1024 sc1
    s_waitcnt vmcnt(31)
    v_mfma_f32_16x16x32_bf16 v[208:211], a[168:171], v[152:155], v[208:211]
    buffer_load_dwordx4 v[152:155], v3, s[36:39], s58 offen offset:2048 sc1
    s_waitcnt vmcnt(31)
    v_mfma_f32_16x16x32_bf16 v[208:211], a[172:175], v[156:159], v[208:211]
    buffer_load_dwordx4 v[156:159], v3, s[36:39], s58 offen offset:3072 sc1
    s_waitcnt vmcnt(31)
    v_mfma_f32_16x16x32_bf16 v[212:215], a[160:163], v[160:163], v[212:215]
    s_add_u32 s58, s58, 4096
    buffer_load_dwordx4 v[160:163], v3, s[36:39], s58 offen offset:0 sc1
    s_waitcnt vmcnt(31)
    v_mfma_f32_16x16x32_bf16 v[212:215], a[164:167], v[164:167], v[212:215]
    buffer_load_dwordx4 v[164:167], v3, s[36:39], s58 offen offset:1024 sc1
    s_waitcnt vmcnt(31)
    v_mfma_f32_16x16x32_bf16 v[212:215], a[168:171], v[168:171], v[212:215]
    buffer_load_dwordx4 v[168:171], v3, s[36:39], s58 offen offset:2048 sc1
    s_waitcnt vmcnt(31)
    v_mfma_f32_16x16x32_bf16 v[212:215], a[172:175], v[172:175], v[212:215]
    buffer_load_dwordx4 v[172:175], v3, s[36:39], s58 offen offset:3072 sc1
    s_waitcnt vmcnt(31)
    v_mfma_f32_16x16x32_bf16 v[208:211], a[176:179], v[176:179], v[208:211]
    s_add_u32 s58, s58, 4096
    buffer_load_dwordx4 v[176:179], v3, s[36:39], s58 offen offset:0 sc1
    s_waitcnt vmcnt(31)
    v_mfma_f32_16x16x32_bf16 v[208:211], a[180:183], v[180:183], v[208:211]
    buffer_load_dwordx4 v[180:183], v3, s[36:39], s58 offen offset:1024 sc1
    s_waitcnt vmcnt(31)
    v_mfma_f32_16x16x32_bf16 v[208:211], a[184:187], v[184:187], v[208:211]
    buffer_load_dwordx4 v[184:187], v3, s[36:39], s58 offen offset:2048 sc1
    s_waitcnt vmcnt(31)
    v_mfma_f32_16x16x32_bf16 v[208:211], a[188:191], v[188:191], v[208:211]
    buffer_load_dwordx4 v[188:191], v3, s[36:39], s58 offen offset:3072 sc1
    s_waitcnt vmcnt(31)
    v_mfma_f32_16x16x32_bf16 v[212:215], a[176:179], v[192:195], v[212:215]
    s_add_u32 s58, s58, 4096
    buffer_load_dwordx4 v[192:195], v3, s[36:39], s58 offen offset:0 sc1
    s_waitcnt vmcnt(31)
    v_mfma_f32_16x16x32_bf16 v[212:215], a[180:183], v[196:199], v[212:215]
    buffer_load_dwordx4 v[196:199], v3, s[36:39], s58 offen offset:1024 sc1
    s_waitcnt vmcnt(31)
    v_mfma_f32_16x16x32_bf16 v[212:215], a[184:187], v[200:203], v[212:215]
    buffer_load_dwordx4 v[200:203], v3, s[36:39], s58 offen offset:2048 sc1
    s_waitcnt vmcnt(31)
    v_mfma_f32_16x16x32_bf16 v[212:215], a[188:191], v[204:207], v[212:215]
    buffer_load_dwordx4 v[204:207], v3, s[36:39], s58 offen offset:3072 sc1
    s_waitcnt vmcnt(31)
    v_mfma_f32_16x16x32_bf16 v[208:211], a[192:195], v[80:83], v[208:211]
    s_waitcnt vmcnt(30)
    v_mfma_f32_16x16x32_bf16 v[208:211], a[196:199], v[84:87], v[208:211]
    s_waitcnt vmcnt(29)
    v_mfma_f32_16x16x32_bf16 v[208:211], a[200:203], v[88:91], v[208:211]
    s_waitcnt vmcnt(28)
    v_mfma_f32_16x16x32_bf16 v[208:211], a[204:207], v[92:95], v[208:211]
    s_waitcnt vmcnt(27)
    v_mfma_f32_16x16x32_bf16 v[212:215], a[192:195], v[96:99], v[212:215]
    s_waitcnt vmcnt(26)
    v_mfma_f32_16x16x32_bf16 v[212:215], a[196:199], v[100:103], v[212:215]
    s_waitcnt vmcnt(25)
    v_mfma_f32_16x16x32_bf16 v[212:215], a[200:203], v[104:107], v[212:215]
    s_waitcnt vmcnt(24)
    v_mfma_f32_16x16x32_bf16 v[212:215], a[204:207], v[108:111], v[212:215]
    s_waitcnt vmcnt(23)
    v_mfma_f32_16x16x32_bf16 v[208:211], a[208:211], v[112:115], v[208:211]
    s_waitcnt vmcnt(22)
    v_mfma_f32_16x16x32_bf16 v[208:211], a[212:215], v[116:119], v[208:211]
    s_waitcnt vmcnt(21)
    v_mfma_f32_16x16x32_bf16 v[208:211], a[216:219], v[120:123], v[208:211]
    s_waitcnt vmcnt(20)
    v_mfma_f32_16x16x32_bf16 v[208:211], a[220:223], v[124:127], v[208:211]
    s_waitcnt vmcnt(19)
    v_mfma_f32_16x16x32_bf16 v[212:215], a[208:211], v[128:131], v[212:215]
    s_waitcnt vmcnt(18)
    v_mfma_f32_16x16x32_bf16 v[212:215], a[212:215], v[132:135], v[212:215]
    s_waitcnt vmcnt(17)
    v_mfma_f32_16x16x32_bf16 v[212:215], a[216:219], v[136:139], v[212:215]
    s_waitcnt vmcnt(16)
    v_mfma_f32_16x16x32_bf16 v[212:215], a[220:223], v[140:143], v[212:215]
    s_waitcnt vmcnt(15)
    v_mfma_f32_16x16x32_bf16 v[208:211], a[224:227], v[144:147], v[208:211]
    s_waitcnt vmcnt(14)
    v_mfma_f32_16x16x32_bf16 v[208:211], a[228:231], v[148:151], v[208:211]
    s_waitcnt vmcnt(13)
    v_mfma_f32_16x16x32_bf16 v[208:211], a[232:235], v[152:155], v[208:211]
    s_waitcnt vmcnt(12)
    v_mfma_f32_16x16x32_bf16 v[208:211], a[236:239], v[156:159], v[208:211]
    s_waitcnt vmcnt(11)
    v_mfma_f32_16x16x32_bf16 v[212:215], a[224:227], v[160:163], v[212:215]
    s_waitcnt vmcnt(10)
    v_mfma_f32_16x16x32_bf16 v[212:215], a[228:231], v[164:167], v[212:215]
    s_waitcnt vmcnt(9)
    v_mfma_f32_16x16x32_bf16 v[212:215], a[232:235], v[168:171], v[212:215]
    s_waitcnt vmcnt(8)
    v_mfma_f32_16x16x32_bf16 v[212:215], a[236:239], v[172:175], v[212:215]
    s_waitcnt vmcnt(7)
    v_mfma_f32_16x16x32_bf16 v[208:211], a[240:243], v[176:179], v[208:211]
    s_waitcnt vmcnt(6)
    v_mfma_f32_16x16x32_bf16 v[208:211], a[244:247], v[180:183], v[208:211]
    s_waitcnt vmcnt(5)
    v_mfma_f32_16x16x32_bf16 v[208:211], a[248:251], v[184:187], v[208:211]
    s_waitcnt vmcnt(4)
    v_mfma_f32_16x16x32_bf16 v[208:211], a[252:255], v[188:191], v[208:211]
    s_waitcnt vmcnt(3)
    v_mfma_f32_16x16x32_bf16 v[212:215], a[240:243], v[192:195], v[212:215]
    s_waitcnt vmcnt(2)
    v_mfma_f32_16x16x32_bf16 v[212:215], a[244:247], v[196:199], v[212:215]
    s_waitcnt vmcnt(1)
    v_mfma_f32_16x16x32_bf16 v[212:215], a[248:251], v[200:203], v[212:215]
    s_waitcnt vmcnt(0)
    v_mfma_f32_16x16x32_bf16 v[212:215], a[252:255], v[204:207], v[212:215]
    s_lshl_b32 s67, s48, 11
    s_add_u32 s67, s67, 77824
    v_add_u32 v6, s67, v3
    s_nop 5
    ds_write_b128 v6, v[208:211]
    ds_write_b128 v6, v[212:215] offset:1024
    s_waitcnt lgkmcnt(0)
    s_barrier
    ds_read_b64 v[80:81], v13 offset:0
    ds_read_b64 v[82:83], v13 offset:2048
    ds_read_b64 v[84:85], v13 offset:4096
    ds_read_b64 v[86:87], v13 offset:6144
    v_lshlrev_b32 v228, 16, v228
    v_lshlrev_b32 v229, 16, v229
    v_lshlrev_b32 v88, 16, v230
    v_and_b32 v89, 0xffff0000, v230
    v_mul_f32 v228, v228, v88
    v_mul_f32 v229, v229, v89
    v_cvt_pk_bf16_f32 v90, v228, v229
    v_lshlrev_b32 v228, 16, v90
    v_and_b32 v229, 0xffff0000, v90
    v_mul_f32 v228, v228, v231
    v_mul_f32 v229, v229, v231
    v_cvt_pk_bf16_f32 v90, v228, v229
    v_lshlrev_b32 v228, 16, v90
    v_and_b32 v229, 0xffff0000, v90
    v_sub_f32 v231, 1.0, v231
    v_cvt_pk_bf16_f32 v231, v231, v231
    v_lshlrev_b32 v231, 16, v231
    s_waitcnt lgkmcnt(0)
    v_add_f32 v80, v80, v82
    v_add_f32 v81, v81, v83
    v_add_f32 v84, v84, v86
    v_add_f32 v85, v85, v87
    v_add_f32 v80, v80, v84
    v_add_f32 v81, v81, v85
    v_cvt_pk_bf16_f32 v90, v80, v81
    v_lshlrev_b32 v80, 16, v90
    v_and_b32 v81, 0xffff0000, v90
    v_mul_f32 v80, v80, v231
    v_mul_f32 v81, v81, v231
    v_cvt_pk_bf16_f32 v90, v80, v81
    v_lshlrev_b32 v80, 16, v90
    v_and_b32 v81, 0xffff0000, v90
    v_add_f32 v80, v80, v228
    v_add_f32 v81, v81, v229
    v_cvt_pk_bf16_f32 v80, v80, v81
    buffer_store_dword v80, v15, s[88:91], s54 offen
PB_NOPREV:
    s_mul_i32 s58, s53, 37
    s_lshr_b32 s58, s58, 9
    s_mul_i32 s58, s58, 14
    s_sub_u32 s58, s53, s58
    s_lshl_b32 s58, s58, 18
    s_lshl_b32 s67, s51, 13
    s_add_u32 s58, s58, s67
    s_cmp_gt_u32 s93, s53
    s_cbranch_scc1 PB_HAVE
    s_cmp_ge_u32 s53, 57
    s_cbranch_scc1 PB_DL
    v_mov_b32 v225, s81
    s_add_u32 s57, s53, 1
    s_cmp_eq_u32 s48, 0
    s_cbranch_scc0 CHWD_79
CHW_78:
    buffer_load_dword v226, v225, s[36:39], 0 offen sc1
    s_add_u32 s65, s65, 1
    s_waitcnt vmcnt(0)
    v_cmp_gt_u32 vcc, s57, v226
    s_cbranch_vccz CHWD_79
    s_sleep 4
    s_cmp_lt_u32 s65, 262144
    s_cbranch_scc1 CHW_78
CHWD_79:
    s_barrier
    buffer_load_dwordx2 v[28:29], v23, s[36:39], s92 offen sc1
    buffer_load_dwordx2 v[248:249], v11, s[36:39], s92 offen offset:0 sc1
    buffer_load_dwordx2 v[250:251], v11, s[36:39], s92 offen offset:128 sc1
    buffer_load_dwordx2 v[252:253], v11, s[36:39], s92 offen offset:512 sc1
    buffer_load_dwordx2 v[254:255], v11, s[36:39], s92 offen offset:640 sc1
    s_waitcnt vmcnt(0)
    s_branch PB_HAVE
PB_DL:
    buffer_load_dwordx2 v[28:29], v23, s[36:39], s92 offen sc1
    buffer_load_dwordx2 v[248:249], v11, s[36:39], s92 offen offset:0 sc1
    buffer_load_dwordx2 v[250:251], v11, s[36:39], s92 offen offset:128 sc1
    buffer_load_dwordx2 v[252:253], v11, s[36:39], s92 offen offset:512 sc1
    buffer_load_dwordx2 v[254:255], v11, s[36:39], s92 offen offset:640 sc1
    s_add_u32 s65, s65, 1
    s_waitcnt vmcnt(0)
    v_max3_u32 v224, v28, v29, v248
    v_max3_u32 v224, v224, v249, v250
    v_max3_u32 v224, v224, v251, v252
    v_max3_u32 v224, v224, v253, v254
    v_max3_u32 v224, v224, v255, v255
    v_cmp_eq_u32 vcc, -1, v224
    s_cbranch_vccz PB_HAVE
    s_sleep 2
    s_cmp_lt_u32 s65, 262144
    s_cbranch_scc1 PB_DL
PB_HAVE:
    ds_write2_b32 v22, v28, v29 offset0:0 offset1:64
    v_swap_b32 v249, v250
    v_swap_b32 v253, v254
    v_mov_b32 v224, 0xf149f2ca
    s_waitcnt lgkmcnt(0)
    s_barrier
    ds_read_b64_tr_b16 v[144:145], v10 offset:0
    ds_read_b64_tr_b16 v[146:147], v10 offset:256
    ds_read_b64_tr_b16 v[148:149], v10 offset:512
    ds_read_b64_tr_b16 v[150:151], v10 offset:768
    ds_read_b64_tr_b16 v[152:153], v10 offset:1024
    ds_read_b64_tr_b16 v[154:155], v10 offset:1280
    ds_read_b64_tr_b16 v[156:157], v10 offset:1536
    ds_read_b64_tr_b16 v[158:159], v10 offset:1792
    s_waitcnt lgkmcnt(6)
    v_mfma_f32_16x16x32_bf16 v[168:171], v[144:147], v[232:235], 0
    s_waitcnt lgkmcnt(4)
    v_mfma_f32_16x16x32_bf16 v[168:171], v[148:151], v[236:239], v[168:171]
    s_waitcnt lgkmcnt(2)
    v_mfma_f32_16x16x32_bf16 v[168:171], v[152:155], v[240:243], v[168:171]
    s_waitcnt lgkmcnt(0)
    v_mfma_f32_16x16x32_bf16 v[168:171], v[156:159], v[244:247], v[168:171]
    s_add_u32 s58, s58, 68157440
    s_lshl_b32 s67, s62, 12
    s_add_u32 s58, s58, s67
    s_lshl_b32 s67, s63, 11
    s_add_u32 s58, s58, s67
    s_lshl_b32 s59, s53, 12
    s_add_u32 s59, s59, 524288
    s_lshl_b32 s67, s51, 7
    s_add_u32 s54, s59, s67
    s_mov_b32 exec_lo, 0
    v_mov_b32 v168, v224
    v_mov_b32 v169, v224
    v_mov_b32 v170, v224
    v_mov_b32 v171, v224
    s_mov_b32 exec_lo, -1
    v_max3_f32 v27, v27, v168, v169
    v_max3_f32 v27, v27, v170, v171
    v_mov_b32 v226, v27
    s_nop 1
    v_permlane16_swap_b32 v27, v226
    v_max_f32 v27, v27, v226
    v_mov_b32 v226, v27
    s_nop 1
    v_permlane32_swap_b32 v27, v226
    v_max_f32 v27, v27, v226
    v_mul_f32 v27, s80, v27
    v_fma_f32 v216, v216, s80, -v27
    v_fma_f32 v217, v217, s80, -v27
    v_fma_f32 v218, v218, s80, -v27
    v_fma_f32 v219, v219, s80, -v27
    v_fma_f32 v220, v220, s80, -v27
    v_fma_f32 v221, v221, s80, -v27
    v_fma_f32 v222, v222, s80, -v27
    v_fma_f32 v223, v223, s80, -v27
    v_fma_f32 v168, v168, s80, -v27
    v_fma_f32 v169, v169, s80, -v27
    v_fma_f32 v170, v170, s80, -v27
    v_fma_f32 v171, v171, s80, -v27
    v_exp_f32 v216, v216
    v_exp_f32 v217, v217
    v_exp_f32 v218, v218
    v_exp_f32 v219, v219
    v_exp_f32 v220, v220
    v_exp_f32 v221, v221
    v_exp_f32 v222, v222
    v_exp_f32 v223, v223
    v_exp_f32 v168, v168
    v_exp_f32 v169, v169
    v_exp_f32 v170, v170
    v_exp_f32 v171, v171
    s_nop 0
    v_add_f32 v27, v216, v217
    v_add_f32 v27, v27, v218
    v_add_f32 v27, v27, v219
    v_add_f32 v27, v27, v220
    v_add_f32 v27, v27, v221
    v_add_f32 v27, v27, v222
    v_add_f32 v27, v27, v223
    v_add_f32 v27, v27, v168
    v_add_f32 v27, v27, v169
    v_add_f32 v27, v27, v170
    v_add_f32 v27, v27, v171
    v_mov_b32 v226, v27
    s_nop 1
    v_permlane16_swap_b32 v27, v226
    v_add_f32 v27, v27, v226
    v_mov_b32 v226, v27
    s_nop 1
    v_permlane32_swap_b32 v27, v226
    v_add_f32 v27, v27, v226
    v_rcp_f32 v27, v27
    s_nop 0
    v_mul_f32 v216, v216, v27
    v_mul_f32 v217, v217, v27
    v_mul_f32 v218, v218, v27
    v_mul_f32 v219, v219, v27
    v_mul_f32 v220, v220, v27
    v_mul_f32 v221, v221, v27
    v_mul_f32 v222, v222, v27
    v_mul_f32 v223, v223, v27
    v_mul_f32 v168, v168, v27
    v_mul_f32 v169, v169, v27
    v_mul_f32 v170, v170, v27
    v_mul_f32 v171, v171, v27
    v_cvt_pk_bf16_f32 v180, v216, v217
    v_cvt_pk_bf16_f32 v181, v218, v219
    v_cvt_pk_bf16_f32 v182, v220, v221
    v_cvt_pk_bf16_f32 v183, v222, v223
    v_cvt_pk_bf16_f32 v184, v168, v169
    v_cvt_pk_bf16_f32 v185, v170, v171
    s_nop 0
    v_mfma_f32_16x16x32_bf16 v[188:191], v[64:67], v[180:183], 0
    v_mfma_f32_16x16x32_bf16 v[192:195], v[68:71], v[180:183], 0
    v_mfma_f32_16x16x32_bf16 v[196:199], v[72:75], v[180:183], 0
    v_mfma_f32_16x16x32_bf16 v[200:203], v[76:79], v[180:183], 0
    v_mfma_f32_16x16x16_bf16 v[188:191], v[248:249], v[184:185], v[188:191]
    v_mfma_f32_16x16x16_bf16 v[192:195], v[250:251], v[184:185], v[192:195]
    v_mfma_f32_16x16x16_bf16 v[196:199], v[252:253], v[184:185], v[196:199]
    v_mfma_f32_16x16x16_bf16 v[200:203], v[254:255], v[184:185], v[200:203]
    s_nop 4
    v_cvt_pk_bf16_f32 v232, v188, v189
    v_cvt_pk_bf16_f32 v233, v190, v191
    v_cvt_pk_bf16_f32 v234, v192, v193
    v_cvt_pk_bf16_f32 v235, v194, v195
    v_cvt_pk_bf16_f32 v236, v196, v197
    v_cvt_pk_bf16_f32 v237, v198, v199
    v_cvt_pk_bf16_f32 v238, v200, v201
    v_cvt_pk_bf16_f32 v239, v202, v203
    buffer_store_dwordx4 v[232:235], v3, s[36:39], s58 offen offset:0 sc1
    buffer_store_dwordx4 v[236:239], v3, s[36:39], s58 offen offset:1024 sc1
    s_waitcnt vmcnt(0)
    s_barrier
    v_mov_b32 v6, 1
    s_mov_b64 exec, s[76:77]
    buffer_store_dword v6, off, s[36:39], s54 sc1
    s_mov_b64 exec, -1
PB_ODONE:
    s_mov_b32 s74, s53
    s_add_u32 s53, s53, 7
    s_cmp_lt_u32 s53, 64
    s_cbranch_scc1 PB_LOOP
    s_mov_b64 s[94:95], -1
    s_mov_b32 s96, 1
    s_mov_b32 s97, 0
    s_mov_b32 s64, 0
    s_cmp_ge_u32 s74, 61
    s_cbranch_scc1 PB_HALF
    s_cmp_eq_u32 s75, 1
    s_cbranch_scc1 CVD_80
    s_mov_b32 s75, 1
    s_mov_b32 s58, 20480
    s_mov_b32 s59, 20736
    s_cmp_eq_u32 s48, 0
    s_cbranch_scc0 CVWD_82
CVW_81:
    buffer_load_dword v226, v24, s[36:39], s58 offen sc1
    s_add_u32 s65, s65, 1
    s_waitcnt vmcnt(0)
    v_cmp_gt_u32 vcc, 1, v226
    s_cbranch_vccz CVWD_82
    s_sleep 32
    s_cmp_lt_u32 s65, 262144
    s_cbranch_scc1 CVW_81
CVWD_82:
    s_cmp_eq_u32 s48, 0
    s_cbranch_scc0 CVWD_84
CVW_83:
    buffer_load_dword v226, v24, s[36:39], s59 offen sc1
    s_add_u32 s65, s65, 1
    s_waitcnt vmcnt(0)
    v_cmp_gt_u32 vcc, 1, v226
    s_cbranch_vccz CVWD_84
    s_sleep 32
    s_cmp_lt_u32 s65, 262144
    s_cbranch_scc1 CVW_83
CVWD_84:
    s_barrier
CVD_80:
    s_lshl_b32 s67, s74, 6
    s_add_u32 s67, s67, 85983232
    s_add_u32 s57, s67, 4096
    buffer_load_ushort v228, v14, s[36:39], s67 offen sc1
    buffer_load_ushort v229, v14, s[36:39], s57 offen sc1
    s_lshl_b32 s54, s74, 15
    buffer_load_dword v230, v15, s[84:87], s54 offen
    s_lshl_b32 s59, s74, 12
    s_add_u32 s59, s59, 524288
    s_cmp_eq_u32 s48, 0
    s_cbranch_scc0 OWD_86
OW_85:
    buffer_load_dword v25, v20, s[36:39], s59 offen sc1
    s_add_u32 s65, s65, 1
    s_waitcnt vmcnt(0)
    v_cmp_gt_u32 vcc, 1, v25
    s_cbranch_vccz OWD_86
    s_sleep 2
    s_cmp_lt_u32 s65, 262144
    s_cbranch_scc1 OW_85
OWD_86:
    s_barrier
    s_lshl_b32 s67, s74, 7
    s_add_u32 s67, s67, 88080384
    buffer_load_dword v231, v21, s[36:39], s67 offen sc1
    s_mul_i32 s58, s74, 37
    s_lshr_b32 s58, s58, 9
    s_mul_i32 s58, s58, 14
    s_sub_u32 s58, s74, s58
    s_lshl_b32 s58, s58, 18
    s_lshl_b32 s67, s48, 16
    s_add_u32 s58, s58, s67
    s_add_u32 s58, s58, 68157440
    buffer_load_dwordx4 v[80:83], v3, s[36:39], s58 offen offset:0 sc1
    buffer_load_dwordx4 v[84:87], v3, s[36:39], s58 offen offset:1024 sc1
    buffer_load_dwordx4 v[88:91], v3, s[36:39], s58 offen offset:2048 sc1
    buffer_load_dwordx4 v[92:95], v3, s[36:39], s58 offen offset:3072 sc1
    s_add_u32 s58, s58, 4096
    buffer_load_dwordx4 v[96:99], v3, s[36:39], s58 offen offset:0 sc1
    buffer_load_dwordx4 v[100:103], v3, s[36:39], s58 offen offset:1024 sc1
    buffer_load_dwordx4 v[104:107], v3, s[36:39], s58 offen offset:2048 sc1
    buffer_load_dwordx4 v[108:111], v3, s[36:39], s58 offen offset:3072 sc1
    s_add_u32 s58, s58, 4096
    buffer_load_dwordx4 v[112:115], v3, s[36:39], s58 offen offset:0 sc1
    buffer_load_dwordx4 v[116:119], v3, s[36:39], s58 offen offset:1024 sc1
    buffer_load_dwordx4 v[120:123], v3, s[36:39], s58 offen offset:2048 sc1
    buffer_load_dwordx4 v[124:127], v3, s[36:39], s58 offen offset:3072 sc1
    s_add_u32 s58, s58, 4096
    buffer_load_dwordx4 v[128:131], v3, s[36:39], s58 offen offset:0 sc1
    buffer_load_dwordx4 v[132:135], v3, s[36:39], s58 offen offset:1024 sc1
    buffer_load_dwordx4 v[136:139], v3, s[36:39], s58 offen offset:2048 sc1
    buffer_load_dwordx4 v[140:143], v3, s[36:39], s58 offen offset:3072 sc1
    s_add_u32 s58, s58, 4096
    buffer_load_dwordx4 v[144:147], v3, s[36:39], s58 offen offset:0 sc1
    buffer_load_dwordx4 v[148:151], v3, s[36:39], s58 offen offset:1024 sc1
    buffer_load_dwordx4 v[152:155], v3, s[36:39], s58 offen offset:2048 sc1
    buffer_load_dwordx4 v[156:159], v3, s[36:39], s58 offen offset:3072 sc1
    s_add_u32 s58, s58, 4096
    buffer_load_dwordx4 v[160:163], v3, s[36:39], s58 offen offset:0 sc1
    buffer_load_dwordx4 v[164:167], v3, s[36:39], s58 offen offset:1024 sc1
    buffer_load_dwordx4 v[168:171], v3, s[36:39], s58 offen offset:2048 sc1
    buffer_load_dwordx4 v[172:175], v3, s[36:39], s58 offen offset:3072 sc1
    s_add_u32 s58, s58, 4096
    buffer_load_dwordx4 v[176:179], v3, s[36:39], s58 offen offset:0 sc1
    buffer_load_dwordx4 v[180:183], v3, s[36:39], s58 offen offset:1024 sc1
    buffer_load_dwordx4 v[184:187], v3, s[36:39], s58 offen offset:2048 sc1
    buffer_load_dwordx4 v[188:191], v3, s[36:39], s58 offen offset:3072 sc1
    s_add_u32 s58, s58, 4096
    buffer_load_dwordx4 v[192:195], v3, s[36:39], s58 offen offset:0 sc1
    buffer_load_dwordx4 v[196:199], v3, s[36:39], s58 offen offset:1024 sc1
    buffer_load_dwordx4 v[200:203], v3, s[36:39], s58 offen offset:2048 sc1
    buffer_load_dwordx4 v[204:207], v3, s[36:39], s58 offen offset:3072 sc1
    s_waitcnt vmcnt(31)
    v_mfma_f32_16x16x32_bf16 v[208:211], a[128:131], v[80:83], 0
    s_add_u32 s58, s58, 4096
    buffer_load_dwordx4 v[80:83], v3, s[36:39], s58 offen offset:0 sc1
    s_waitcnt vmcnt(31)
    v_mfma_f32_16x16x32_bf16 v[208:211], a[132:135], v[84:87], v[208:211]
    buffer_load_dwordx4 v[84:87], v3, s[36:39], s58 offen offset:1024 sc1
    s_waitcnt vmcnt(31)
    v_mfma_f32_16x16x32_bf16 v[208:211], a[136:139], v[88:91], v[208:211]
    buffer_load_dwordx4 v[88:91], v3, s[36:39], s58 offen offset:2048 sc1
    s_waitcnt vmcnt(31)
    v_mfma_f32_16x16x32_bf16 v[208:211], a[140:143], v[92:95], v[208:211]
    buffer_load_dwordx4 v[92:95], v3, s[36:39], s58 offen offset:3072 sc1
    s_waitcnt vmcnt(31)
    v_mfma_f32_16x16x32_bf16 v[212:215], a[128:131], v[96:99], 0
    s_add_u32 s58, s58, 4096
    buffer_load_dwordx4 v[96:99], v3, s[36:39], s58 offen offset:0 sc1
    s_waitcnt vmcnt(31)
    v_mfma_f32_16x16x32_bf16 v[212:215], a[132:135], v[100:103], v[212:215]
    buffer_load_dwordx4 v[100:103], v3, s[36:39], s58 offen offset:1024 sc1
    s_waitcnt vmcnt(31)
    v_mfma_f32_16x16x32_bf16 v[212:215], a[136:139], v[104:107], v[212:215]
    buffer_load_dwordx4 v[104:107], v3, s[36:39], s58 offen offset:2048 sc1
    s_waitcnt vmcnt(31)
    v_mfma_f32_16x16x32_bf16 v[212:215], a[140:143], v[108:111], v[212:215]
    buffer_load_dwordx4 v[108:111], v3, s[36:39], s58 offen offset:3072 sc1
    s_waitcnt vmcnt(31)
    v_mfma_f32_16x16x32_bf16 v[208:211], a[144:147], v[112:115], v[208:211]
    s_add_u32 s58, s58, 4096
    buffer_load_dwordx4 v[112:115], v3, s[36:39], s58 offen offset:0 sc1
    s_waitcnt vmcnt(31)
    v_mfma_f32_16x16x32_bf16 v[208:211], a[148:151], v[116:119], v[208:211]
    buffer_load_dwordx4 v[116:119], v3, s[36:39], s58 offen offset:1024 sc1
    s_waitcnt vmcnt(31)
    v_mfma_f32_16x16x32_bf16 v[208:211], a[152:155], v[120:123], v[208:211]
    buffer_load_dwordx4 v[120:123], v3, s[36:39], s58 offen offset:2048 sc1
    s_waitcnt vmcnt(31)
    v_mfma_f32_16x16x32_bf16 v[208:211], a[156:159], v[124:127], v[208:211]
    buffer_load_dwordx4 v[124:127], v3, s[36:39], s58 offen offset:3072 sc1
    s_waitcnt vmcnt(31)
    v_mfma_f32_16x16x32_bf16 v[212:215], a[144:147], v[128:131], v[212:215]
    s_add_u32 s58, s58, 4096
    buffer_load_dwordx4 v[128:131], v3, s[36:39], s58 offen offset:0 sc1
    s_waitcnt vmcnt(31)
    v_mfma_f32_16x16x32_bf16 v[212:215], a[148:151], v[132:135], v[212:215]
    buffer_load_dwordx4 v[132:135], v3, s[36:39], s58 offen offset:1024 sc1
    s_waitcnt vmcnt(31)
    v_mfma_f32_16x16x32_bf16 v[212:215], a[152:155], v[136:139], v[212:215]
    buffer_load_dwordx4 v[136:139], v3, s[36:39], s58 offen offset:2048 sc1
    s_waitcnt vmcnt(31)
    v_mfma_f32_16x16x32_bf16 v[212:215], a[156:159], v[140:143], v[212:215]
    buffer_load_dwordx4 v[140:143], v3, s[36:39], s58 offen offset:3072 sc1
    s_waitcnt vmcnt(31)
    v_mfma_f32_16x16x32_bf16 v[208:211], a[160:163], v[144:147], v[208:211]
    s_add_u32 s58, s58, 4096
    buffer_load_dwordx4 v[144:147], v3, s[36:39], s58 offen offset:0 sc1
    s_waitcnt vmcnt(31)
    v_mfma_f32_16x16x32_bf16 v[208:211], a[164:167], v[148:151], v[208:211]
    buffer_load_dwordx4 v[148:151], v3, s[36:39], s58 offen offset:1024 sc1
    s_waitcnt vmcnt(31)
    v_mfma_f32_16x16x32_bf16 v[208:211], a[168:171], v[152:155], v[208:211]
    buffer_load_dwordx4 v[152:155], v3, s[36:39], s58 offen offset:2048 sc1
    s_waitcnt vmcnt(31)
    v_mfma_f32_16x16x32_bf16 v[208:211], a[172:175], v[156:159], v[208:211]
    buffer_load_dwordx4 v[156:159], v3, s[36:39], s58 offen offset:3072 sc1
    s_waitcnt vmcnt(31)
    v_mfma_f32_16x16x32_bf16 v[212:215], a[160:163], v[160:163], v[212:215]
    s_add_u32 s58, s58, 4096
    buffer_load_dwordx4 v[160:163], v3, s[36:39], s58 offen offset:0 sc1
    s_waitcnt vmcnt(31)
    v_mfma_f32_16x16x32_bf16 v[212:215], a[164:167], v[164:167], v[212:215]
    buffer_load_dwordx4 v[164:167], v3, s[36:39], s58 offen offset:1024 sc1
    s_waitcnt vmcnt(31)
    v_mfma_f32_16x16x32_bf16 v[212:215], a[168:171], v[168:171], v[212:215]
    buffer_load_dwordx4 v[168:171], v3, s[36:39], s58 offen offset:2048 sc1
    s_waitcnt vmcnt(31)
    v_mfma_f32_16x16x32_bf16 v[212:215], a[172:175], v[172:175], v[212:215]
    buffer_load_dwordx4 v[172:175], v3, s[36:39], s58 offen offset:3072 sc1
    s_waitcnt vmcnt(31)
    v_mfma_f32_16x16x32_bf16 v[208:211], a[176:179], v[176:179], v[208:211]
    s_add_u32 s58, s58, 4096
    buffer_load_dwordx4 v[176:179], v3, s[36:39], s58 offen offset:0 sc1
    s_waitcnt vmcnt(31)
    v_mfma_f32_16x16x32_bf16 v[208:211], a[180:183], v[180:183], v[208:211]
    buffer_load_dwordx4 v[180:183], v3, s[36:39], s58 offen offset:1024 sc1
    s_waitcnt vmcnt(31)
    v_mfma_f32_16x16x32_bf16 v[208:211], a[184:187], v[184:187], v[208:211]
    buffer_load_dwordx4 v[184:187], v3, s[36:39], s58 offen offset:2048 sc1
    s_waitcnt vmcnt(31)
    v_mfma_f32_16x16x32_bf16 v[208:211], a[188:191], v[188:191], v[208:211]
    buffer_load_dwordx4 v[188:191], v3, s[36:39], s58 offen offset:3072 sc1
    s_waitcnt vmcnt(31)
    v_mfma_f32_16x16x32_bf16 v[212:215], a[176:179], v[192:195], v[212:215]
    s_add_u32 s58, s58, 4096
    buffer_load_dwordx4 v[192:195], v3, s[36:39], s58 offen offset:0 sc1
    s_waitcnt vmcnt(31)
    v_mfma_f32_16x16x32_bf16 v[212:215], a[180:183], v[196:199], v[212:215]
    buffer_load_dwordx4 v[196:199], v3, s[36:39], s58 offen offset:1024 sc1
    s_waitcnt vmcnt(31)
    v_mfma_f32_16x16x32_bf16 v[212:215], a[184:187], v[200:203], v[212:215]
    buffer_load_dwordx4 v[200:203], v3, s[36:39], s58 offen offset:2048 sc1
    s_waitcnt vmcnt(31)
    v_mfma_f32_16x16x32_bf16 v[212:215], a[188:191], v[204:207], v[212:215]
    buffer_load_dwordx4 v[204:207], v3, s[36:39], s58 offen offset:3072 sc1
    s_waitcnt vmcnt(31)
    v_mfma_f32_16x16x32_bf16 v[208:211], a[192:195], v[80:83], v[208:211]
    s_waitcnt vmcnt(30)
    v_mfma_f32_16x16x32_bf16 v[208:211], a[196:199], v[84:87], v[208:211]
    s_waitcnt vmcnt(29)
    v_mfma_f32_16x16x32_bf16 v[208:211], a[200:203], v[88:91], v[208:211]
    s_waitcnt vmcnt(28)
    v_mfma_f32_16x16x32_bf16 v[208:211], a[204:207], v[92:95], v[208:211]
    s_waitcnt vmcnt(27)
    v_mfma_f32_16x16x32_bf16 v[212:215], a[192:195], v[96:99], v[212:215]
    s_waitcnt vmcnt(26)
    v_mfma_f32_16x16x32_bf16 v[212:215], a[196:199], v[100:103], v[212:215]
    s_waitcnt vmcnt(25)
    v_mfma_f32_16x16x32_bf16 v[212:215], a[200:203], v[104:107], v[212:215]
    s_waitcnt vmcnt(24)
    v_mfma_f32_16x16x32_bf16 v[212:215], a[204:207], v[108:111], v[212:215]
    s_waitcnt vmcnt(23)
    v_mfma_f32_16x16x32_bf16 v[208:211], a[208:211], v[112:115], v[208:211]
    s_waitcnt vmcnt(22)
    v_mfma_f32_16x16x32_bf16 v[208:211], a[212:215], v[116:119], v[208:211]
    s_waitcnt vmcnt(21)
    v_mfma_f32_16x16x32_bf16 v[208:211], a[216:219], v[120:123], v[208:211]
    s_waitcnt vmcnt(20)
    v_mfma_f32_16x16x32_bf16 v[208:211], a[220:223], v[124:127], v[208:211]
    s_waitcnt vmcnt(19)
    v_mfma_f32_16x16x32_bf16 v[212:215], a[208:211], v[128:131], v[212:215]
    s_waitcnt vmcnt(18)
    v_mfma_f32_16x16x32_bf16 v[212:215], a[212:215], v[132:135], v[212:215]
    s_waitcnt vmcnt(17)
    v_mfma_f32_16x16x32_bf16 v[212:215], a[216:219], v[136:139], v[212:215]
    s_waitcnt vmcnt(16)
    v_mfma_f32_16x16x32_bf16 v[212:215], a[220:223], v[140:143], v[212:215]
    s_waitcnt vmcnt(15)
    v_mfma_f32_16x16x32_bf16 v[208:211], a[224:227], v[144:147], v[208:211]
    s_waitcnt vmcnt(14)
    v_mfma_f32_16x16x32_bf16 v[208:211], a[228:231], v[148:151], v[208:211]
    s_waitcnt vmcnt(13)
    v_mfma_f32_16x16x32_bf16 v[208:211], a[232:235], v[152:155], v[208:211]
    s_waitcnt vmcnt(12)
    v_mfma_f32_16x16x32_bf16 v[208:211], a[236:239], v[156:159], v[208:211]
    s_waitcnt vmcnt(11)
    v_mfma_f32_16x16x32_bf16 v[212:215], a[224:227], v[160:163], v[212:215]
    s_waitcnt vmcnt(10)
    v_mfma_f32_16x16x32_bf16 v[212:215], a[228:231], v[164:167], v[212:215]
    s_waitcnt vmcnt(9)
    v_mfma_f32_16x16x32_bf16 v[212:215], a[232:235], v[168:171], v[212:215]
    s_waitcnt vmcnt(8)
    v_mfma_f32_16x16x32_bf16 v[212:215], a[236:239], v[172:175], v[212:215]
    s_waitcnt vmcnt(7)
    v_mfma_f32_16x16x32_bf16 v[208:211], a[240:243], v[176:179], v[208:211]
    s_waitcnt vmcnt(6)
    v_mfma_f32_16x16x32_bf16 v[208:211], a[244:247], v[180:183], v[208:211]
    s_waitcnt vmcnt(5)
    v_mfma_f32_16x16x32_bf16 v[208:211], a[248:251], v[184:187], v[208:211]
    s_waitcnt vmcnt(4)
    v_mfma_f32_16x16x32_bf16 v[208:211], a[252:255], v[188:191], v[208:211]
    s_waitcnt vmcnt(3)
    v_mfma_f32_16x16x32_bf16 v[212:215], a[240:243], v[192:195], v[212:215]
    s_waitcnt vmcnt(2)
    v_mfma_f32_16x16x32_bf16 v[212:215], a[244:247], v[196:199], v[212:215]
    s_waitcnt vmcnt(1)
    v_mfma_f32_16x16x32_bf16 v[212:215], a[248:251], v[200:203], v[212:215]
    s_waitcnt vmcnt(0)
    v_mfma_f32_16x16x32_bf16 v[212:215], a[252:255], v[204:207], v[212:215]
    s_lshl_b32 s67, s48, 11
    s_add_u32 s67, s67, 77824
    v_add_u32 v6, s67, v3
    s_nop 5
    ds_write_b128 v6, v[208:211]
    ds_write_b128 v6, v[212:215] offset:1024
    s_waitcnt lgkmcnt(0)
    s_barrier
    ds_read_b64 v[80:81], v13 offset:0
    ds_read_b64 v[82:83], v13 offset:2048
    ds_read_b64 v[84:85], v13 offset:4096
    ds_read_b64 v[86:87], v13 offset:6144
    v_lshlrev_b32 v228, 16, v228
    v_lshlrev_b32 v229, 16, v229
    v_lshlrev_b32 v88, 16, v230
    v_and_b32 v89, 0xffff0000, v230
    v_mul_f32 v228, v228, v88
    v_mul_f32 v229, v229, v89
    v_cvt_pk_bf16_f32 v90, v228, v229
    v_lshlrev_b32 v228, 16, v90
    v_and_b32 v229, 0xffff0000, v90
    v_mul_f32 v228, v228, v231
    v_mul_f32 v229, v229, v231
    v_cvt_pk_bf16_f32 v90, v228, v229
    v_lshlrev_b32 v228, 16, v90
    v_and_b32 v229, 0xffff0000, v90
    v_sub_f32 v231, 1.0, v231
    v_cvt_pk_bf16_f32 v231, v231, v231
    v_lshlrev_b32 v231, 16, v231
    s_waitcnt lgkmcnt(0)
    v_add_f32 v80, v80, v82
    v_add_f32 v81, v81, v83
    v_add_f32 v84, v84, v86
    v_add_f32 v85, v85, v87
    v_add_f32 v80, v80, v84
    v_add_f32 v81, v81, v85
    v_cvt_pk_bf16_f32 v90, v80, v81
    v_lshlrev_b32 v80, 16, v90
    v_and_b32 v81, 0xffff0000, v90
    v_mul_f32 v80, v80, v231
    v_mul_f32 v81, v81, v231
    v_cvt_pk_bf16_f32 v90, v80, v81
    v_lshlrev_b32 v80, 16, v90
    v_and_b32 v81, 0xffff0000, v90
    v_add_f32 v80, v80, v228
    v_add_f32 v81, v81, v229
    v_cvt_pk_bf16_f32 v80, v80, v81
    buffer_store_dword v80, v15, s[88:91], s54 offen
    s_cmp_eq_u32 s74, 60
    s_cbranch_scc1 PB_END
    s_sub_u32 s74, 120, s74
    s_mov_b32 s64, 1
    s_mov_b32 s97, 1
    s_barrier
PB_HALF:
    s_cmp_eq_u32 s75, 1
    s_cbranch_scc1 CVD_87
    s_mov_b32 s75, 1
    s_mov_b32 s58, 20480
    s_mov_b32 s59, 20736
    s_cmp_eq_u32 s48, 0
    s_cbranch_scc0 CVWD_89
CVW_88:
    buffer_load_dword v226, v24, s[36:39], s58 offen sc1
    s_add_u32 s65, s65, 1
    s_waitcnt vmcnt(0)
    v_cmp_gt_u32 vcc, 1, v226
    s_cbranch_vccz CVWD_89
    s_sleep 32
    s_cmp_lt_u32 s65, 262144
    s_cbranch_scc1 CVW_88
CVWD_89:
    s_cmp_eq_u32 s48, 0
    s_cbranch_scc0 CVWD_91
CVW_90:
    buffer_load_dword v226, v24, s[36:39], s59 offen sc1
    s_add_u32 s65, s65, 1
    s_waitcnt vmcnt(0)
    v_cmp_gt_u32 vcc, 1, v226
    s_cbranch_vccz CVWD_91
    s_sleep 32
    s_cmp_lt_u32 s65, 262144
    s_cbranch_scc1 CVW_90
CVWD_91:
    s_barrier
CVD_87:
    s_lshl_b32 s67, s74, 6
    s_add_u32 s67, s67, 85983232
    s_add_u32 s57, s67, 4096
    buffer_load_ushort v228, v14, s[36:39], s67 offen sc1
    buffer_load_ushort v229, v14, s[36:39], s57 offen sc1
    s_lshl_b32 s54, s74, 15
    buffer_load_dword v230, v15, s[84:87], s54 offen
    s_lshl_b32 s59, s74, 12
    s_add_u32 s59, s59, 524288
    s_cmp_eq_u32 s48, 0
    s_cbranch_scc0 OWD_93
OW_92:
    buffer_load_dword v25, v20, s[36:39], s59 offen sc1
    s_add_u32 s65, s65, 1
    s_waitcnt vmcnt(0)
    v_cmp_gt_u32 vcc, 1, v25
    s_cbranch_vccz OWD_93
    s_sleep 2
    s_cmp_lt_u32 s65, 262144
    s_cbranch_scc1 OW_92
OWD_93:
    s_barrier
    s_lshl_b32 s67, s74, 7
    s_add_u32 s67, s67, 88080384
    buffer_load_dword v231, v21, s[36:39], s67 offen sc1
    s_mul_i32 s58, s74, 37
    s_lshr_b32 s58, s58, 9
    s_mul_i32 s58, s58, 14
    s_sub_u32 s58, s74, s58
    s_lshl_b32 s58, s58, 18
    s_lshl_b32 s67, s48, 16
    s_add_u32 s58, s58, s67
    s_add_u32 s58, s58, 68157440
    s_lshl_b32 s67, s64, 12
    s_add_u32 s58, s58, s67
    s_mov_b64 exec, s[94:95]
    buffer_load_dwordx4 v[80:83], v3, s[36:39], s58 offen offset:0 sc1
    buffer_load_dwordx4 v[84:87], v3, s[36:39], s58 offen offset:1024 sc1
    buffer_load_dwordx4 v[88:91], v3, s[36:39], s58 offen offset:2048 sc1
    buffer_load_dwordx4 v[92:95], v3, s[36:39], s58 offen offset:3072 sc1
    s_add_u32 s58, s58, 8192
    buffer_load_dwordx4 v[96:99], v3, s[36:39], s58 offen offset:0 sc1
    buffer_load_dwordx4 v[100:103], v3, s[36:39], s58 offen offset:1024 sc1
    buffer_load_dwordx4 v[104:107], v3, s[36:39], s58 offen offset:2048 sc1
    buffer_load_dwordx4 v[108:111], v3, s[36:39], s58 offen offset:3072 sc1
    s_add_u32 s58, s58, 8192
    buffer_load_dwordx4 v[112:115], v3, s[36:39], s58 offen offset:0 sc1
    buffer_load_dwordx4 v[116:119], v3, s[36:39], s58 offen offset:1024 sc1
    buffer_load_dwordx4 v[120:123], v3, s[36:39], s58 offen offset:2048 sc1
    buffer_load_dwordx4 v[124:127], v3, s[36:39], s58 offen offset:3072 sc1
    s_add_u32 s58, s58, 8192
    buffer_load_dwordx4 v[128:131], v3, s[36:39], s58 offen offset:0 sc1
    buffer_load_dwordx4 v[132:135], v3, s[36:39], s58 offen offset:1024 sc1
    buffer_load_dwordx4 v[136:139], v3, s[36:39], s58 offen offset:2048 sc1
    buffer_load_dwordx4 v[140:143], v3, s[36:39], s58 offen offset:3072 sc1
    s_add_u32 s58, s58, 8192
    buffer_load_dwordx4 v[144:147], v3, s[36:39], s58 offen offset:0 sc1
    buffer_load_dwordx4 v[148:151], v3, s[36:39], s58 offen offset:1024 sc1
    buffer_load_dwordx4 v[152:155], v3, s[36:39], s58 offen offset:2048 sc1
    buffer_load_dwordx4 v[156:159], v3, s[36:39], s58 offen offset:3072 sc1
    s_add_u32 s58, s58, 8192
    buffer_load_dwordx4 v[160:163], v3, s[36:39], s58 offen offset:0 sc1
    buffer_load_dwordx4 v[164:167], v3, s[36:39], s58 offen offset:1024 sc1
    buffer_load_dwordx4 v[168:171], v3, s[36:39], s58 offen offset:2048 sc1
    buffer_load_dwordx4 v[172:175], v3, s[36:39], s58 offen offset:3072 sc1
    s_add_u32 s58, s58, 8192
    buffer_load_dwordx4 v[176:179], v3, s[36:39], s58 offen offset:0 sc1
    buffer_load_dwordx4 v[180:183], v3, s[36:39], s58 offen offset:1024 sc1
    buffer_load_dwordx4 v[184:187], v3, s[36:39], s58 offen offset:2048 sc1
    buffer_load_dwordx4 v[188:191], v3, s[36:39], s58 offen offset:3072 sc1
    s_add_u32 s58, s58, 8192
    buffer_load_dwordx4 v[192:195], v3, s[36:39], s58 offen offset:0 sc1
    buffer_load_dwordx4 v[196:199], v3, s[36:39], s58 offen offset:1024 sc1
    buffer_load_dwordx4 v[200:203], v3, s[36:39], s58 offen offset:2048 sc1
    buffer_load_dwordx4 v[204:207], v3, s[36:39], s58 offen offset:3072 sc1
    s_mov_b64 exec, -1
    s_waitcnt vmcnt(31)
    v_mfma_f32_16x16x32_bf16 v[208:211], a[128:131], v[80:83], 0
    s_waitcnt vmcnt(30)
    v_mfma_f32_16x16x32_bf16 v[208:211], a[132:135], v[84:87], v[208:211]
    s_waitcnt vmcnt(29)
    v_mfma_f32_16x16x32_bf16 v[208:211], a[136:139], v[88:91], v[208:211]
    s_waitcnt vmcnt(28)
    v_mfma_f32_16x16x32_bf16 v[208:211], a[140:143], v[92:95], v[208:211]
    s_waitcnt vmcnt(27)
    v_mfma_f32_16x16x32_bf16 v[208:211], a[144:147], v[96:99], v[208:211]
    s_waitcnt vmcnt(26)
    v_mfma_f32_16x16x32_bf16 v[208:211], a[148:151], v[100:103], v[208:211]
    s_waitcnt vmcnt(25)
    v_mfma_f32_16x16x32_bf16 v[208:211], a[152:155], v[104:107], v[208:211]
    s_waitcnt vmcnt(24)
    v_mfma_f32_16x16x32_bf16 v[208:211], a[156:159], v[108:111], v[208:211]
    s_waitcnt vmcnt(23)
    v_mfma_f32_16x16x32_bf16 v[208:211], a[160:163], v[112:115], v[208:211]
    s_waitcnt vmcnt(22)
    v_mfma_f32_16x16x32_bf16 v[208:211], a[164:167], v[116:119], v[208:211]
    s_waitcnt vmcnt(21)
    v_mfma_f32_16x16x32_bf16 v[208:211], a[168:171], v[120:123], v[208:211]
    s_waitcnt vmcnt(20)
    v_mfma_f32_16x16x32_bf16 v[208:211], a[172:175], v[124:127], v[208:211]
    s_waitcnt vmcnt(19)
    v_mfma_f32_16x16x32_bf16 v[208:211], a[176:179], v[128:131], v[208:211]
    s_waitcnt vmcnt(18)
    v_mfma_f32_16x16x32_bf16 v[208:211], a[180:183], v[132:135], v[208:211]
    s_waitcnt vmcnt(17)
    v_mfma_f32_16x16x32_bf16 v[208:211], a[184:187], v[136:139], v[208:211]
    s_waitcnt vmcnt(16)
    v_mfma_f32_16x16x32_bf16 v[208:211], a[188:191], v[140:143], v[208:211]
    s_waitcnt vmcnt(15)
    v_mfma_f32_16x16x32_bf16 v[208:211], a[192:195], v[144:147], v[208:211]
    s_waitcnt vmcnt(14)
    v_mfma_f32_16x16x32_bf16 v[208:211], a[196:199], v[148:151], v[208:211]
    s_waitcnt vmcnt(13)
    v_mfma_f32_16x16x32_bf16 v[208:211], a[200:203], v[152:155], v[208:211]
    s_waitcnt vmcnt(12)
    v_mfma_f32_16x16x32_bf16 v[208:211], a[204:207], v[156:159], v[208:211]
    s_waitcnt vmcnt(11)
    v_mfma_f32_16x16x32_bf16 v[208:211], a[208:211], v[160:163], v[208:211]
    s_waitcnt vmcnt(10)
    v_mfma_f32_16x16x32_bf16 v[208:211], a[212:215], v[164:167], v[208:211]
    s_waitcnt vmcnt(9)
    v_mfma_f32_16x16x32_bf16 v[208:211], a[216:219], v[168:171], v[208:211]
    s_waitcnt vmcnt(8)
    v_mfma_f32_16x16x32_bf16 v[208:211], a[220:223], v[172:175], v[208:211]
    s_waitcnt vmcnt(7)
    v_mfma_f32_16x16x32_bf16 v[208:211], a[224:227], v[176:179], v[208:211]
    s_waitcnt vmcnt(6)
    v_mfma_f32_16x16x32_bf16 v[208:211], a[228:231], v[180:183], v[208:211]
    s_waitcnt vmcnt(5)
    v_mfma_f32_16x16x32_bf16 v[208:211], a[232:235], v[184:187], v[208:211]
    s_waitcnt vmcnt(4)
    v_mfma_f32_16x16x32_bf16 v[208:211], a[236:239], v[188:191], v[208:211]
    s_waitcnt vmcnt(3)
    v_mfma_f32_16x16x32_bf16 v[208:211], a[240:243], v[192:195], v[208:211]
    s_waitcnt vmcnt(2)
    v_mfma_f32_16x16x32_bf16 v[208:211], a[244:247], v[196:199], v[208:211]
    s_waitcnt vmcnt(1)
    v_mfma_f32_16x16x32_bf16 v[208:211], a[248:251], v[200:203], v[208:211]
    s_waitcnt vmcnt(0)
    v_mfma_f32_16x16x32_bf16 v[208:211], a[252:255], v[204:207], v[208:211]
    s_lshl_b32 s67, s48, 11
    s_add_u32 s67, s67, 77824
    s_lshl_b32 s57, s64, 10
    s_add_u32 s67, s67, s57
    v_add_u32 v6, s67, v3
    s_nop 5
    ds_write_b128 v6, v[208:211]
    s_waitcnt lgkmcnt(0)
    s_barrier
    ds_read_b64 v[80:81], v13 offset:0
    ds_read_b64 v[82:83], v13 offset:2048
    ds_read_b64 v[84:85], v13 offset:4096
    ds_read_b64 v[86:87], v13 offset:6144
    v_lshlrev_b32 v228, 16, v228
    v_lshlrev_b32 v229, 16, v229
    v_lshlrev_b32 v88, 16, v230
    v_and_b32 v89, 0xffff0000, v230
    v_mul_f32 v228, v228, v88
    v_mul_f32 v229, v229, v89
    v_cvt_pk_bf16_f32 v90, v228, v229
    v_lshlrev_b32 v228, 16, v90
    v_and_b32 v229, 0xffff0000, v90
    v_mul_f32 v228, v228, v231
    v_mul_f32 v229, v229, v231
    v_cvt_pk_bf16_f32 v90, v228, v229
    v_lshlrev_b32 v228, 16, v90
    v_and_b32 v229, 0xffff0000, v90
    v_sub_f32 v231, 1.0, v231
    v_cvt_pk_bf16_f32 v231, v231, v231
    v_lshlrev_b32 v231, 16, v231
    s_waitcnt lgkmcnt(0)
    v_add_f32 v80, v80, v82
    v_add_f32 v81, v81, v83
    v_add_f32 v84, v84, v86
    v_add_f32 v85, v85, v87
    v_add_f32 v80, v80, v84
    v_add_f32 v81, v81, v85
    v_cvt_pk_bf16_f32 v90, v80, v81
    v_lshlrev_b32 v80, 16, v90
    v_and_b32 v81, 0xffff0000, v90
    v_mul_f32 v80, v80, v231
    v_mul_f32 v81, v81, v231
    v_cvt_pk_bf16_f32 v90, v80, v81
    v_lshlrev_b32 v80, 16, v90
    v_and_b32 v81, 0xffff0000, v90
    v_add_f32 v80, v80, v228
    v_add_f32 v81, v81, v229
    v_cvt_pk_bf16_f32 v80, v80, v81
    s_lshr_b32 s67, s48, s96
    s_cmp_eq_u32 s67, s97
    s_cselect_b64 exec, -1, 0
    buffer_store_dword v80, v15, s[88:91], s54 offen
    s_mov_b64 exec, -1
PB_END:
KEND:
    s_waitcnt vmcnt(0)
    s_endpgm
.section .rodata,"a"
.p2align 6
.amdhsa_kernel gated_mix__ssm_conv_h3__memory_aug_recurrent_mem_tr__prompt_kernel
  .amdhsa_next_free_vgpr 512
  .amdhsa_next_free_sgpr 102
  .amdhsa_accum_offset 256
  .amdhsa_group_segment_fixed_size 0
  .amdhsa_kernarg_size 136
  .amdhsa_user_sgpr_count 2
  .amdhsa_user_sgpr_kernarg_segment_ptr 1
  .amdhsa_system_sgpr_workgroup_id_x 1
.end_amdhsa_kernel
```
